```python
import torch

def _softmax(x, axis=-1):
    return torch.softmax(x, dim=axis)

def _gelu(x):
    return torch.nn.functional.gelu(x, approximate='tanh')

def _silu(x):
    return torch.nn.functional.silu(x)

def _sigmoid(x):
    return torch.sigmoid(x)

def _layernorm(x, axis=-1, eps=1e-05):
    m = x.mean(dim=axis, keepdim=True)
    v = x.var(dim=axis, keepdim=True, unbiased=False)
    return (x - m) / torch.sqrt(v + eps)

def _scatter_add(tgt, idx, src, axis=0):
    return tgt.clone().index_add_(axis, idx, src)

def _segment_sum(src, seg, n):
    out = torch.zeros((n,) + src.shape[1:], dtype=src.dtype)
    return out.index_add_(0, seg, src)

def _pad(x, pw):
    flat = tuple((v for pair in reversed(pw) for v in pair))
    return torch.nn.functional.pad(x, flat)
kernel_name = 'adaLN_cond__softmax_full_mha__dense_activation_relu__prompt'

def setup_inputs():

    _w = lambda a: (lambda t: t.to(torch.bfloat16) if t.is_floating_point() else t)(torch.as_tensor(a))

    def _A_setup():
        B, S, D = (1, 2048, 1024)
        return {'x': _w((lambda *s: torch.randn(*s, dtype=torch.bfloat16) * 0.05)(B, S, D)), 'wqkv': _w((lambda *s: torch.randn(*s, dtype=torch.bfloat16) * 0.05)(D, 3 * D)), 'wo': _w((lambda *s: torch.randn(*s, dtype=torch.bfloat16) * 0.05)(D, D))}
    _A_in = _A_setup()

    def _B_setup():
        B, S, D, Dff = (1, 2048, 1024, 3584)
        return {'x': _w((lambda *s: torch.randn(*s, dtype=torch.bfloat16) * 0.05)(B, S, D)), 'w1': _w((lambda *s: torch.randn(*s, dtype=torch.bfloat16) * 0.05)(D, Dff)), 'w2': _w((lambda *s: torch.randn(*s, dtype=torch.bfloat16) * 0.05)(Dff, D))}
    _B_in = _B_setup()
    return {'A_x': _A_in['x'], 'A_wqkv': _A_in['wqkv'], 'A_wo': _A_in['wo'], 'B_x': _B_in['x'], 'B_w1': _B_in['w1'], 'B_w2': _B_in['w2'], 'c': _w((lambda *s: torch.randn(*s, dtype=torch.bfloat16) * 0.2)(1, 1024) * 8.0), 'w_mod': _w((lambda *s: torch.randn(*s, dtype=torch.bfloat16) * 0.2)(1024, 6 * 1024) * 1024 ** (-0.5) * 8.0)}

def reference(A_x, A_wqkv, A_wo, B_x, B_w1, B_w2, c, w_mod):

    def _A_ref(x, wqkv, wo):
        B, S, D = x.shape
        H = 32
        Dh = D // H
        qkv = (lambda x, *d: x.permute(*d))((x @ wqkv).reshape(B, S, 3, H, Dh), 2, 0, 3, 1, 4)
        q, k, v = (qkv[0], qkv[1], qkv[2])
        scale = Dh ** (-0.5)
        scores = torch.einsum('bhqd,bhkd->bhqk', q, k) * scale
        p = _softmax(scores, axis=-1)
        o = torch.einsum('bhqk,bhkd->bhqd', p, v)
        return (lambda x, *d: x.permute(*d))(o, 0, 2, 1, 3).reshape(B, S, D) @ wo

    def _B_ref(x, w1, w2):
        h = torch.einsum('bsd,df->bsf', x, w1)
        zero = torch.zeros_like(h)
        h = torch.maximum(h, zero)
        return torch.einsum('bsf,fd->bsd', h, w2)
    x = A_x
    mod = (_silu(c) @ w_mod).reshape(c.shape[0], 6, 1, -1)
    sa, ca, ga, sb, cb, gb = (mod[:, 0].clone(), mod[:, 1].clone(), mod[:, 2].clone(), mod[:, 3].clone(), mod[:, 4].clone(), mod[:, 5].clone())
    h = _layernorm(x, axis=-1) * (1 + ca) + sa
    x = x + ga * _A_ref(h, A_wqkv, A_wo)
    h = _layernorm(x, axis=-1) * (1 + cb) + sb
    x = x + gb * _B_ref(h, B_w1, B_w2)
    return x
```

```asm
; @launch kernel=mod_kernel grid=(512,1,1) block=(256,1,1) lds=5120
; @launch kernel=attn_kernel grid=(256,1,1) block=(512,1,1) lds=163840
.amdgcn_target "amdgcn-amd-amdhsa--gfx950"
.text
.globl mod_kernel
.p2align 8
.type mod_kernel,@function
mod_kernel:
  s_cmp_ge_u32 s2, 512
  s_cbranch_scc1 .Lmod_kernel_end_1
  s_cmp_lt_u32 s2, 32
  s_cbranch_scc1 .Lmod_kernel_rt_4
  s_sub_u32 s2, s2, 32
  s_cmp_ge_u32 s2, 384
  s_cbranch_scc1 .Lmod_kernel_pf_3
  s_load_dwordx2 s[20:21], s[0:1], 80
  s_cmp_ge_u32 s2, 128
  s_cbranch_scc1 .Lmod_kernel_xr_2
  s_mov_b32 s3, s2
  s_load_dwordx4 s[4:7], s[0:1], 48
  s_and_b32 s22, s3, 3
  s_lshr_b32 s23, s3, 2
  v_and_b32 v1, 7, v0
  v_lshrrev_b32 v2, 3, v0
  v_mul_u32_u24 v3, 12288, v2
  v_lshl_add_u32 v3, v1, 4, v3
  s_mul_i32 s24, s22, 3145728
  s_lshl_b32 s25, s23, 7
  s_add_u32 s24, s24, s25
  v_lshlrev_b32 v4, 1, v2
  s_lshl_b32 s25, s22, 9
  s_waitcnt lgkmcnt(0)
  s_mov_b32 s8, s6
  s_mov_b32 s9, s7
  s_mov_b32 s10, 0xc00000
  s_mov_b32 s11, 0x20000
  s_mov_b32 s12, s4
  s_mov_b32 s13, s5
  s_mov_b32 s14, 0x800
  s_mov_b32 s15, 0x20000
  buffer_load_ushort v40, v4, s[12:15], s25 offen offset:0
  buffer_load_ushort v41, v4, s[12:15], s25 offen offset:64
  buffer_load_ushort v42, v4, s[12:15], s25 offen offset:128
  buffer_load_ushort v43, v4, s[12:15], s25 offen offset:192
  buffer_load_ushort v44, v4, s[12:15], s25 offen offset:256
  buffer_load_ushort v45, v4, s[12:15], s25 offen offset:320
  buffer_load_ushort v46, v4, s[12:15], s25 offen offset:384
  buffer_load_ushort v47, v4, s[12:15], s25 offen offset:448
  buffer_load_dwordx4 v[8:11], v3, s[8:11], s24 offen nt
  s_add_u32 s24, s24, 393216
  buffer_load_dwordx4 v[12:15], v3, s[8:11], s24 offen nt
  s_add_u32 s24, s24, 393216
  buffer_load_dwordx4 v[16:19], v3, s[8:11], s24 offen nt
  s_add_u32 s24, s24, 393216
  buffer_load_dwordx4 v[20:23], v3, s[8:11], s24 offen nt
  s_add_u32 s24, s24, 393216
  buffer_load_dwordx4 v[24:27], v3, s[8:11], s24 offen nt
  s_add_u32 s24, s24, 393216
  buffer_load_dwordx4 v[28:31], v3, s[8:11], s24 offen nt
  s_add_u32 s24, s24, 393216
  buffer_load_dwordx4 v[32:35], v3, s[8:11], s24 offen nt
  s_add_u32 s24, s24, 393216
  buffer_load_dwordx4 v[36:39], v3, s[8:11], s24 offen nt
  s_add_u32 s16, s20, 0x0
  s_addc_u32 s17, s21, 0
  s_mov_b32 s18, 0x100000
  s_mov_b32 s19, 0x20000
  s_waitcnt vmcnt(8)
  v_lshlrev_b32 v40, 16, v40
  v_lshlrev_b32 v41, 16, v41
  v_lshlrev_b32 v42, 16, v42
  v_lshlrev_b32 v43, 16, v43
  v_lshlrev_b32 v44, 16, v44
  v_lshlrev_b32 v45, 16, v45
  v_lshlrev_b32 v46, 16, v46
  v_lshlrev_b32 v47, 16, v47
  v_mul_f32 v48, 0xbfb8aa3b, v40
  v_mul_f32 v49, 0xbfb8aa3b, v41
  v_mul_f32 v50, 0xbfb8aa3b, v42
  v_mul_f32 v51, 0xbfb8aa3b, v43
  v_mul_f32 v52, 0xbfb8aa3b, v44
  v_mul_f32 v53, 0xbfb8aa3b, v45
  v_mul_f32 v54, 0xbfb8aa3b, v46
  v_mul_f32 v55, 0xbfb8aa3b, v47
  v_exp_f32 v48, v48
  v_exp_f32 v49, v49
  v_exp_f32 v50, v50
  v_exp_f32 v51, v51
  v_exp_f32 v52, v52
  v_exp_f32 v53, v53
  v_exp_f32 v54, v54
  v_exp_f32 v55, v55
  v_add_f32 v48, 1.0, v48
  v_add_f32 v49, 1.0, v49
  v_add_f32 v50, 1.0, v50
  v_add_f32 v51, 1.0, v51
  v_add_f32 v52, 1.0, v52
  v_add_f32 v53, 1.0, v53
  v_add_f32 v54, 1.0, v54
  v_add_f32 v55, 1.0, v55
  v_rcp_f32 v48, v48
  v_rcp_f32 v49, v49
  v_rcp_f32 v50, v50
  v_rcp_f32 v51, v51
  v_rcp_f32 v52, v52
  v_rcp_f32 v53, v53
  v_rcp_f32 v54, v54
  v_rcp_f32 v55, v55
  v_mul_f32 v40, v40, v48
  v_mul_f32 v41, v41, v49
  v_mul_f32 v42, v42, v50
  v_mul_f32 v43, v43, v51
  v_mul_f32 v44, v44, v52
  v_mul_f32 v45, v45, v53
  v_mul_f32 v46, v46, v54
  v_mul_f32 v47, v47, v55
  v_cvt_pk_bf16_f32 v40, v40, v40
  v_and_b32 v40, 0xffff0000, v40
  v_cvt_pk_bf16_f32 v41, v41, v41
  v_and_b32 v41, 0xffff0000, v41
  v_cvt_pk_bf16_f32 v42, v42, v42
  v_and_b32 v42, 0xffff0000, v42
  v_cvt_pk_bf16_f32 v43, v43, v43
  v_and_b32 v43, 0xffff0000, v43
  v_cvt_pk_bf16_f32 v44, v44, v44
  v_and_b32 v44, 0xffff0000, v44
  v_cvt_pk_bf16_f32 v45, v45, v45
  v_and_b32 v45, 0xffff0000, v45
  v_cvt_pk_bf16_f32 v46, v46, v46
  v_and_b32 v46, 0xffff0000, v46
  v_cvt_pk_bf16_f32 v47, v47, v47
  v_and_b32 v47, 0xffff0000, v47
  v_lshrrev_b32 v5, 4, v0
  v_lshlrev_b32 v5, 2, v5
  v_mul_u32_u24 v6, 640, v1
  v_add_u32 v5, v5, v6
  s_waitcnt vmcnt(7)
  v_lshlrev_b32 v48, 16, v8
  v_and_b32 v49, 0xffff0000, v8
  v_mul_f32 v56, v48, v40
  v_mul_f32 v57, v49, v40
  v_lshlrev_b32 v48, 16, v9
  v_and_b32 v49, 0xffff0000, v9
  v_mul_f32 v58, v48, v40
  v_mul_f32 v59, v49, v40
  v_lshlrev_b32 v48, 16, v10
  v_and_b32 v49, 0xffff0000, v10
  v_mul_f32 v60, v48, v40
  v_mul_f32 v61, v49, v40
  v_lshlrev_b32 v48, 16, v11
  v_and_b32 v49, 0xffff0000, v11
  v_mul_f32 v62, v48, v40
  v_mul_f32 v63, v49, v40
  s_waitcnt vmcnt(6)
  v_lshlrev_b32 v48, 16, v12
  v_and_b32 v49, 0xffff0000, v12
  v_fmac_f32 v56, v48, v41
  v_fmac_f32 v57, v49, v41
  v_lshlrev_b32 v48, 16, v13
  v_and_b32 v49, 0xffff0000, v13
  v_fmac_f32 v58, v48, v41
  v_fmac_f32 v59, v49, v41
  v_lshlrev_b32 v48, 16, v14
  v_and_b32 v49, 0xffff0000, v14
  v_fmac_f32 v60, v48, v41
  v_fmac_f32 v61, v49, v41
  v_lshlrev_b32 v48, 16, v15
  v_and_b32 v49, 0xffff0000, v15
  v_fmac_f32 v62, v48, v41
  v_fmac_f32 v63, v49, v41
  s_waitcnt vmcnt(5)
  v_lshlrev_b32 v48, 16, v16
  v_and_b32 v49, 0xffff0000, v16
  v_fmac_f32 v56, v48, v42
  v_fmac_f32 v57, v49, v42
  v_lshlrev_b32 v48, 16, v17
  v_and_b32 v49, 0xffff0000, v17
  v_fmac_f32 v58, v48, v42
  v_fmac_f32 v59, v49, v42
  v_lshlrev_b32 v48, 16, v18
  v_and_b32 v49, 0xffff0000, v18
  v_fmac_f32 v60, v48, v42
  v_fmac_f32 v61, v49, v42
  v_lshlrev_b32 v48, 16, v19
  v_and_b32 v49, 0xffff0000, v19
  v_fmac_f32 v62, v48, v42
  v_fmac_f32 v63, v49, v42
  s_waitcnt vmcnt(4)
  v_lshlrev_b32 v48, 16, v20
  v_and_b32 v49, 0xffff0000, v20
  v_fmac_f32 v56, v48, v43
  v_fmac_f32 v57, v49, v43
  v_lshlrev_b32 v48, 16, v21
  v_and_b32 v49, 0xffff0000, v21
  v_fmac_f32 v58, v48, v43
  v_fmac_f32 v59, v49, v43
  v_lshlrev_b32 v48, 16, v22
  v_and_b32 v49, 0xffff0000, v22
  v_fmac_f32 v60, v48, v43
  v_fmac_f32 v61, v49, v43
  v_lshlrev_b32 v48, 16, v23
  v_and_b32 v49, 0xffff0000, v23
  v_fmac_f32 v62, v48, v43
  v_fmac_f32 v63, v49, v43
  s_waitcnt vmcnt(3)
  v_lshlrev_b32 v48, 16, v24
  v_and_b32 v49, 0xffff0000, v24
  v_fmac_f32 v56, v48, v44
  v_fmac_f32 v57, v49, v44
  v_lshlrev_b32 v48, 16, v25
  v_and_b32 v49, 0xffff0000, v25
  v_fmac_f32 v58, v48, v44
  v_fmac_f32 v59, v49, v44
  v_lshlrev_b32 v48, 16, v26
  v_and_b32 v49, 0xffff0000, v26
  v_fmac_f32 v60, v48, v44
  v_fmac_f32 v61, v49, v44
  v_lshlrev_b32 v48, 16, v27
  v_and_b32 v49, 0xffff0000, v27
  v_fmac_f32 v62, v48, v44
  v_fmac_f32 v63, v49, v44
  s_waitcnt vmcnt(2)
  v_lshlrev_b32 v48, 16, v28
  v_and_b32 v49, 0xffff0000, v28
  v_fmac_f32 v56, v48, v45
  v_fmac_f32 v57, v49, v45
  v_lshlrev_b32 v48, 16, v29
  v_and_b32 v49, 0xffff0000, v29
  v_fmac_f32 v58, v48, v45
  v_fmac_f32 v59, v49, v45
  v_lshlrev_b32 v48, 16, v30
  v_and_b32 v49, 0xffff0000, v30
  v_fmac_f32 v60, v48, v45
  v_fmac_f32 v61, v49, v45
  v_lshlrev_b32 v48, 16, v31
  v_and_b32 v49, 0xffff0000, v31
  v_fmac_f32 v62, v48, v45
  v_fmac_f32 v63, v49, v45
  s_waitcnt vmcnt(1)
  v_lshlrev_b32 v48, 16, v32
  v_and_b32 v49, 0xffff0000, v32
  v_fmac_f32 v56, v48, v46
  v_fmac_f32 v57, v49, v46
  v_lshlrev_b32 v48, 16, v33
  v_and_b32 v49, 0xffff0000, v33
  v_fmac_f32 v58, v48, v46
  v_fmac_f32 v59, v49, v46
  v_lshlrev_b32 v48, 16, v34
  v_and_b32 v49, 0xffff0000, v34
  v_fmac_f32 v60, v48, v46
  v_fmac_f32 v61, v49, v46
  v_lshlrev_b32 v48, 16, v35
  v_and_b32 v49, 0xffff0000, v35
  v_fmac_f32 v62, v48, v46
  v_fmac_f32 v63, v49, v46
  s_waitcnt vmcnt(0)
  v_lshlrev_b32 v48, 16, v36
  v_and_b32 v49, 0xffff0000, v36
  v_fmac_f32 v56, v48, v47
  v_fmac_f32 v57, v49, v47
  v_lshlrev_b32 v48, 16, v37
  v_and_b32 v49, 0xffff0000, v37
  v_fmac_f32 v58, v48, v47
  v_fmac_f32 v59, v49, v47
  v_lshlrev_b32 v48, 16, v38
  v_and_b32 v49, 0xffff0000, v38
  v_fmac_f32 v60, v48, v47
  v_fmac_f32 v61, v49, v47
  v_lshlrev_b32 v48, 16, v39
  v_and_b32 v49, 0xffff0000, v39
  v_fmac_f32 v62, v48, v47
  v_fmac_f32 v63, v49, v47
  s_nop 1
  v_add_f32_dpp v56, v56, v56 row_ror:8 row_mask:0xf bank_mask:0xf
  v_add_f32_dpp v57, v57, v57 row_ror:8 row_mask:0xf bank_mask:0xf
  v_add_f32_dpp v58, v58, v58 row_ror:8 row_mask:0xf bank_mask:0xf
  v_add_f32_dpp v59, v59, v59 row_ror:8 row_mask:0xf bank_mask:0xf
  v_add_f32_dpp v60, v60, v60 row_ror:8 row_mask:0xf bank_mask:0xf
  v_add_f32_dpp v61, v61, v61 row_ror:8 row_mask:0xf bank_mask:0xf
  v_add_f32_dpp v62, v62, v62 row_ror:8 row_mask:0xf bank_mask:0xf
  v_add_f32_dpp v63, v63, v63 row_ror:8 row_mask:0xf bank_mask:0xf
  ds_write_b32 v5, v56 offset:0
  ds_write_b32 v5, v57 offset:80
  ds_write_b32 v5, v58 offset:160
  ds_write_b32 v5, v59 offset:240
  ds_write_b32 v5, v60 offset:320
  ds_write_b32 v5, v61 offset:400
  ds_write_b32 v5, v62 offset:480
  ds_write_b32 v5, v63 offset:560
  s_cmp_lg_u32 s23, 0
  s_cbranch_scc1 .Lmod_kernel_nosilu_5
  s_lshl_b32 s25, s22, 9
  s_add_u32 s25, s25, 147456
  buffer_store_short_d16_hi v40, v4, s[16:19], s25 offen offset:0
  buffer_store_short_d16_hi v41, v4, s[16:19], s25 offen offset:64
  buffer_store_short_d16_hi v42, v4, s[16:19], s25 offen offset:128
  buffer_store_short_d16_hi v43, v4, s[16:19], s25 offen offset:192
  buffer_store_short_d16_hi v44, v4, s[16:19], s25 offen offset:256
  buffer_store_short_d16_hi v45, v4, s[16:19], s25 offen offset:320
  buffer_store_short_d16_hi v46, v4, s[16:19], s25 offen offset:384
  buffer_store_short_d16_hi v47, v4, s[16:19], s25 offen offset:448
.Lmod_kernel_nosilu_5:
  s_waitcnt lgkmcnt(0)
  s_barrier
  v_cmp_gt_u32 vcc, 64, v0
  s_and_saveexec_b64 s[30:31], vcc
  s_cbranch_execz .Lmod_kernel_end_1
  v_mul_u32_u24 v5, 80, v0
  ds_read_b128 v[8:11], v5 offset:0
  ds_read_b128 v[12:15], v5 offset:16
  ds_read_b128 v[16:19], v5 offset:32
  ds_read_b128 v[20:23], v5 offset:48
  v_and_b32 v2, 63, v0
  v_lshlrev_b32 v2, 2, v2
  s_mul_i32 s24, s22, 24576
  s_lshl_b32 s25, s23, 8
  s_add_u32 s24, s24, s25
  s_add_u32 s24, s24, 0
  s_waitcnt lgkmcnt(0)
  v_add_f32 v8, v8, v16
  v_add_f32 v9, v9, v17
  v_add_f32 v10, v10, v18
  v_add_f32 v11, v11, v19
  v_add_f32 v12, v12, v20
  v_add_f32 v13, v13, v21
  v_add_f32 v14, v14, v22
  v_add_f32 v15, v15, v23
  v_add_f32 v8, v8, v12
  v_add_f32 v9, v9, v13
  v_add_f32 v10, v10, v14
  v_add_f32 v11, v11, v15
  v_add_f32 v8, v8, v10
  v_add_f32 v9, v9, v11
  v_add_f32 v8, v8, v9
  buffer_store_dword v8, v2, s[16:19], s24 offen
  s_endpgm
.Lmod_kernel_xr_2:
  s_load_dwordx2 s[4:5], s[0:1], 0
  s_sub_u32 s3, s2, 128
  s_and_b32 s22, s3, 1
  s_lshl_b32 s22, s22, 3
  s_lshr_b32 s23, s3, 5
  s_add_u32 s22, s22, s23
  s_lshl_b32 s22, s22, 2
  s_bfe_u32 s23, s3, 0x20001
  s_add_u32 s22, s22, s23
  s_lshl_b32 s22, s22, 2
  s_bfe_u32 s23, s3, 0x20003
  s_add_u32 s22, s22, s23
  v_lshrrev_b32 v1, 5, v0
  v_and_b32 v2, 31, v0
  v_lshlrev_b32 v3, 4, v2
  v_lshl_add_u32 v3, v1, 11, v3
  s_lshl_b32 s23, s22, 14
  s_waitcnt lgkmcnt(0)
  s_mov_b32 s8, s4
  s_mov_b32 s9, s5
  s_mov_b32 s10, 0x400000
  s_mov_b32 s11, 0x20000
  buffer_load_dwordx4 v[8:11], v3, s[8:11], s23 offen offset:0
  buffer_load_dwordx4 v[12:15], v3, s[8:11], s23 offen offset:512
  buffer_load_dwordx4 v[16:19], v3, s[8:11], s23 offen offset:1024
  buffer_load_dwordx4 v[20:23], v3, s[8:11], s23 offen offset:1536
  s_add_u32 s16, s20, 0x0
  s_addc_u32 s17, s21, 0
  s_mov_b32 s18, 0x100000
  s_mov_b32 s19, 0x20000
  v_lshlrev_b32 v4, 3, v1
  s_lshl_b32 s22, s22, 6
  s_add_u32 s22, s22, 163840
  s_waitcnt vmcnt(3)
  v_lshlrev_b32 v24, 16, v8
  v_and_b32 v25, 0xffff0000, v8
  v_lshlrev_b32 v26, 16, v9
  v_and_b32 v27, 0xffff0000, v9
  v_lshlrev_b32 v28, 16, v10
  v_and_b32 v29, 0xffff0000, v10
  v_lshlrev_b32 v30, 16, v11
  v_and_b32 v31, 0xffff0000, v11
  v_mov_b32 v58, v24
  v_mov_b32 v59, v25
  v_mov_b32 v60, v26
  v_mov_b32 v61, v27
  v_pk_add_f32 v[58:59], v[58:59], v[28:29]
  v_pk_add_f32 v[60:61], v[60:61], v[30:31]
  s_waitcnt vmcnt(2)
  v_lshlrev_b32 v32, 16, v12
  v_and_b32 v33, 0xffff0000, v12
  v_lshlrev_b32 v34, 16, v13
  v_and_b32 v35, 0xffff0000, v13
  v_lshlrev_b32 v36, 16, v14
  v_and_b32 v37, 0xffff0000, v14
  v_lshlrev_b32 v38, 16, v15
  v_and_b32 v39, 0xffff0000, v15
  v_pk_add_f32 v[58:59], v[58:59], v[32:33]
  v_pk_add_f32 v[60:61], v[60:61], v[34:35]
  v_pk_add_f32 v[58:59], v[58:59], v[36:37]
  v_pk_add_f32 v[60:61], v[60:61], v[38:39]
  s_waitcnt vmcnt(1)
  v_lshlrev_b32 v40, 16, v16
  v_and_b32 v41, 0xffff0000, v16
  v_lshlrev_b32 v42, 16, v17
  v_and_b32 v43, 0xffff0000, v17
  v_lshlrev_b32 v44, 16, v18
  v_and_b32 v45, 0xffff0000, v18
  v_lshlrev_b32 v46, 16, v19
  v_and_b32 v47, 0xffff0000, v19
  v_pk_add_f32 v[58:59], v[58:59], v[40:41]
  v_pk_add_f32 v[60:61], v[60:61], v[42:43]
  v_pk_add_f32 v[58:59], v[58:59], v[44:45]
  v_pk_add_f32 v[60:61], v[60:61], v[46:47]
  s_waitcnt vmcnt(0)
  v_lshlrev_b32 v48, 16, v20
  v_and_b32 v49, 0xffff0000, v20
  v_lshlrev_b32 v50, 16, v21
  v_and_b32 v51, 0xffff0000, v21
  v_lshlrev_b32 v52, 16, v22
  v_and_b32 v53, 0xffff0000, v22
  v_lshlrev_b32 v54, 16, v23
  v_and_b32 v55, 0xffff0000, v23
  v_pk_add_f32 v[58:59], v[58:59], v[48:49]
  v_pk_add_f32 v[60:61], v[60:61], v[50:51]
  v_pk_add_f32 v[58:59], v[58:59], v[52:53]
  v_pk_add_f32 v[60:61], v[60:61], v[54:55]
  v_pk_add_f32 v[58:59], v[58:59], v[60:61]
  v_add_f32 v58, v58, v59
  s_nop 1
  v_add_f32_dpp v58, v58, v58 row_ror:1 row_mask:0xf bank_mask:0xf
  s_nop 1
  v_add_f32_dpp v58, v58, v58 row_ror:2 row_mask:0xf bank_mask:0xf
  s_nop 1
  v_add_f32_dpp v58, v58, v58 row_ror:4 row_mask:0xf bank_mask:0xf
  s_nop 1
  v_add_f32_dpp v58, v58, v58 row_ror:8 row_mask:0xf bank_mask:0xf
  v_mov_b32 v59, v58
  s_nop 1
  v_permlane16_swap_b32 v58, v59
  s_nop 1
  v_add_f32 v58, v58, v59
  v_mul_f32 v56, 0xba800000, v58
  v_pk_add_f32 v[24:25], v[24:25], v[56:57] op_sel_hi:[1,0]
  v_pk_add_f32 v[26:27], v[26:27], v[56:57] op_sel_hi:[1,0]
  v_pk_add_f32 v[28:29], v[28:29], v[56:57] op_sel_hi:[1,0]
  v_pk_add_f32 v[30:31], v[30:31], v[56:57] op_sel_hi:[1,0]
  v_pk_add_f32 v[32:33], v[32:33], v[56:57] op_sel_hi:[1,0]
  v_pk_add_f32 v[34:35], v[34:35], v[56:57] op_sel_hi:[1,0]
  v_pk_add_f32 v[36:37], v[36:37], v[56:57] op_sel_hi:[1,0]
  v_pk_add_f32 v[38:39], v[38:39], v[56:57] op_sel_hi:[1,0]
  v_pk_add_f32 v[40:41], v[40:41], v[56:57] op_sel_hi:[1,0]
  v_pk_add_f32 v[42:43], v[42:43], v[56:57] op_sel_hi:[1,0]
  v_pk_add_f32 v[44:45], v[44:45], v[56:57] op_sel_hi:[1,0]
  v_pk_add_f32 v[46:47], v[46:47], v[56:57] op_sel_hi:[1,0]
  v_pk_add_f32 v[48:49], v[48:49], v[56:57] op_sel_hi:[1,0]
  v_pk_add_f32 v[50:51], v[50:51], v[56:57] op_sel_hi:[1,0]
  v_pk_add_f32 v[52:53], v[52:53], v[56:57] op_sel_hi:[1,0]
  v_pk_add_f32 v[54:55], v[54:55], v[56:57] op_sel_hi:[1,0]
  v_pk_mul_f32 v[58:59], v[24:25], v[24:25]
  v_pk_mul_f32 v[60:61], v[26:27], v[26:27]
  v_pk_fma_f32 v[58:59], v[28:29], v[28:29], v[58:59]
  v_pk_fma_f32 v[60:61], v[30:31], v[30:31], v[60:61]
  v_pk_fma_f32 v[58:59], v[32:33], v[32:33], v[58:59]
  v_pk_fma_f32 v[60:61], v[34:35], v[34:35], v[60:61]
  v_pk_fma_f32 v[58:59], v[36:37], v[36:37], v[58:59]
  v_pk_fma_f32 v[60:61], v[38:39], v[38:39], v[60:61]
  v_pk_fma_f32 v[58:59], v[40:41], v[40:41], v[58:59]
  v_pk_fma_f32 v[60:61], v[42:43], v[42:43], v[60:61]
  v_pk_fma_f32 v[58:59], v[44:45], v[44:45], v[58:59]
  v_pk_fma_f32 v[60:61], v[46:47], v[46:47], v[60:61]
  v_pk_fma_f32 v[58:59], v[48:49], v[48:49], v[58:59]
  v_pk_fma_f32 v[60:61], v[50:51], v[50:51], v[60:61]
  v_pk_fma_f32 v[58:59], v[52:53], v[52:53], v[58:59]
  v_pk_fma_f32 v[60:61], v[54:55], v[54:55], v[60:61]
  v_pk_add_f32 v[58:59], v[58:59], v[60:61]
  v_add_f32 v58, v58, v59
  s_nop 1
  v_add_f32_dpp v58, v58, v58 row_ror:1 row_mask:0xf bank_mask:0xf
  s_nop 1
  v_add_f32_dpp v58, v58, v58 row_ror:2 row_mask:0xf bank_mask:0xf
  s_nop 1
  v_add_f32_dpp v58, v58, v58 row_ror:4 row_mask:0xf bank_mask:0xf
  s_nop 1
  v_add_f32_dpp v58, v58, v58 row_ror:8 row_mask:0xf bank_mask:0xf
  v_mov_b32 v59, v58
  s_nop 1
  v_permlane16_swap_b32 v58, v59
  s_nop 1
  v_add_f32 v58, v58, v59
  v_mov_b32 v62, 0x3727c5ac
  v_fmac_f32 v62, 0x3a800000, v58
  v_rsq_f32 v62, v62
  v_cmp_eq_u32 vcc, 0, v2
  v_mul_f32 v63, v56, v62
  s_and_saveexec_b64 s[30:31], vcc
  buffer_store_dwordx2 v[62:63], v4, s[16:19], s22 offen
  v_mov_b32 v5, 0
  s_lshl_b32 s23, s3, 7
  s_add_u32 s23, s23, 655360
  buffer_store_dword v5, v5, s[16:19], s23 offen
  s_endpgm
.Lmod_kernel_pf_3:
  s_sub_u32 s3, s2, 384
  s_getpc_b64 s[40:41]
.Lmod_kernel_pc_6:
  s_add_u32 s40, s40, attn_kernel-.Lmod_kernel_pc_6
  s_addc_u32 s41, s41, 0
  v_lshlrev_b32 v44, 7, v0
  v_min_u32 v44, .Ltext_end-attn_kernel-128, v44
  v_mov_b32 v45, s41
  v_add_co_u32 v44, vcc, s40, v44
  s_nop 1
  v_addc_co_u32 v45, vcc, 0, v45, vcc
  global_load_dword v46, v[44:45], off
  global_load_dword v47, v[44:45], off offset:64
  s_load_dwordx2 s[4:5], s[0:1], 8
  s_lshl_b32 s3, s3, 15
  v_lshlrev_b32 v1, 4, v0
  s_waitcnt lgkmcnt(0)
  s_mov_b32 s8, s4
  s_mov_b32 s9, s5
  s_mov_b32 s10, 0x600000
  s_mov_b32 s11, 0x20000
  buffer_load_dwordx4 v[8:11], v1, s[8:11], s3 offen
  s_add_u32 s3, s3, 4096
  buffer_load_dwordx4 v[12:15], v1, s[8:11], s3 offen
  s_add_u32 s3, s3, 4096
  buffer_load_dwordx4 v[16:19], v1, s[8:11], s3 offen
  s_add_u32 s3, s3, 4096
  buffer_load_dwordx4 v[20:23], v1, s[8:11], s3 offen
  s_add_u32 s3, s3, 4096
  buffer_load_dwordx4 v[24:27], v1, s[8:11], s3 offen
  s_add_u32 s3, s3, 4096
  buffer_load_dwordx4 v[28:31], v1, s[8:11], s3 offen
  s_add_u32 s3, s3, 4096
  buffer_load_dwordx4 v[32:35], v1, s[8:11], s3 offen
  s_add_u32 s3, s3, 4096
  buffer_load_dwordx4 v[36:39], v1, s[8:11], s3 offen
  s_add_u32 s3, s3, 4096
  s_waitcnt vmcnt(0)
  s_endpgm
.Lmod_kernel_rt_4:
  s_cmp_ge_u32 s2, 24
  s_cbranch_scc1 .Lmod_kernel_rtw_7
  s_load_dwordx2 s[4:5], s[0:1], 8
  s_load_dwordx2 s[20:21], s[0:1], 80
  s_lshr_b32 s22, s2, 2
  s_cmp_ge_u32 s22, 3
  s_cselect_b32 s23, 3, 0
  s_cselect_b32 s25, 1408, 0
  s_sub_u32 s24, s22, s23
  s_lshl_b32 s24, s24, 11
  s_max_u32 s25, s25, 384
  s_add_u32 s24, s24, s25
  s_and_b32 s23, s2, 3
  s_mul_i32 s23, s23, 1572864
  s_add_u32 s24, s24, s23
  s_lshl_b32 s25, s2, 15
  v_lshrrev_b32 v1, 6, v0
  v_bfe_u32 v2, v0, 3, 3
  v_lshl_add_u32 v2, v1, 6, v2
  v_mul_u32_u24 v2, 6144, v2
  v_and_b32 v3, 7, v0
  v_bfe_u32 v4, v0, 4, 1
  v_lshlrev_b32 v4, 1, v4
  v_xor_b32 v3, v3, v4
  v_lshl_add_u32 v2, v3, 4, v2
  v_xor_b32 v4, 64, v2
  v_and_b32 v3, 63, v0
  v_lshlrev_b32 v3, 4, v3
  v_lshl_add_u32 v3, v1, 13, v3
  s_waitcnt lgkmcnt(0)
  s_mov_b32 s8, s4
  s_mov_b32 s9, s5
  s_mov_b32 s10, 0x600000
  s_mov_b32 s11, 0x20000
  s_add_u32 s12, s20, 0x3800000
  s_addc_u32 s13, s21, 0
  s_mov_b32 s14, 0xc0000
  s_mov_b32 s15, 0x20000
  buffer_load_dwordx4 v[8:11], v2, s[8:11], s24 offen nt
  s_add_u32 s24, s24, 49152
  buffer_load_dwordx4 v[12:15], v4, s[8:11], s24 offen nt
  s_add_u32 s24, s24, 49152
  buffer_load_dwordx4 v[16:19], v2, s[8:11], s24 offen nt
  s_add_u32 s24, s24, 49152
  buffer_load_dwordx4 v[20:23], v4, s[8:11], s24 offen nt
  s_add_u32 s24, s24, 49152
  buffer_load_dwordx4 v[24:27], v2, s[8:11], s24 offen nt
  s_add_u32 s24, s24, 49152
  buffer_load_dwordx4 v[28:31], v4, s[8:11], s24 offen nt
  s_add_u32 s24, s24, 49152
  buffer_load_dwordx4 v[32:35], v2, s[8:11], s24 offen nt
  s_add_u32 s24, s24, 49152
  buffer_load_dwordx4 v[36:39], v4, s[8:11], s24 offen nt
  s_add_u32 s24, s24, 49152
  s_add_u32 s26, s25, 4096
  s_waitcnt vmcnt(0)
  buffer_store_dwordx4 v[8:11], v3, s[12:15], s25 offen offset:0 sc0 sc1
  buffer_store_dwordx4 v[12:15], v3, s[12:15], s25 offen offset:1024 sc0 sc1
  buffer_store_dwordx4 v[16:19], v3, s[12:15], s25 offen offset:2048 sc0 sc1
  buffer_store_dwordx4 v[20:23], v3, s[12:15], s25 offen offset:3072 sc0 sc1
  buffer_store_dwordx4 v[24:27], v3, s[12:15], s26 offen offset:0 sc0 sc1
  buffer_store_dwordx4 v[28:31], v3, s[12:15], s26 offen offset:1024 sc0 sc1
  buffer_store_dwordx4 v[32:35], v3, s[12:15], s26 offen offset:2048 sc0 sc1
  buffer_store_dwordx4 v[36:39], v3, s[12:15], s26 offen offset:3072 sc0 sc1
  s_endpgm
.Lmod_kernel_rtw_7:
  s_load_dwordx2 s[4:5], s[0:1], 16
  s_load_dwordx2 s[20:21], s[0:1], 80
  s_bfe_u32 s22, s2, 0x10002
  s_lshl_b32 s22, s22, 10
  s_and_b32 s23, s2, 3
  s_lshl_b32 s23, s23, 19
  s_add_u32 s24, s22, s23
  s_add_u32 s24, s24, 384
  s_lshl_b32 s25, s2, 15
  v_lshrrev_b32 v1, 6, v0
  v_bfe_u32 v2, v0, 3, 3
  v_lshl_add_u32 v2, v1, 6, v2
  v_lshlrev_b32 v2, 11, v2
  v_and_b32 v3, 7, v0
  v_bfe_u32 v4, v0, 4, 1
  v_lshlrev_b32 v4, 2, v4
  v_xor_b32 v3, v3, v4
  v_lshl_add_u32 v2, v3, 4, v2
  v_and_b32 v3, 63, v0
  v_lshlrev_b32 v3, 4, v3
  v_lshl_add_u32 v3, v1, 13, v3
  s_waitcnt lgkmcnt(0)
  s_mov_b32 s8, s4
  s_mov_b32 s9, s5
  s_mov_b32 s10, 0x200000
  s_mov_b32 s11, 0x20000
  s_add_u32 s12, s20, 0x3800000
  s_addc_u32 s13, s21, 0
  s_mov_b32 s14, 0x100000
  s_mov_b32 s15, 0x20000
  buffer_load_dwordx4 v[8:11], v2, s[8:11], s24 offen nt
  s_add_u32 s24, s24, 16384
  buffer_load_dwordx4 v[12:15], v2, s[8:11], s24 offen nt
  s_add_u32 s24, s24, 16384
  buffer_load_dwordx4 v[16:19], v2, s[8:11], s24 offen nt
  s_add_u32 s24, s24, 16384
  buffer_load_dwordx4 v[20:23], v2, s[8:11], s24 offen nt
  s_add_u32 s24, s24, 16384
  buffer_load_dwordx4 v[24:27], v2, s[8:11], s24 offen nt
  s_add_u32 s24, s24, 16384
  buffer_load_dwordx4 v[28:31], v2, s[8:11], s24 offen nt
  s_add_u32 s24, s24, 16384
  buffer_load_dwordx4 v[32:35], v2, s[8:11], s24 offen nt
  s_add_u32 s24, s24, 16384
  buffer_load_dwordx4 v[36:39], v2, s[8:11], s24 offen nt
  s_add_u32 s24, s24, 16384
  s_add_u32 s26, s25, 4096
  s_waitcnt vmcnt(0)
  buffer_store_dwordx4 v[8:11], v3, s[12:15], s25 offen offset:0 sc0 sc1
  buffer_store_dwordx4 v[12:15], v3, s[12:15], s25 offen offset:1024 sc0 sc1
  buffer_store_dwordx4 v[16:19], v3, s[12:15], s25 offen offset:2048 sc0 sc1
  buffer_store_dwordx4 v[20:23], v3, s[12:15], s25 offen offset:3072 sc0 sc1
  buffer_store_dwordx4 v[24:27], v3, s[12:15], s26 offen offset:0 sc0 sc1
  buffer_store_dwordx4 v[28:31], v3, s[12:15], s26 offen offset:1024 sc0 sc1
  buffer_store_dwordx4 v[32:35], v3, s[12:15], s26 offen offset:2048 sc0 sc1
  buffer_store_dwordx4 v[36:39], v3, s[12:15], s26 offen offset:3072 sc0 sc1
.Lmod_kernel_end_1:
  s_endpgm
.globl attn_kernel
.p2align 8
.type attn_kernel,@function
attn_kernel:
  s_cmp_ge_u32 s2, 256
  s_cbranch_scc1 .Lattn_kernel_end_3
  s_load_dwordx2 s[6:7], s[0:1], 80
  s_load_dwordx2 s[4:5], s[0:1], 8
  s_load_dwordx2 s[36:37], s[0:1], 0
  v_lshrrev_b32 v1, 6, v0
  v_and_b32 v0, 63, v0
  v_readfirstlane_b32 s24, v1
  v_lshlrev_b32 v1, 4, v0
  v_lshrrev_b32 v7, 5, v0
  v_and_b32 v9, 31, v0
  s_cmp_lt_u32 s24, 4
  s_cbranch_scc1 .Lattn_kernel_qcomp_4
  s_and_b32 s20, s2, 7
  s_lshr_b32 s21, s2, 3
  s_and_b32 s22, s20, 1
  s_lshr_b32 s23, s20, 1
  s_and_b32 s20, s21, 7
  s_lshr_b32 s21, s21, 3
  s_mul_i32 s22, s22, 8
  s_add_u32 s22, s22, s20
  s_mul_i32 s23, s23, 4
  s_add_u32 s23, s23, s21
  s_sub_u32 s25, s24, 4
  s_lshl_b32 s26, s25, 12
  v_add_u32 v2, s26, v1
  s_mul_i32 s28, s22, 262144
  s_mov_b32 s29, 0
  v_lshrrev_b32 v4, 3, v0
  v_and_b32 v3, 7, v0
  v_bfe_u32 v5, v0, 4, 1
  v_lshlrev_b32 v5, 1, v5
  v_xor_b32 v3, v3, v5
  s_lshl_b32 s26, s25, 4
  v_add_u32 v4, s26, v4
  v_mul_u32_u24 v4, 6144, v4
  v_lshl_add_u32 v4, v3, 4, v4
  s_mul_i32 s26, s23, 128
  v_add_u32 v4, s26, v4
  v_add_u32 v104, 0, v4
  v_add_u32 v105, 48128, v4
  v_xor_b32 v105, 64, v105
  v_add_u32 v106, 2048, v4
  v_add_u32 v107, 50176, v4
  v_xor_b32 v107, 64, v107
  v_add_u32 v108, 4096, v4
  v_add_u32 v109, 52224, v4
  v_xor_b32 v109, 64, v109
  s_mov_b32 s54, 393216
  s_mov_b32 s53, 21626880
  s_and_b32 s26, s23, 7
  s_cmp_lg_u32 s26, 3
  s_cbranch_scc1 .Lattn_kernel_untiled_6
  s_mov_b32 s54, 8192
  s_mov_b32 s53, 450560
  s_lshr_b32 s26, s23, 3
  s_mul_i32 s29, s26, 393216
  s_lshl_b32 s26, s25, 11
  v_add_u32 v4, s26, v1
  v_add_u32 v104, 0, v4
  v_add_u32 v105, 0, v4
  v_add_u32 v106, 131072, v4
  v_add_u32 v107, 131072, v4
  v_add_u32 v108, 262144, v4
  v_add_u32 v109, 262144, v4
.Lattn_kernel_untiled_6:
  s_lshl_b32 s31, s25, 12
  s_lshl_b32 s32, s25, 11
  s_add_u32 s32, s32, 16384
  s_mov_b32 s30, 0
  s_mov_b32 s34, 0
  s_mov_b32 s35, 0
  v_lshlrev_b32 v12, 2, v0
  s_waitcnt lgkmcnt(0)
  s_add_u32 s8, s6, 0x2b00000
  s_addc_u32 s9, s7, 0
  s_mov_b32 s10, 0x400000
  s_mov_b32 s11, 0x20000
  s_mov_b32 s12, s4
  s_mov_b32 s13, s5
  s_mov_b32 s14, 0x600000
  s_mov_b32 s15, 0x20000
  s_add_u32 s26, s6, 0x3800000
  s_addc_u32 s27, s7, 0
  s_cmp_eq_u32 s54, 8192
  s_cselect_b32 s12, s26, s12
  s_cselect_b32 s13, s27, s13
  s_cselect_b32 s14, 1048576, s14
  s_add_u32 s16, s6, 0x0
  s_addc_u32 s17, s7, 0
  s_mov_b32 s18, 0x100000
  s_mov_b32 s19, 0x20000
  s_sub_u32 s50, s24, 4
  s_lshl_b32 s50, s50, 6
  v_add_u32 v128, s50, v0
  s_lshl_b32 s52, s22, 2
  s_lshr_b32 s53, s23, 2
  s_add_u32 s52, s52, s53
  s_and_b32 s53, s23, 3
  v_lshrrev_b32 v129, 3, v128
  v_and_b32 v134, 7, v128
  v_lshlrev_b32 v133, 4, v134
  v_lshl_add_u32 v133, v129, 11, v133
  s_lshl_b32 s48, s52, 16
  s_lshl_b32 s50, s53, 9
  s_add_u32 s48, s48, s50
  v_lshlrev_b32 v132, 6, v134
  v_add_u32 v132, 122880, v132
  v_bfe_u32 v135, v128, 4, 3
  v_xor_b32 v134, v134, v135
  v_lshlrev_b32 v134, 4, v134
  v_lshl_add_u32 v134, v129, 7, v134
  v_and_b32 v130, 127, v128
  v_lshlrev_b32 v130, 3, v130
  v_lshrrev_b32 v135, 7, v128
  v_xor_b32 v131, 1, v135
  v_lshl_add_u32 v130, v131, 12, v130
  s_lshl_b32 s51, s53, 10
  v_lshlrev_b32 v129, 3, v129
  s_lshl_b32 s49, s52, 8
  s_add_u32 s49, s49, 163840
  s_mov_b32 s44, s36
  s_mov_b32 s45, s37
  s_mov_b32 s46, 0x400000
  s_mov_b32 s47, 0x20000
  buffer_load_dwordx2 v[184:185], v130, s[16:19], s51 offen
  s_add_u32 s51, s51, 24576
  buffer_load_dwordx2 v[186:187], v130, s[16:19], s51 offen
  s_add_u32 s51, s51, 24576
  buffer_load_dwordx2 v[188:189], v130, s[16:19], s51 offen
  s_add_u32 s51, s51, 24576
  buffer_load_dwordx2 v[190:191], v130, s[16:19], s51 offen
  s_add_u32 s51, s51, 24576
  buffer_load_dwordx2 v[254:255], v129, s[16:19], s49 offen
  buffer_load_dwordx4 v[136:139], v133, s[44:47], s48 offen offset:0
  buffer_load_dwordx4 v[140:143], v133, s[44:47], s48 offen offset:128
  buffer_load_dwordx4 v[144:147], v133, s[44:47], s48 offen offset:256
  buffer_load_dwordx4 v[148:151], v133, s[44:47], s48 offen offset:384
  s_mul_i32 s26, s54, 0
  s_add_u32 s26, s26, s29
  s_add_u32 s33, 0, s32
  s_add_u32 m0, s33, 0
  s_nop 0
  buffer_load_dwordx4 v104, s[12:15], s26 offen offset:0 lds
  buffer_load_dwordx4 v105, s[12:15], s26 offen offset:1024 lds
  s_add_u32 m0, s33, 8192
  s_nop 0
  buffer_load_dwordx4 v106, s[12:15], s26 offen offset:0 lds
  buffer_load_dwordx4 v107, s[12:15], s26 offen offset:1024 lds
  s_add_u32 m0, s33, 16384
  s_nop 0
  buffer_load_dwordx4 v108, s[12:15], s26 offen offset:0 lds
  buffer_load_dwordx4 v109, s[12:15], s26 offen offset:1024 lds
  s_add_u32 s56, s6, 0x2b00000
  s_addc_u32 s57, s7, 0
  s_mov_b32 s58, 0x400000
  s_mov_b32 s59, 0x20000
  s_lshl_b32 s40, s22, 18
  s_lshl_b32 s50, s53, 16
  s_add_u32 s40, s40, s50
  s_and_b32 s50, s52, 3
  s_lshl_b32 s50, s50, 12
  s_add_u32 s40, s40, s50
  s_add_u32 s41, s40, 16384
  s_add_u32 s42, s40, 32768
  s_add_u32 s43, s40, 49152
  v_bfe_u32 v228, v128, 2, 5
  v_lshlrev_b32 v228, 6, v228
  v_lshl_add_u32 v228, v135, 5, v228
  v_and_b32 v229, 3, v128
  v_lshl_add_u32 v228, v229, 3, v228
  v_add_u32 v228, 122880, v228
  v_cvt_f32_u32 v131, v131
  v_mov_b32 v229, 127040
  v_mov_b32 v230, 0
  ds_write_b32 v229, v230
  ds_write_b32 v229, v230 offset:64
  ds_write_b32 v229, v230 offset:4160
  ds_write_b32 v229, v230 offset:8256
  s_waitcnt vmcnt(11)
  v_add_f32 v184, v184, v186
  v_add_f32 v188, v188, v190
  v_add_f32 v185, v185, v187
  v_add_f32 v189, v189, v191
  v_add_f32 v184, v184, v188
  v_add_f32 v185, v185, v189
  v_cvt_pk_bf16_f32 v184, v184, v184
  v_and_b32 v184, 0xffff0000, v184
  v_cvt_pk_bf16_f32 v185, v185, v185
  v_and_b32 v185, 0xffff0000, v185
  v_add_f32 v184, v131, v184
  v_add_f32 v185, v131, v185
  v_cvt_pk_bf16_f32 v184, v184, v184
  v_and_b32 v184, 0xffff0000, v184
  v_cvt_pk_bf16_f32 v185, v185, v185
  v_and_b32 v185, 0xffff0000, v185
  ds_write_b64 v228, v[184:185]
  s_waitcnt lgkmcnt(0)
  s_barrier
  ds_read_b128 v[192:195], v132 offset:0
  ds_read_b128 v[196:199], v132 offset:16
  ds_read_b128 v[200:203], v132 offset:32
  ds_read_b128 v[204:207], v132 offset:48
  ds_read_b128 v[208:211], v132 offset:512
  ds_read_b128 v[212:215], v132 offset:528
  ds_read_b128 v[216:219], v132 offset:544
  ds_read_b128 v[220:223], v132 offset:560
  ds_read_b128 v[224:227], v132 offset:1024
  ds_read_b128 v[228:231], v132 offset:1040
  ds_read_b128 v[232:235], v132 offset:1056
  ds_read_b128 v[236:239], v132 offset:1072
  s_waitcnt vmcnt(9)
  v_lshlrev_b32 v152, 16, v136
  v_and_b32 v153, 0xffff0000, v136
  v_lshlrev_b32 v154, 16, v137
  v_and_b32 v155, 0xffff0000, v137
  v_lshlrev_b32 v156, 16, v138
  v_and_b32 v157, 0xffff0000, v138
  v_lshlrev_b32 v158, 16, v139
  v_and_b32 v159, 0xffff0000, v139
  v_pk_fma_f32 v[152:153], v[152:153], v[254:255], v[254:255] op_sel:[0,0,1] op_sel_hi:[1,0,1]
  v_pk_fma_f32 v[154:155], v[154:155], v[254:255], v[254:255] op_sel:[0,0,1] op_sel_hi:[1,0,1]
  v_pk_fma_f32 v[156:157], v[156:157], v[254:255], v[254:255] op_sel:[0,0,1] op_sel_hi:[1,0,1]
  v_pk_fma_f32 v[158:159], v[158:159], v[254:255], v[254:255] op_sel:[0,0,1] op_sel_hi:[1,0,1]
  s_waitcnt vmcnt(8)
  v_lshlrev_b32 v160, 16, v140
  v_and_b32 v161, 0xffff0000, v140
  v_lshlrev_b32 v162, 16, v141
  v_and_b32 v163, 0xffff0000, v141
  v_lshlrev_b32 v164, 16, v142
  v_and_b32 v165, 0xffff0000, v142
  v_lshlrev_b32 v166, 16, v143
  v_and_b32 v167, 0xffff0000, v143
  v_pk_fma_f32 v[160:161], v[160:161], v[254:255], v[254:255] op_sel:[0,0,1] op_sel_hi:[1,0,1]
  v_pk_fma_f32 v[162:163], v[162:163], v[254:255], v[254:255] op_sel:[0,0,1] op_sel_hi:[1,0,1]
  v_pk_fma_f32 v[164:165], v[164:165], v[254:255], v[254:255] op_sel:[0,0,1] op_sel_hi:[1,0,1]
  v_pk_fma_f32 v[166:167], v[166:167], v[254:255], v[254:255] op_sel:[0,0,1] op_sel_hi:[1,0,1]
  s_waitcnt vmcnt(7)
  v_lshlrev_b32 v168, 16, v144
  v_and_b32 v169, 0xffff0000, v144
  v_lshlrev_b32 v170, 16, v145
  v_and_b32 v171, 0xffff0000, v145
  v_lshlrev_b32 v172, 16, v146
  v_and_b32 v173, 0xffff0000, v146
  v_lshlrev_b32 v174, 16, v147
  v_and_b32 v175, 0xffff0000, v147
  v_pk_fma_f32 v[168:169], v[168:169], v[254:255], v[254:255] op_sel:[0,0,1] op_sel_hi:[1,0,1]
  v_pk_fma_f32 v[170:171], v[170:171], v[254:255], v[254:255] op_sel:[0,0,1] op_sel_hi:[1,0,1]
  v_pk_fma_f32 v[172:173], v[172:173], v[254:255], v[254:255] op_sel:[0,0,1] op_sel_hi:[1,0,1]
  v_pk_fma_f32 v[174:175], v[174:175], v[254:255], v[254:255] op_sel:[0,0,1] op_sel_hi:[1,0,1]
  s_waitcnt vmcnt(6)
  v_lshlrev_b32 v176, 16, v148
  v_and_b32 v177, 0xffff0000, v148
  v_lshlrev_b32 v178, 16, v149
  v_and_b32 v179, 0xffff0000, v149
  v_lshlrev_b32 v180, 16, v150
  v_and_b32 v181, 0xffff0000, v150
  v_lshlrev_b32 v182, 16, v151
  v_and_b32 v183, 0xffff0000, v151
  v_pk_fma_f32 v[176:177], v[176:177], v[254:255], v[254:255] op_sel:[0,0,1] op_sel_hi:[1,0,1]
  v_pk_fma_f32 v[178:179], v[178:179], v[254:255], v[254:255] op_sel:[0,0,1] op_sel_hi:[1,0,1]
  v_pk_fma_f32 v[180:181], v[180:181], v[254:255], v[254:255] op_sel:[0,0,1] op_sel_hi:[1,0,1]
  v_pk_fma_f32 v[182:183], v[182:183], v[254:255], v[254:255] op_sel:[0,0,1] op_sel_hi:[1,0,1]
  s_waitcnt lgkmcnt(8)
  v_pk_fma_f32 v[152:153], v[152:153], v[192:193], v[200:201]
  v_pk_fma_f32 v[154:155], v[154:155], v[194:195], v[202:203]
  v_pk_fma_f32 v[156:157], v[156:157], v[196:197], v[204:205]
  v_pk_fma_f32 v[158:159], v[158:159], v[198:199], v[206:207]
  ds_read_b128 v[192:195], v132 offset:1536
  ds_read_b128 v[196:199], v132 offset:1552
  ds_read_b128 v[200:203], v132 offset:1568
  ds_read_b128 v[204:207], v132 offset:1584
  v_cvt_pk_bf16_f32 v136, v152, v153
  v_cvt_pk_bf16_f32 v137, v154, v155
  v_cvt_pk_bf16_f32 v138, v156, v157
  v_cvt_pk_bf16_f32 v139, v158, v159
  s_waitcnt vmcnt(0)
  buffer_store_dwordx4 v[136:139], v134, s[56:59], s40 offen sc0 sc1
  s_waitcnt lgkmcnt(8)
  v_pk_fma_f32 v[160:161], v[160:161], v[208:209], v[216:217]
  v_pk_fma_f32 v[162:163], v[162:163], v[210:211], v[218:219]
  v_pk_fma_f32 v[164:165], v[164:165], v[212:213], v[220:221]
  v_pk_fma_f32 v[166:167], v[166:167], v[214:215], v[222:223]
  v_cvt_pk_bf16_f32 v140, v160, v161
  v_cvt_pk_bf16_f32 v141, v162, v163
  v_cvt_pk_bf16_f32 v142, v164, v165
  v_cvt_pk_bf16_f32 v143, v166, v167
  buffer_store_dwordx4 v[140:143], v134, s[56:59], s41 offen sc0 sc1
  s_waitcnt lgkmcnt(4)
  v_pk_fma_f32 v[168:169], v[168:169], v[224:225], v[232:233]
  v_pk_fma_f32 v[170:171], v[170:171], v[226:227], v[234:235]
  v_pk_fma_f32 v[172:173], v[172:173], v[228:229], v[236:237]
  v_pk_fma_f32 v[174:175], v[174:175], v[230:231], v[238:239]
  v_cvt_pk_bf16_f32 v144, v168, v169
  v_cvt_pk_bf16_f32 v145, v170, v171
  v_cvt_pk_bf16_f32 v146, v172, v173
  v_cvt_pk_bf16_f32 v147, v174, v175
  buffer_store_dwordx4 v[144:147], v134, s[56:59], s42 offen sc0 sc1
  s_waitcnt lgkmcnt(0)
  v_pk_fma_f32 v[176:177], v[176:177], v[192:193], v[200:201]
  v_pk_fma_f32 v[178:179], v[178:179], v[194:195], v[202:203]
  v_pk_fma_f32 v[180:181], v[180:181], v[196:197], v[204:205]
  v_pk_fma_f32 v[182:183], v[182:183], v[198:199], v[206:207]
  v_cvt_pk_bf16_f32 v148, v176, v177
  v_cvt_pk_bf16_f32 v149, v178, v179
  v_cvt_pk_bf16_f32 v150, v180, v181
  v_cvt_pk_bf16_f32 v151, v182, v183
  buffer_store_dwordx4 v[148:151], v134, s[56:59], s43 offen sc0 sc1
  s_waitcnt vmcnt(0)
  s_mov_b32 s48, s29
  s_mov_b32 s49, s30
  v_mov_b32 v228, 127040
  v_mov_b32 v229, 1
  s_mov_b64 exec, 1
  ds_add_rtn_u32 v230, v228, v229
  s_mov_b64 exec, -1
  s_lshl_b32 s29, s22, 8
  s_add_u32 s29, s29, 671744
  s_waitcnt lgkmcnt(0)
  v_readfirstlane_b32 s30, v230
  s_nop 3
  s_cmp_lg_u32 s30, 3
  s_cbranch_scc1 .Lattn_kernel_nolast_7
  v_mov_b32 v228, 0
  v_mov_b32 v229, 1
  s_mov_b64 exec, 1
  buffer_atomic_add v229, v228, s[16:19], s29 offen sc1
  s_mov_b64 exec, -1
.Lattn_kernel_nolast_7:
  s_mov_b32 s29, s48
  s_mov_b32 s30, s49
  s_lshl_b32 s38, s22, 8
  s_add_u32 s38, s38, 671744
  s_mul_i32 s26, s54, 1
  s_add_u32 s26, s26, s29
  s_add_u32 s33, 40960, s32
  s_add_u32 m0, s33, 0
  s_nop 0
  buffer_load_dwordx4 v104, s[12:15], s26 offen offset:0 lds
  buffer_load_dwordx4 v105, s[12:15], s26 offen offset:1024 lds
  s_add_u32 m0, s33, 8192
  s_nop 0
  buffer_load_dwordx4 v106, s[12:15], s26 offen offset:0 lds
  buffer_load_dwordx4 v107, s[12:15], s26 offen offset:1024 lds
  s_add_u32 m0, s33, 16384
  s_nop 0
  buffer_load_dwordx4 v108, s[12:15], s26 offen offset:0 lds
  buffer_load_dwordx4 v109, s[12:15], s26 offen offset:1024 lds
  s_barrier
  s_mul_i32 s26, s54, 2
  s_add_u32 s26, s26, s29
  s_add_u32 s33, 81920, s32
  s_add_u32 m0, s33, 0
  s_nop 0
  buffer_load_dwordx4 v104, s[12:15], s26 offen offset:0 lds
  buffer_load_dwordx4 v105, s[12:15], s26 offen offset:1024 lds
  s_add_u32 m0, s33, 8192
  s_nop 0
  buffer_load_dwordx4 v106, s[12:15], s26 offen offset:0 lds
  buffer_load_dwordx4 v107, s[12:15], s26 offen offset:1024 lds
  s_add_u32 m0, s33, 16384
  s_nop 0
  buffer_load_dwordx4 v108, s[12:15], s26 offen offset:0 lds
  buffer_load_dwordx4 v109, s[12:15], s26 offen offset:1024 lds
  s_waitcnt vmcnt(6)
  s_barrier
  s_cmp_lg_u32 s25, 0
  s_cbranch_scc1 .Lattn_kernel_nold_8
  v_mov_b32 v30, 0
  v_mov_b32 v31, 0
  s_mov_b64 exec, 1
  buffer_atomic_add v30, v31, s[16:19], s38 offen sc0 sc1
  s_mov_b64 exec, -1
.Lattn_kernel_nold_8:
  s_mul_i32 s26, s54, 3
  s_add_u32 s26, s26, s29
  s_add_u32 s33, 122880, s32
  s_add_u32 m0, s33, 0
  s_nop 0
  buffer_load_dwordx4 v104, s[12:15], s26 offen offset:0 lds
  buffer_load_dwordx4 v105, s[12:15], s26 offen offset:1024 lds
  s_add_u32 m0, s33, 8192
  s_nop 0
  buffer_load_dwordx4 v106, s[12:15], s26 offen offset:0 lds
  buffer_load_dwordx4 v107, s[12:15], s26 offen offset:1024 lds
  s_add_u32 m0, s33, 16384
  s_nop 0
  buffer_load_dwordx4 v108, s[12:15], s26 offen offset:0 lds
  buffer_load_dwordx4 v109, s[12:15], s26 offen offset:1024 lds
  s_waitcnt vmcnt(6)
  s_cmp_lg_u32 s25, 0
  s_cbranch_scc1 .Lattn_kernel_others_9
  s_mov_b32 s39, 0
  s_branch .Lattn_kernel_chk_12
.Lattn_kernel_spin_11:
  v_mov_b32 v30, 0
  v_mov_b32 v31, 0
  s_mov_b64 exec, 1
  buffer_atomic_add v30, v31, s[16:19], s38 offen sc0 sc1
  s_mov_b64 exec, -1
  s_waitcnt vmcnt(0)
.Lattn_kernel_chk_12:
  v_cmp_gt_u32 vcc, 16, v30
  s_add_u32 s39, s39, 1
  s_and_b32 s61, vcc_lo, 1
  s_cbranch_scc0 .Lattn_kernel_go_13
  s_sleep 1
  s_cmp_lt_u32 s39, 131072
  s_cbranch_scc1 .Lattn_kernel_spin_11
.Lattn_kernel_go_13:
  v_mov_b32 v13, 127104
  v_mov_b32 v14, 1
  ds_write_b32 v13, v14 offset:0
  ds_write_b32 v13, v14 offset:4096
  ds_write_b32 v13, v14 offset:8192
  s_branch .Lattn_kernel_lgo_10
.Lattn_kernel_others_9:
  s_add_u32 s26, s31, 123008
  v_mov_b32 v13, s26
.Lattn_kernel_lspin_14:
  s_sleep 1
  ds_read_b32 v14, v13
  s_waitcnt lgkmcnt(0)
  v_readfirstlane_b32 s26, v14
  s_nop 3
  s_cmp_eq_u32 s26, 0
  s_cbranch_scc1 .Lattn_kernel_lspin_14
.Lattn_kernel_lgo_10:
  s_add_u32 s28, s28, 16384
  s_add_u32 s29, s29, s54
  s_add_u32 s30, s30, 40960
  s_cmp_eq_u32 s30, 163840
  s_cselect_b32 s30, 0, s30
  s_add_u32 s34, s34, 1
  s_add_u32 s28, s28, 16384
  s_add_u32 s29, s29, s54
  s_add_u32 s30, s30, 40960
  s_cmp_eq_u32 s30, 163840
  s_cselect_b32 s30, 0, s30
  s_add_u32 s34, s34, 1
  s_add_u32 s28, s28, 16384
  s_add_u32 s29, s29, s54
  s_add_u32 s30, s30, 40960
  s_cmp_eq_u32 s30, 163840
  s_cselect_b32 s30, 0, s30
  s_add_u32 s34, s34, 1
  s_add_u32 m0, s30, s31
  s_nop 0
  buffer_load_dwordx4 v2, s[8:11], s28 offen offset:0 sc1 lds
  buffer_load_dwordx4 v2, s[8:11], s28 offen offset:1024 sc1 lds
  buffer_load_dwordx4 v2, s[8:11], s28 offen offset:2048 sc1 lds
  buffer_load_dwordx4 v2, s[8:11], s28 offen offset:3072 sc1 lds
  s_add_u32 s28, s28, 16384
  s_add_u32 s29, s29, s54
  s_add_u32 s30, s30, 40960
  s_cmp_eq_u32 s30, 163840
  s_cselect_b32 s30, 0, s30
  s_add_u32 s34, s34, 1
  s_barrier
  s_add_u32 m0, s30, s31
  s_nop 0
  buffer_load_dwordx4 v2, s[8:11], s28 offen offset:0 sc1 lds
  buffer_load_dwordx4 v2, s[8:11], s28 offen offset:1024 sc1 lds
  buffer_load_dwordx4 v2, s[8:11], s28 offen offset:2048 sc1 lds
  buffer_load_dwordx4 v2, s[8:11], s28 offen offset:3072 sc1 lds
  s_add_u32 s33, s30, s32
  s_add_u32 m0, s33, 0
  s_nop 0
  buffer_load_dwordx4 v104, s[12:15], s29 offen offset:0 lds
  buffer_load_dwordx4 v105, s[12:15], s29 offen offset:1024 lds
  s_add_u32 m0, s33, 8192
  s_nop 0
  buffer_load_dwordx4 v106, s[12:15], s29 offen offset:0 lds
  buffer_load_dwordx4 v107, s[12:15], s29 offen offset:1024 lds
  s_add_u32 m0, s33, 16384
  s_nop 0
  buffer_load_dwordx4 v108, s[12:15], s29 offen offset:0 lds
  buffer_load_dwordx4 v109, s[12:15], s29 offen offset:1024 lds
  s_add_u32 s28, s28, 16384
  s_add_u32 s29, s29, s54
  s_add_u32 s30, s30, 40960
  s_cmp_eq_u32 s30, 163840
  s_cselect_b32 s30, 0, s30
  s_add_u32 s34, s34, 1
  s_waitcnt vmcnt(10)
  s_barrier
  s_add_u32 m0, s30, s31
  s_nop 0
  buffer_load_dwordx4 v2, s[8:11], s28 offen offset:0 sc1 lds
  buffer_load_dwordx4 v2, s[8:11], s28 offen offset:1024 sc1 lds
  buffer_load_dwordx4 v2, s[8:11], s28 offen offset:2048 sc1 lds
  buffer_load_dwordx4 v2, s[8:11], s28 offen offset:3072 sc1 lds
  s_add_u32 s33, s30, s32
  s_add_u32 m0, s33, 0
  s_nop 0
  buffer_load_dwordx4 v104, s[12:15], s29 offen offset:0 lds
  buffer_load_dwordx4 v105, s[12:15], s29 offen offset:1024 lds
  s_add_u32 m0, s33, 8192
  s_nop 0
  buffer_load_dwordx4 v106, s[12:15], s29 offen offset:0 lds
  buffer_load_dwordx4 v107, s[12:15], s29 offen offset:1024 lds
  s_add_u32 m0, s33, 16384
  s_nop 0
  buffer_load_dwordx4 v108, s[12:15], s29 offen offset:0 lds
  buffer_load_dwordx4 v109, s[12:15], s29 offen offset:1024 lds
  s_add_u32 s28, s28, 16384
  s_add_u32 s29, s29, s54
  s_add_u32 s30, s30, 40960
  s_cmp_eq_u32 s30, 163840
  s_cselect_b32 s30, 0, s30
  s_add_u32 s34, s34, 1
  s_add_u32 m0, s30, s31
  s_nop 0
  buffer_load_dwordx4 v2, s[8:11], s28 offen offset:0 sc1 lds
  buffer_load_dwordx4 v2, s[8:11], s28 offen offset:1024 sc1 lds
  buffer_load_dwordx4 v2, s[8:11], s28 offen offset:2048 sc1 lds
  buffer_load_dwordx4 v2, s[8:11], s28 offen offset:3072 sc1 lds
  s_add_u32 s33, s30, s32
  s_add_u32 m0, s33, 0
  s_nop 0
  buffer_load_dwordx4 v104, s[12:15], s29 offen offset:0 lds
  buffer_load_dwordx4 v105, s[12:15], s29 offen offset:1024 lds
  s_add_u32 m0, s33, 8192
  s_nop 0
  buffer_load_dwordx4 v106, s[12:15], s29 offen offset:0 lds
  buffer_load_dwordx4 v107, s[12:15], s29 offen offset:1024 lds
  s_add_u32 m0, s33, 16384
  s_nop 0
  buffer_load_dwordx4 v108, s[12:15], s29 offen offset:0 lds
  buffer_load_dwordx4 v109, s[12:15], s29 offen offset:1024 lds
  s_add_u32 s28, s28, 16384
  s_add_u32 s29, s29, s54
  s_add_u32 s30, s30, 40960
  s_cmp_eq_u32 s30, 163840
  s_cselect_b32 s30, 0, s30
  s_add_u32 s34, s34, 1
.Lattn_kernel_lmain_15:
  s_waitcnt vmcnt(20)
  s_barrier
  s_add_u32 m0, s30, s31
  s_nop 0
  buffer_load_dwordx4 v2, s[8:11], s28 offen offset:0 sc1 lds
  buffer_load_dwordx4 v2, s[8:11], s28 offen offset:1024 sc1 lds
  buffer_load_dwordx4 v2, s[8:11], s28 offen offset:2048 sc1 lds
  buffer_load_dwordx4 v2, s[8:11], s28 offen offset:3072 sc1 lds
  s_add_u32 s33, s30, s32
  s_add_u32 m0, s33, 0
  s_nop 0
  buffer_load_dwordx4 v104, s[12:15], s29 offen offset:0 lds
  buffer_load_dwordx4 v105, s[12:15], s29 offen offset:1024 lds
  s_add_u32 m0, s33, 8192
  s_nop 0
  buffer_load_dwordx4 v106, s[12:15], s29 offen offset:0 lds
  buffer_load_dwordx4 v107, s[12:15], s29 offen offset:1024 lds
  s_add_u32 m0, s33, 16384
  s_nop 0
  buffer_load_dwordx4 v108, s[12:15], s29 offen offset:0 lds
  buffer_load_dwordx4 v109, s[12:15], s29 offen offset:1024 lds
  s_add_u32 s28, s28, 16384
  s_add_u32 s29, s29, s54
  s_add_u32 s30, s30, 40960
  s_cmp_eq_u32 s30, 163840
  s_cselect_b32 s30, 0, s30
  s_add_u32 s34, s34, 1
  s_cmp_lt_u32 s34, 16
  s_cbranch_scc1 .Lattn_kernel_lmain_15
  s_waitcnt vmcnt(20)
  s_barrier
  s_waitcnt vmcnt(10)
  s_barrier
  s_waitcnt vmcnt(0)
  v_mov_b32 v13, 32832
  v_mov_b32 v14, 0
  ds_write_b32 v13, v14
  s_waitcnt lgkmcnt(0)
  s_barrier
  s_branch .Lattn_kernel_helper_5
.Lattn_kernel_qcomp_4:
  s_and_b32 s20, s2, 7
  s_lshr_b32 s21, s2, 3
  s_and_b32 s22, s20, 1
  s_lshr_b32 s23, s20, 1
  s_and_b32 s20, s21, 7
  s_lshr_b32 s21, s21, 3
  s_mul_i32 s22, s22, 8
  s_add_u32 s22, s22, s20
  s_mul_i32 s23, s23, 4
  s_add_u32 s23, s23, s21
  s_lshl_b32 s50, s24, 6
  v_add_u32 v240, s50, v0
  v_lshrrev_b32 v241, 3, v0
  v_and_b32 v242, 7, v0
  v_lshlrev_b32 v243, 4, v242
  v_lshl_add_u32 v243, v241, 11, v243
  s_lshl_b32 s44, s22, 18
  s_lshl_b32 s50, s24, 16
  s_add_u32 s44, s44, s50
  v_and_b32 v244, 127, v240
  v_lshlrev_b32 v244, 3, v244
  v_lshrrev_b32 v245, 7, v240
  v_xor_b32 v246, 1, v245
  v_lshl_add_u32 v244, v246, 12, v244
  v_lshlrev_b32 v247, 3, v241
  s_lshr_b32 s49, s44, 8
  s_add_u32 s49, s49, 163840
  s_mov_b32 s51, 0
  s_waitcnt lgkmcnt(0)
  s_add_u32 s16, s6, 0x0
  s_addc_u32 s17, s7, 0
  s_mov_b32 s18, 0x100000
  s_mov_b32 s19, 0x20000
  s_mov_b32 s8, s36
  s_mov_b32 s9, s37
  s_mov_b32 s10, 0x400000
  s_mov_b32 s11, 0x20000
  buffer_load_dwordx2 v[224:225], v244, s[16:19], s51 offen
  s_add_u32 s51, s51, 24576
  buffer_load_dwordx2 v[226:227], v244, s[16:19], s51 offen
  s_add_u32 s51, s51, 24576
  buffer_load_dwordx2 v[228:229], v244, s[16:19], s51 offen
  s_add_u32 s51, s51, 24576
  buffer_load_dwordx2 v[230:231], v244, s[16:19], s51 offen
  s_add_u32 s51, s51, 24576
  buffer_load_dwordx2 v[232:233], v247, s[16:19], s49 offen offset:0
  buffer_load_dwordx2 v[234:235], v247, s[16:19], s49 offen offset:64
  buffer_load_dwordx2 v[236:237], v247, s[16:19], s49 offen offset:128
  buffer_load_dwordx2 v[238:239], v247, s[16:19], s49 offen offset:192
  s_add_u32 s45, s44, 16384
  s_add_u32 s46, s44, 32768
  s_add_u32 s47, s44, 49152
  buffer_load_dwordx4 v[128:131], v243, s[8:11], s44 offen offset:0
  buffer_load_dwordx4 v[132:135], v243, s[8:11], s45 offen offset:0
  buffer_load_dwordx4 v[136:139], v243, s[8:11], s46 offen offset:0
  buffer_load_dwordx4 v[140:143], v243, s[8:11], s47 offen offset:0
  buffer_load_dwordx4 v[144:147], v243, s[8:11], s44 offen offset:128
  buffer_load_dwordx4 v[148:151], v243, s[8:11], s45 offen offset:128
  buffer_load_dwordx4 v[152:155], v243, s[8:11], s46 offen offset:128
  buffer_load_dwordx4 v[156:159], v243, s[8:11], s47 offen offset:128
  buffer_load_dwordx4 v[160:163], v243, s[8:11], s44 offen offset:256
  buffer_load_dwordx4 v[164:167], v243, s[8:11], s45 offen offset:256
  buffer_load_dwordx4 v[168:171], v243, s[8:11], s46 offen offset:256
  buffer_load_dwordx4 v[172:175], v243, s[8:11], s47 offen offset:256
  v_bfe_u32 v248, v240, 2, 5
  v_lshlrev_b32 v248, 6, v248
  v_lshl_add_u32 v248, v245, 5, v248
  v_and_b32 v249, 3, v240
  v_lshl_add_u32 v248, v249, 3, v248
  v_add_u32 v248, 124928, v248
  v_cvt_f32_u32 v246, v246
  v_lshlrev_b32 v249, 6, v242
  v_add_u32 v249, 124928, v249
  v_lshrrev_b32 v250, 4, v0
  v_xor_b32 v250, v250, v242
  v_lshlrev_b32 v250, 4, v250
  v_lshl_add_u32 v250, v241, 7, v250
  s_lshl_b32 s50, s24, 12
  v_add_u32 v250, s50, v250
  v_xor_b32 v251, 64, v250
  s_and_b32 s20, s2, 7
  s_lshr_b32 s21, s2, 3
  s_and_b32 s22, s20, 1
  s_lshr_b32 s23, s20, 1
  s_and_b32 s20, s21, 7
  s_lshr_b32 s21, s21, 3
  s_mul_i32 s22, s22, 8
  s_add_u32 s22, s22, s20
  s_mul_i32 s23, s23, 4
  s_add_u32 s23, s23, s21
  s_lshr_b32 s25, s24, 1
  s_and_b32 s26, s24, 1
  v_and_b32 v6, 15, v0
  v_bfe_u32 v8, v0, 4, 1
  v_lshrrev_b32 v15, 4, v0
  v_bfe_u32 v13, v0, 1, 3
  v_xor_b32 v13, v13, v15
  v_lshlrev_b32 v13, 4, v13
  v_lshl_add_u32 v2, v6, 7, v13
  s_lshl_b32 s27, s25, 13
  v_add_u32 v2, s27, v2
  v_bfe_u32 v13, v0, 2, 2
  v_lshlrev_b32 v4, 7, v13
  v_lshl_add_u32 v4, v15, 10, v4
  v_and_b32 v13, 3, v0
  v_lshl_add_u32 v4, v13, 3, v4
  v_bfe_u32 v13, v0, 3, 2
  s_lshl_b32 s27, s26, 1
  v_xor_b32 v13, s27, v13
  v_lshl_add_u32 v4, v13, 5, v4
  v_add_u32 v4, 16384, v4
  v_xor_b32 v10, 32, v4
  v_mov_b32 v32, 0
  v_mov_b32 v33, 0
  v_mov_b32 v34, 0
  v_mov_b32 v35, 0
  v_mov_b32 v36, 0
  v_mov_b32 v37, 0
  v_mov_b32 v38, 0
  v_mov_b32 v39, 0
  v_mov_b32 v40, 0
  v_mov_b32 v41, 0
  v_mov_b32 v42, 0
  v_mov_b32 v43, 0
  v_mov_b32 v44, 0
  v_mov_b32 v45, 0
  v_mov_b32 v46, 0
  v_mov_b32 v47, 0
  v_mov_b32 v48, 0
  v_mov_b32 v49, 0
  v_mov_b32 v50, 0
  v_mov_b32 v51, 0
  v_mov_b32 v52, 0
  v_mov_b32 v53, 0
  v_mov_b32 v54, 0
  v_mov_b32 v55, 0
  v_mov_b32 v56, 0
  v_mov_b32 v57, 0
  v_mov_b32 v58, 0
  v_mov_b32 v59, 0
  v_mov_b32 v60, 0
  v_mov_b32 v61, 0
  v_mov_b32 v62, 0
  v_mov_b32 v63, 0
  v_mov_b32 v64, 0
  v_mov_b32 v65, 0
  v_mov_b32 v66, 0
  v_mov_b32 v67, 0
  v_mov_b32 v68, 0
  v_mov_b32 v69, 0
  v_mov_b32 v70, 0
  v_mov_b32 v71, 0
  v_mov_b32 v72, 0
  v_mov_b32 v73, 0
  v_mov_b32 v74, 0
  v_mov_b32 v75, 0
  v_mov_b32 v76, 0
  v_mov_b32 v77, 0
  v_mov_b32 v78, 0
  v_mov_b32 v79, 0
  v_mov_b32 v80, 0
  v_mov_b32 v81, 0
  v_mov_b32 v82, 0
  v_mov_b32 v83, 0
  v_mov_b32 v84, 0
  v_mov_b32 v85, 0
  v_mov_b32 v86, 0
  v_mov_b32 v87, 0
  v_mov_b32 v88, 0
  v_mov_b32 v89, 0
  v_mov_b32 v90, 0
  v_mov_b32 v91, 0
  v_mov_b32 v92, 0
  v_mov_b32 v93, 0
  v_mov_b32 v94, 0
  v_mov_b32 v95, 0
  v_mov_b32 v96, 0
  v_mov_b32 v97, 0
  v_mov_b32 v98, 0
  v_mov_b32 v99, 0
  v_mov_b32 v100, 0
  v_mov_b32 v101, 0
  v_mov_b32 v102, 0
  v_mov_b32 v103, 0
  v_mov_b32 v104, 0
  v_mov_b32 v105, 0
  v_mov_b32 v106, 0
  v_mov_b32 v107, 0
  v_mov_b32 v108, 0
  v_mov_b32 v109, 0
  v_mov_b32 v110, 0
  v_mov_b32 v111, 0
  v_mov_b32 v112, 0
  v_mov_b32 v113, 0
  v_mov_b32 v114, 0
  v_mov_b32 v115, 0
  v_mov_b32 v116, 0
  v_mov_b32 v117, 0
  v_mov_b32 v118, 0
  v_mov_b32 v119, 0
  v_mov_b32 v120, 0
  v_mov_b32 v121, 0
  v_mov_b32 v122, 0
  v_mov_b32 v123, 0
  v_mov_b32 v124, 0
  v_mov_b32 v125, 0
  v_mov_b32 v126, 0
  v_mov_b32 v127, 0
  s_mov_b32 s34, 0
  s_mov_b32 s35, 0
  v_mov_b32 v3, v2
  v_mov_b32 v5, v4
  v_mov_b32 v11, v10
  v_xor_b32 v14, 64, v3
  s_add_u32 s40, s6, 0x500000
  s_addc_u32 s41, s7, 0
  s_mov_b32 s42, 0x800000
  s_mov_b32 s43, 0x20000
  s_lshl_b32 s29, s23, 19
  s_lshl_b32 s30, s22, 15
  s_add_u32 s29, s29, s30
  s_add_u32 s30, s29, 8192
  s_lshl_b32 s31, s26, 14
  s_lshl_b32 s32, s25, 12
  s_add_u32 s31, s31, s32
  v_lshlrev_b32 v13, 9, v15
  v_lshl_add_u32 v16, v6, 4, v13
  v_bfe_u32 v17, v0, 3, 1
  v_lshl_add_u32 v17, v17, 7, v16
  v_add_u32 v17, s31, v17
  v_add_u32 v18, s31, v16
  s_lshl_b32 s31, s24, 12
  s_add_u32 s31, s31, 32768
  v_add_u32 v16, s31, v16
  v_add_u32 v19, s31, v1
  s_mov_b32 s32, 0x3e8293ee
  s_mov_b32 s33, s32
  s_mov_b32 s31, 0x4f800000
  s_waitcnt vmcnt(16)
  v_add_f32 v224, v224, v226
  v_add_f32 v228, v228, v230
  v_add_f32 v225, v225, v227
  v_add_f32 v229, v229, v231
  v_add_f32 v224, v224, v228
  v_add_f32 v225, v225, v229
  v_cvt_pk_bf16_f32 v224, v224, v224
  v_and_b32 v224, 0xffff0000, v224
  v_cvt_pk_bf16_f32 v225, v225, v225
  v_and_b32 v225, 0xffff0000, v225
  v_add_f32 v224, v246, v224
  v_add_f32 v225, v246, v225
  v_cvt_pk_bf16_f32 v224, v224, v224
  v_and_b32 v224, 0xffff0000, v224
  v_cvt_pk_bf16_f32 v225, v225, v225
  v_and_b32 v225, 0xffff0000, v225
  ds_write_b64 v248, v[224:225]
  s_waitcnt lgkmcnt(0)
  s_barrier
  ds_read_b128 v[176:179], v249 offset:0
  ds_read_b128 v[180:183], v249 offset:16
  ds_read_b128 v[184:187], v249 offset:32
  ds_read_b128 v[188:191], v249 offset:48
  ds_read_b128 v[192:195], v249 offset:512
  ds_read_b128 v[196:199], v249 offset:528
  ds_read_b128 v[200:203], v249 offset:544
  ds_read_b128 v[204:207], v249 offset:560
  ds_read_b128 v[208:211], v249 offset:1024
  ds_read_b128 v[212:215], v249 offset:1040
  ds_read_b128 v[216:219], v249 offset:1056
  ds_read_b128 v[220:223], v249 offset:1072
  s_waitcnt lgkmcnt(0)
  s_waitcnt vmcnt(11)
  v_lshlrev_b32 v224, 16, v128
  v_and_b32 v225, 0xffff0000, v128
  v_lshlrev_b32 v226, 16, v129
  v_and_b32 v227, 0xffff0000, v129
  v_lshlrev_b32 v228, 16, v130
  v_and_b32 v229, 0xffff0000, v130
  v_lshlrev_b32 v230, 16, v131
  v_and_b32 v231, 0xffff0000, v131
  v_pk_fma_f32 v[224:225], v[224:225], v[232:233], v[232:233] op_sel:[0,0,1] op_sel_hi:[1,0,1]
  v_pk_fma_f32 v[226:227], v[226:227], v[232:233], v[232:233] op_sel:[0,0,1] op_sel_hi:[1,0,1]
  v_pk_fma_f32 v[228:229], v[228:229], v[232:233], v[232:233] op_sel:[0,0,1] op_sel_hi:[1,0,1]
  v_pk_fma_f32 v[230:231], v[230:231], v[232:233], v[232:233] op_sel:[0,0,1] op_sel_hi:[1,0,1]
  v_pk_fma_f32 v[224:225], v[224:225], v[176:177], v[184:185]
  v_pk_fma_f32 v[226:227], v[226:227], v[178:179], v[186:187]
  v_pk_fma_f32 v[228:229], v[228:229], v[180:181], v[188:189]
  v_pk_fma_f32 v[230:231], v[230:231], v[182:183], v[190:191]
  v_cvt_pk_bf16_f32 v128, v224, v225
  v_cvt_pk_bf16_f32 v129, v226, v227
  v_cvt_pk_bf16_f32 v130, v228, v229
  v_cvt_pk_bf16_f32 v131, v230, v231
  ds_write_b128 v250, v[128:131] offset:0
  s_waitcnt vmcnt(10)
  v_lshlrev_b32 v224, 16, v132
  v_and_b32 v225, 0xffff0000, v132
  v_lshlrev_b32 v226, 16, v133
  v_and_b32 v227, 0xffff0000, v133
  v_lshlrev_b32 v228, 16, v134
  v_and_b32 v229, 0xffff0000, v134
  v_lshlrev_b32 v230, 16, v135
  v_and_b32 v231, 0xffff0000, v135
  v_pk_fma_f32 v[224:225], v[224:225], v[234:235], v[234:235] op_sel:[0,0,1] op_sel_hi:[1,0,1]
  v_pk_fma_f32 v[226:227], v[226:227], v[234:235], v[234:235] op_sel:[0,0,1] op_sel_hi:[1,0,1]
  v_pk_fma_f32 v[228:229], v[228:229], v[234:235], v[234:235] op_sel:[0,0,1] op_sel_hi:[1,0,1]
  v_pk_fma_f32 v[230:231], v[230:231], v[234:235], v[234:235] op_sel:[0,0,1] op_sel_hi:[1,0,1]
  v_pk_fma_f32 v[224:225], v[224:225], v[176:177], v[184:185]
  v_pk_fma_f32 v[226:227], v[226:227], v[178:179], v[186:187]
  v_pk_fma_f32 v[228:229], v[228:229], v[180:181], v[188:189]
  v_pk_fma_f32 v[230:231], v[230:231], v[182:183], v[190:191]
  v_cvt_pk_bf16_f32 v132, v224, v225
  v_cvt_pk_bf16_f32 v133, v226, v227
  v_cvt_pk_bf16_f32 v134, v228, v229
  v_cvt_pk_bf16_f32 v135, v230, v231
  ds_write_b128 v251, v[132:135] offset:1024
  s_waitcnt vmcnt(9)
  v_lshlrev_b32 v224, 16, v136
  v_and_b32 v225, 0xffff0000, v136
  v_lshlrev_b32 v226, 16, v137
  v_and_b32 v227, 0xffff0000, v137
  v_lshlrev_b32 v228, 16, v138
  v_and_b32 v229, 0xffff0000, v138
  v_lshlrev_b32 v230, 16, v139
  v_and_b32 v231, 0xffff0000, v139
  v_pk_fma_f32 v[224:225], v[224:225], v[236:237], v[236:237] op_sel:[0,0,1] op_sel_hi:[1,0,1]
  v_pk_fma_f32 v[226:227], v[226:227], v[236:237], v[236:237] op_sel:[0,0,1] op_sel_hi:[1,0,1]
  v_pk_fma_f32 v[228:229], v[228:229], v[236:237], v[236:237] op_sel:[0,0,1] op_sel_hi:[1,0,1]
  v_pk_fma_f32 v[230:231], v[230:231], v[236:237], v[236:237] op_sel:[0,0,1] op_sel_hi:[1,0,1]
  v_pk_fma_f32 v[224:225], v[224:225], v[176:177], v[184:185]
  v_pk_fma_f32 v[226:227], v[226:227], v[178:179], v[186:187]
  v_pk_fma_f32 v[228:229], v[228:229], v[180:181], v[188:189]
  v_pk_fma_f32 v[230:231], v[230:231], v[182:183], v[190:191]
  v_cvt_pk_bf16_f32 v136, v224, v225
  v_cvt_pk_bf16_f32 v137, v226, v227
  v_cvt_pk_bf16_f32 v138, v228, v229
  v_cvt_pk_bf16_f32 v139, v230, v231
  ds_write_b128 v250, v[136:139] offset:2048
  s_waitcnt vmcnt(8)
  v_lshlrev_b32 v224, 16, v140
  v_and_b32 v225, 0xffff0000, v140
  v_lshlrev_b32 v226, 16, v141
  v_and_b32 v227, 0xffff0000, v141
  v_lshlrev_b32 v228, 16, v142
  v_and_b32 v229, 0xffff0000, v142
  v_lshlrev_b32 v230, 16, v143
  v_and_b32 v231, 0xffff0000, v143
  v_pk_fma_f32 v[224:225], v[224:225], v[238:239], v[238:239] op_sel:[0,0,1] op_sel_hi:[1,0,1]
  v_pk_fma_f32 v[226:227], v[226:227], v[238:239], v[238:239] op_sel:[0,0,1] op_sel_hi:[1,0,1]
  v_pk_fma_f32 v[228:229], v[228:229], v[238:239], v[238:239] op_sel:[0,0,1] op_sel_hi:[1,0,1]
  v_pk_fma_f32 v[230:231], v[230:231], v[238:239], v[238:239] op_sel:[0,0,1] op_sel_hi:[1,0,1]
  v_pk_fma_f32 v[224:225], v[224:225], v[176:177], v[184:185]
  v_pk_fma_f32 v[226:227], v[226:227], v[178:179], v[186:187]
  v_pk_fma_f32 v[228:229], v[228:229], v[180:181], v[188:189]
  v_pk_fma_f32 v[230:231], v[230:231], v[182:183], v[190:191]
  v_cvt_pk_bf16_f32 v140, v224, v225
  v_cvt_pk_bf16_f32 v141, v226, v227
  v_cvt_pk_bf16_f32 v142, v228, v229
  v_cvt_pk_bf16_f32 v143, v230, v231
  ds_write_b128 v251, v[140:143] offset:3072
  v_add_u32 v250, 40960, v250
  v_add_u32 v251, 40960, v251
  s_waitcnt vmcnt(7)
  v_lshlrev_b32 v224, 16, v144
  v_and_b32 v225, 0xffff0000, v144
  v_lshlrev_b32 v226, 16, v145
  v_and_b32 v227, 0xffff0000, v145
  v_lshlrev_b32 v228, 16, v146
  v_and_b32 v229, 0xffff0000, v146
  v_lshlrev_b32 v230, 16, v147
  v_and_b32 v231, 0xffff0000, v147
  v_pk_fma_f32 v[224:225], v[224:225], v[232:233], v[232:233] op_sel:[0,0,1] op_sel_hi:[1,0,1]
  v_pk_fma_f32 v[226:227], v[226:227], v[232:233], v[232:233] op_sel:[0,0,1] op_sel_hi:[1,0,1]
  v_pk_fma_f32 v[228:229], v[228:229], v[232:233], v[232:233] op_sel:[0,0,1] op_sel_hi:[1,0,1]
  v_pk_fma_f32 v[230:231], v[230:231], v[232:233], v[232:233] op_sel:[0,0,1] op_sel_hi:[1,0,1]
  v_pk_fma_f32 v[224:225], v[224:225], v[192:193], v[200:201]
  v_pk_fma_f32 v[226:227], v[226:227], v[194:195], v[202:203]
  v_pk_fma_f32 v[228:229], v[228:229], v[196:197], v[204:205]
  v_pk_fma_f32 v[230:231], v[230:231], v[198:199], v[206:207]
  v_cvt_pk_bf16_f32 v144, v224, v225
  v_cvt_pk_bf16_f32 v145, v226, v227
  v_cvt_pk_bf16_f32 v146, v228, v229
  v_cvt_pk_bf16_f32 v147, v230, v231
  ds_write_b128 v250, v[144:147] offset:0
  s_waitcnt vmcnt(6)
  v_lshlrev_b32 v224, 16, v148
  v_and_b32 v225, 0xffff0000, v148
  v_lshlrev_b32 v226, 16, v149
  v_and_b32 v227, 0xffff0000, v149
  v_lshlrev_b32 v228, 16, v150
  v_and_b32 v229, 0xffff0000, v150
  v_lshlrev_b32 v230, 16, v151
  v_and_b32 v231, 0xffff0000, v151
  v_pk_fma_f32 v[224:225], v[224:225], v[234:235], v[234:235] op_sel:[0,0,1] op_sel_hi:[1,0,1]
  v_pk_fma_f32 v[226:227], v[226:227], v[234:235], v[234:235] op_sel:[0,0,1] op_sel_hi:[1,0,1]
  v_pk_fma_f32 v[228:229], v[228:229], v[234:235], v[234:235] op_sel:[0,0,1] op_sel_hi:[1,0,1]
  v_pk_fma_f32 v[230:231], v[230:231], v[234:235], v[234:235] op_sel:[0,0,1] op_sel_hi:[1,0,1]
  v_pk_fma_f32 v[224:225], v[224:225], v[192:193], v[200:201]
  v_pk_fma_f32 v[226:227], v[226:227], v[194:195], v[202:203]
  v_pk_fma_f32 v[228:229], v[228:229], v[196:197], v[204:205]
  v_pk_fma_f32 v[230:231], v[230:231], v[198:199], v[206:207]
  v_cvt_pk_bf16_f32 v148, v224, v225
  v_cvt_pk_bf16_f32 v149, v226, v227
  v_cvt_pk_bf16_f32 v150, v228, v229
  v_cvt_pk_bf16_f32 v151, v230, v231
  ds_write_b128 v251, v[148:151] offset:1024
  s_waitcnt vmcnt(5)
  v_lshlrev_b32 v224, 16, v152
  v_and_b32 v225, 0xffff0000, v152
  v_lshlrev_b32 v226, 16, v153
  v_and_b32 v227, 0xffff0000, v153
  v_lshlrev_b32 v228, 16, v154
  v_and_b32 v229, 0xffff0000, v154
  v_lshlrev_b32 v230, 16, v155
  v_and_b32 v231, 0xffff0000, v155
  v_pk_fma_f32 v[224:225], v[224:225], v[236:237], v[236:237] op_sel:[0,0,1] op_sel_hi:[1,0,1]
  v_pk_fma_f32 v[226:227], v[226:227], v[236:237], v[236:237] op_sel:[0,0,1] op_sel_hi:[1,0,1]
  v_pk_fma_f32 v[228:229], v[228:229], v[236:237], v[236:237] op_sel:[0,0,1] op_sel_hi:[1,0,1]
  v_pk_fma_f32 v[230:231], v[230:231], v[236:237], v[236:237] op_sel:[0,0,1] op_sel_hi:[1,0,1]
  v_pk_fma_f32 v[224:225], v[224:225], v[192:193], v[200:201]
  v_pk_fma_f32 v[226:227], v[226:227], v[194:195], v[202:203]
  v_pk_fma_f32 v[228:229], v[228:229], v[196:197], v[204:205]
  v_pk_fma_f32 v[230:231], v[230:231], v[198:199], v[206:207]
  v_cvt_pk_bf16_f32 v152, v224, v225
  v_cvt_pk_bf16_f32 v153, v226, v227
  v_cvt_pk_bf16_f32 v154, v228, v229
  v_cvt_pk_bf16_f32 v155, v230, v231
  ds_write_b128 v250, v[152:155] offset:2048
  s_waitcnt vmcnt(4)
  v_lshlrev_b32 v224, 16, v156
  v_and_b32 v225, 0xffff0000, v156
  v_lshlrev_b32 v226, 16, v157
  v_and_b32 v227, 0xffff0000, v157
  v_lshlrev_b32 v228, 16, v158
  v_and_b32 v229, 0xffff0000, v158
  v_lshlrev_b32 v230, 16, v159
  v_and_b32 v231, 0xffff0000, v159
  v_pk_fma_f32 v[224:225], v[224:225], v[238:239], v[238:239] op_sel:[0,0,1] op_sel_hi:[1,0,1]
  v_pk_fma_f32 v[226:227], v[226:227], v[238:239], v[238:239] op_sel:[0,0,1] op_sel_hi:[1,0,1]
  v_pk_fma_f32 v[228:229], v[228:229], v[238:239], v[238:239] op_sel:[0,0,1] op_sel_hi:[1,0,1]
  v_pk_fma_f32 v[230:231], v[230:231], v[238:239], v[238:239] op_sel:[0,0,1] op_sel_hi:[1,0,1]
  v_pk_fma_f32 v[224:225], v[224:225], v[192:193], v[200:201]
  v_pk_fma_f32 v[226:227], v[226:227], v[194:195], v[202:203]
  v_pk_fma_f32 v[228:229], v[228:229], v[196:197], v[204:205]
  v_pk_fma_f32 v[230:231], v[230:231], v[198:199], v[206:207]
  v_cvt_pk_bf16_f32 v156, v224, v225
  v_cvt_pk_bf16_f32 v157, v226, v227
  v_cvt_pk_bf16_f32 v158, v228, v229
  v_cvt_pk_bf16_f32 v159, v230, v231
  ds_write_b128 v251, v[156:159] offset:3072
  v_add_u32 v250, 40960, v250
  v_add_u32 v251, 40960, v251
  s_waitcnt vmcnt(3)
  v_lshlrev_b32 v224, 16, v160
  v_and_b32 v225, 0xffff0000, v160
  v_lshlrev_b32 v226, 16, v161
  v_and_b32 v227, 0xffff0000, v161
  v_lshlrev_b32 v228, 16, v162
  v_and_b32 v229, 0xffff0000, v162
  v_lshlrev_b32 v230, 16, v163
  v_and_b32 v231, 0xffff0000, v163
  v_pk_fma_f32 v[224:225], v[224:225], v[232:233], v[232:233] op_sel:[0,0,1] op_sel_hi:[1,0,1]
  v_pk_fma_f32 v[226:227], v[226:227], v[232:233], v[232:233] op_sel:[0,0,1] op_sel_hi:[1,0,1]
  v_pk_fma_f32 v[228:229], v[228:229], v[232:233], v[232:233] op_sel:[0,0,1] op_sel_hi:[1,0,1]
  v_pk_fma_f32 v[230:231], v[230:231], v[232:233], v[232:233] op_sel:[0,0,1] op_sel_hi:[1,0,1]
  v_pk_fma_f32 v[224:225], v[224:225], v[208:209], v[216:217]
  v_pk_fma_f32 v[226:227], v[226:227], v[210:211], v[218:219]
  v_pk_fma_f32 v[228:229], v[228:229], v[212:213], v[220:221]
  v_pk_fma_f32 v[230:231], v[230:231], v[214:215], v[222:223]
  v_cvt_pk_bf16_f32 v160, v224, v225
  v_cvt_pk_bf16_f32 v161, v226, v227
  v_cvt_pk_bf16_f32 v162, v228, v229
  v_cvt_pk_bf16_f32 v163, v230, v231
  ds_write_b128 v250, v[160:163] offset:0
  s_waitcnt vmcnt(2)
  v_lshlrev_b32 v224, 16, v164
  v_and_b32 v225, 0xffff0000, v164
  v_lshlrev_b32 v226, 16, v165
  v_and_b32 v227, 0xffff0000, v165
  v_lshlrev_b32 v228, 16, v166
  v_and_b32 v229, 0xffff0000, v166
  v_lshlrev_b32 v230, 16, v167
  v_and_b32 v231, 0xffff0000, v167
  v_pk_fma_f32 v[224:225], v[224:225], v[234:235], v[234:235] op_sel:[0,0,1] op_sel_hi:[1,0,1]
  v_pk_fma_f32 v[226:227], v[226:227], v[234:235], v[234:235] op_sel:[0,0,1] op_sel_hi:[1,0,1]
  v_pk_fma_f32 v[228:229], v[228:229], v[234:235], v[234:235] op_sel:[0,0,1] op_sel_hi:[1,0,1]
  v_pk_fma_f32 v[230:231], v[230:231], v[234:235], v[234:235] op_sel:[0,0,1] op_sel_hi:[1,0,1]
  v_pk_fma_f32 v[224:225], v[224:225], v[208:209], v[216:217]
  v_pk_fma_f32 v[226:227], v[226:227], v[210:211], v[218:219]
  v_pk_fma_f32 v[228:229], v[228:229], v[212:213], v[220:221]
  v_pk_fma_f32 v[230:231], v[230:231], v[214:215], v[222:223]
  v_cvt_pk_bf16_f32 v164, v224, v225
  v_cvt_pk_bf16_f32 v165, v226, v227
  v_cvt_pk_bf16_f32 v166, v228, v229
  v_cvt_pk_bf16_f32 v167, v230, v231
  ds_write_b128 v251, v[164:167] offset:1024
  s_waitcnt vmcnt(1)
  v_lshlrev_b32 v224, 16, v168
  v_and_b32 v225, 0xffff0000, v168
  v_lshlrev_b32 v226, 16, v169
  v_and_b32 v227, 0xffff0000, v169
  v_lshlrev_b32 v228, 16, v170
  v_and_b32 v229, 0xffff0000, v170
  v_lshlrev_b32 v230, 16, v171
  v_and_b32 v231, 0xffff0000, v171
  v_pk_fma_f32 v[224:225], v[224:225], v[236:237], v[236:237] op_sel:[0,0,1] op_sel_hi:[1,0,1]
  v_pk_fma_f32 v[226:227], v[226:227], v[236:237], v[236:237] op_sel:[0,0,1] op_sel_hi:[1,0,1]
  v_pk_fma_f32 v[228:229], v[228:229], v[236:237], v[236:237] op_sel:[0,0,1] op_sel_hi:[1,0,1]
  v_pk_fma_f32 v[230:231], v[230:231], v[236:237], v[236:237] op_sel:[0,0,1] op_sel_hi:[1,0,1]
  v_pk_fma_f32 v[224:225], v[224:225], v[208:209], v[216:217]
  v_pk_fma_f32 v[226:227], v[226:227], v[210:211], v[218:219]
  v_pk_fma_f32 v[228:229], v[228:229], v[212:213], v[220:221]
  v_pk_fma_f32 v[230:231], v[230:231], v[214:215], v[222:223]
  v_cvt_pk_bf16_f32 v168, v224, v225
  v_cvt_pk_bf16_f32 v169, v226, v227
  v_cvt_pk_bf16_f32 v170, v228, v229
  v_cvt_pk_bf16_f32 v171, v230, v231
  ds_write_b128 v250, v[168:171] offset:2048
  s_waitcnt vmcnt(0)
  v_lshlrev_b32 v224, 16, v172
  v_and_b32 v225, 0xffff0000, v172
  v_lshlrev_b32 v226, 16, v173
  v_and_b32 v227, 0xffff0000, v173
  v_lshlrev_b32 v228, 16, v174
  v_and_b32 v229, 0xffff0000, v174
  v_lshlrev_b32 v230, 16, v175
  v_and_b32 v231, 0xffff0000, v175
  v_pk_fma_f32 v[224:225], v[224:225], v[238:239], v[238:239] op_sel:[0,0,1] op_sel_hi:[1,0,1]
  v_pk_fma_f32 v[226:227], v[226:227], v[238:239], v[238:239] op_sel:[0,0,1] op_sel_hi:[1,0,1]
  v_pk_fma_f32 v[228:229], v[228:229], v[238:239], v[238:239] op_sel:[0,0,1] op_sel_hi:[1,0,1]
  v_pk_fma_f32 v[230:231], v[230:231], v[238:239], v[238:239] op_sel:[0,0,1] op_sel_hi:[1,0,1]
  v_pk_fma_f32 v[224:225], v[224:225], v[208:209], v[216:217]
  v_pk_fma_f32 v[226:227], v[226:227], v[210:211], v[218:219]
  v_pk_fma_f32 v[228:229], v[228:229], v[212:213], v[220:221]
  v_pk_fma_f32 v[230:231], v[230:231], v[214:215], v[222:223]
  v_cvt_pk_bf16_f32 v172, v224, v225
  v_cvt_pk_bf16_f32 v173, v226, v227
  v_cvt_pk_bf16_f32 v174, v228, v229
  v_cvt_pk_bf16_f32 v175, v230, v231
  ds_write_b128 v251, v[172:175] offset:3072
  s_waitcnt lgkmcnt(0)
  s_setprio 1
  s_mov_b32 s44, s4
  s_mov_b32 s45, s5
  s_mov_b32 s46, 0x600000
  s_mov_b32 s47, 0x20000
  s_mul_i32 s48, s2, 12288
  s_add_u32 s48, s48, 3145728
  s_lshl_b32 s49, s24, 10
  s_add_u32 s48, s48, s49
  buffer_load_dwordx4 v[252:255], v1, s[44:47], s48 offen
  s_add_u32 s48, s48, 4096
  buffer_load_dwordx4 v[252:255], v1, s[44:47], s48 offen
  s_add_u32 s48, s48, 4096
  buffer_load_dwordx4 v[252:255], v1, s[44:47], s48 offen
  s_add_u32 s48, s48, 4096
  s_barrier
  ds_read_b64_tr_b16 v[208:209], v5 offset:8192
  ds_read_b64_tr_b16 v[210:211], v5 offset:8704
  ds_read_b128 v[160:163], v3 offset:0
  ds_read_b128 v[164:167], v3 offset:2048
  ds_read_b128 v[168:171], v3 offset:4096
  ds_read_b128 v[172:175], v3 offset:6144
  ds_read_b64_tr_b16 v[212:213], v11 offset:8192
  ds_read_b64_tr_b16 v[214:215], v11 offset:8704
  ds_read_b64_tr_b16 v[216:217], v5 offset:16384
  ds_read_b64_tr_b16 v[218:219], v5 offset:16896
.Lattn_kernel_loop_16:
  s_waitcnt lgkmcnt(4)
  v_mfma_f32_16x16x32_bf16 v[32:35], v[208:211], v[160:163], v[32:35]
  ds_read_b64_tr_b16 v[220:221], v11 offset:16384
  v_mfma_f32_16x16x32_bf16 v[36:39], v[208:211], v[164:167], v[36:39]
  ds_read_b64_tr_b16 v[222:223], v11 offset:16896
  v_mfma_f32_16x16x32_bf16 v[40:43], v[208:211], v[168:171], v[40:43]
  v_mfma_f32_16x16x32_bf16 v[44:47], v[208:211], v[172:175], v[44:47]
  s_add_u32 s34, s34, 40960
  s_cmp_eq_u32 s34, 163840
  s_cselect_b32 s34, 0, s34
  s_add_u32 s35, s35, 1
  s_waitcnt lgkmcnt(4)
  v_mfma_f32_16x16x32_bf16 v[48:51], v[212:215], v[160:163], v[48:51]
  ds_read_b64_tr_b16 v[224:225], v5 offset:0
  v_mfma_f32_16x16x32_bf16 v[52:55], v[212:215], v[164:167], v[52:55]
  ds_read_b64_tr_b16 v[226:227], v5 offset:512
  v_mfma_f32_16x16x32_bf16 v[56:59], v[212:215], v[168:171], v[56:59]
  v_mfma_f32_16x16x32_bf16 v[60:63], v[212:215], v[172:175], v[60:63]
  s_waitcnt lgkmcnt(4)
  v_mfma_f32_16x16x32_bf16 v[64:67], v[160:163], v[216:219], v[64:67]
  ds_read_b64_tr_b16 v[228:229], v11 offset:0
  v_mfma_f32_16x16x32_bf16 v[68:71], v[164:167], v[216:219], v[68:71]
  ds_read_b64_tr_b16 v[230:231], v11 offset:512
  v_mfma_f32_16x16x32_bf16 v[72:75], v[168:171], v[216:219], v[72:75]
  ds_read_b128 v[176:179], v14 offset:0
  v_mfma_f32_16x16x32_bf16 v[76:79], v[172:175], v[216:219], v[76:79]
  ds_read_b128 v[180:183], v14 offset:2048
  s_waitcnt lgkmcnt(6)
  v_mfma_f32_16x16x32_bf16 v[80:83], v[160:163], v[220:223], v[80:83]
  ds_read_b64_tr_b16 v[208:209], v5 offset:12288
  v_mfma_f32_16x16x32_bf16 v[84:87], v[164:167], v[220:223], v[84:87]
  ds_read_b64_tr_b16 v[210:211], v5 offset:12800
  v_mfma_f32_16x16x32_bf16 v[88:91], v[168:171], v[220:223], v[88:91]
  ds_read_b128 v[184:187], v14 offset:4096
  v_mfma_f32_16x16x32_bf16 v[92:95], v[172:175], v[220:223], v[92:95]
  ds_read_b128 v[188:191], v14 offset:6144
  s_waitcnt lgkmcnt(8)
  v_mfma_f32_16x16x32_bf16 v[96:99], v[224:227], v[160:163], v[96:99]
  ds_read_b64_tr_b16 v[212:213], v11 offset:12288
  v_mfma_f32_16x16x32_bf16 v[100:103], v[224:227], v[164:167], v[100:103]
  ds_read_b64_tr_b16 v[214:215], v11 offset:12800
  v_mfma_f32_16x16x32_bf16 v[104:107], v[224:227], v[168:171], v[104:107]
  v_mfma_f32_16x16x32_bf16 v[108:111], v[224:227], v[172:175], v[108:111]
  s_waitcnt lgkmcnt(8)
  v_mfma_f32_16x16x32_bf16 v[112:115], v[228:231], v[160:163], v[112:115]
  ds_read_b64_tr_b16 v[216:217], v5 offset:20480
  v_mfma_f32_16x16x32_bf16 v[116:119], v[228:231], v[164:167], v[116:119]
  ds_read_b64_tr_b16 v[218:219], v5 offset:20992
  v_mfma_f32_16x16x32_bf16 v[120:123], v[228:231], v[168:171], v[120:123]
  v_mfma_f32_16x16x32_bf16 v[124:127], v[228:231], v[172:175], v[124:127]
  s_waitcnt lgkmcnt(4)
  v_mfma_f32_16x16x32_bf16 v[32:35], v[208:211], v[176:179], v[32:35]
  ds_read_b64_tr_b16 v[220:221], v11 offset:20480
  v_mfma_f32_16x16x32_bf16 v[36:39], v[208:211], v[180:183], v[36:39]
  ds_read_b64_tr_b16 v[222:223], v11 offset:20992
  v_mfma_f32_16x16x32_bf16 v[40:43], v[208:211], v[184:187], v[40:43]
  v_mfma_f32_16x16x32_bf16 v[44:47], v[208:211], v[188:191], v[44:47]
  s_waitcnt lgkmcnt(4)
  v_mfma_f32_16x16x32_bf16 v[48:51], v[212:215], v[176:179], v[48:51]
  ds_read_b64_tr_b16 v[224:225], v5 offset:4096
  v_mfma_f32_16x16x32_bf16 v[52:55], v[212:215], v[180:183], v[52:55]
  ds_read_b64_tr_b16 v[226:227], v5 offset:4608
  v_mfma_f32_16x16x32_bf16 v[56:59], v[212:215], v[184:187], v[56:59]
  ds_read_b64_tr_b16 v[228:229], v11 offset:4096
  v_mfma_f32_16x16x32_bf16 v[60:63], v[212:215], v[188:191], v[60:63]
  ds_read_b64_tr_b16 v[230:231], v11 offset:4608
  v_add_u32 v3, s34, v2
  v_add_u32 v5, s34, v4
  v_add_u32 v11, s34, v10
  v_xor_b32 v14, 64, v3
  s_waitcnt lgkmcnt(6)
  v_mfma_f32_16x16x32_bf16 v[64:67], v[176:179], v[216:219], v[64:67]
  v_mfma_f32_16x16x32_bf16 v[68:71], v[180:183], v[216:219], v[68:71]
  v_mfma_f32_16x16x32_bf16 v[72:75], v[184:187], v[216:219], v[72:75]
  v_mfma_f32_16x16x32_bf16 v[76:79], v[188:191], v[216:219], v[76:79]
  s_waitcnt lgkmcnt(0)
  s_barrier
  v_mfma_f32_16x16x32_bf16 v[80:83], v[176:179], v[220:223], v[80:83]
  ds_read_b64_tr_b16 v[208:209], v5 offset:8192
  v_mfma_f32_16x16x32_bf16 v[84:87], v[180:183], v[220:223], v[84:87]
  ds_read_b64_tr_b16 v[210:211], v5 offset:8704
  v_mfma_f32_16x16x32_bf16 v[88:91], v[184:187], v[220:223], v[88:91]
  ds_read_b128 v[160:163], v3 offset:0
  v_mfma_f32_16x16x32_bf16 v[92:95], v[188:191], v[220:223], v[92:95]
  ds_read_b128 v[164:167], v3 offset:2048
  v_mfma_f32_16x16x32_bf16 v[96:99], v[224:227], v[176:179], v[96:99]
  ds_read_b128 v[168:171], v3 offset:4096
  v_mfma_f32_16x16x32_bf16 v[100:103], v[224:227], v[180:183], v[100:103]
  ds_read_b128 v[172:175], v3 offset:6144
  v_mfma_f32_16x16x32_bf16 v[104:107], v[224:227], v[184:187], v[104:107]
  ds_read_b64_tr_b16 v[212:213], v11 offset:8192
  v_mfma_f32_16x16x32_bf16 v[108:111], v[224:227], v[188:191], v[108:111]
  ds_read_b64_tr_b16 v[214:215], v11 offset:8704
  v_mfma_f32_16x16x32_bf16 v[112:115], v[228:231], v[176:179], v[112:115]
  ds_read_b64_tr_b16 v[216:217], v5 offset:16384
  v_mfma_f32_16x16x32_bf16 v[116:119], v[228:231], v[180:183], v[116:119]
  ds_read_b64_tr_b16 v[218:219], v5 offset:16896
  v_mfma_f32_16x16x32_bf16 v[120:123], v[228:231], v[184:187], v[120:123]
  v_mfma_f32_16x16x32_bf16 v[124:127], v[228:231], v[188:191], v[124:127]
  s_cmp_lt_u32 s35, 13
  s_cbranch_scc1 .Lattn_kernel_loop_16
  v_add_u32 v24, 81920, v2
  v_xor_b32 v25, 64, v24
  v_add_u32 v26, 81920, v4
  v_add_u32 v27, 81920, v10
  v_add_u32 v28, 122880, v2
  v_xor_b32 v29, 64, v28
  v_add_u32 v30, 122880, v4
  v_add_u32 v31, 122880, v10
  s_waitcnt lgkmcnt(4)
  v_mfma_f32_16x16x32_bf16 v[32:35], v[208:211], v[160:163], v[32:35]
  ds_read_b128 v[176:179], v14 offset:0
  ds_read_b128 v[180:183], v14 offset:2048
  v_mfma_f32_16x16x32_bf16 v[36:39], v[208:211], v[164:167], v[36:39]
  ds_read_b64_tr_b16 v[220:221], v11 offset:16384
  ds_read_b64_tr_b16 v[222:223], v11 offset:16896
  v_mfma_f32_16x16x32_bf16 v[40:43], v[208:211], v[168:171], v[40:43]
  v_mfma_f32_16x16x32_bf16 v[44:47], v[208:211], v[172:175], v[44:47]
  s_waitcnt lgkmcnt(6)
  v_mfma_f32_16x16x32_bf16 v[48:51], v[212:215], v[160:163], v[48:51]
  ds_read_b128 v[184:187], v14 offset:4096
  ds_read_b128 v[188:191], v14 offset:6144
  v_mfma_f32_16x16x32_bf16 v[52:55], v[212:215], v[164:167], v[52:55]
  ds_read_b64_tr_b16 v[224:225], v5 offset:12288
  ds_read_b64_tr_b16 v[226:227], v5 offset:12800
  v_mfma_f32_16x16x32_bf16 v[56:59], v[212:215], v[168:171], v[56:59]
  v_mfma_f32_16x16x32_bf16 v[60:63], v[212:215], v[172:175], v[60:63]
  s_waitcnt lgkmcnt(8)
  v_mfma_f32_16x16x32_bf16 v[64:67], v[160:163], v[216:219], v[64:67]
  ds_read_b64_tr_b16 v[228:229], v11 offset:12288
  ds_read_b64_tr_b16 v[230:231], v11 offset:12800
  v_mfma_f32_16x16x32_bf16 v[68:71], v[164:167], v[216:219], v[68:71]
  v_mfma_f32_16x16x32_bf16 v[72:75], v[168:171], v[216:219], v[72:75]
  v_mfma_f32_16x16x32_bf16 v[76:79], v[172:175], v[216:219], v[76:79]
  s_waitcnt lgkmcnt(6)
  v_mfma_f32_16x16x32_bf16 v[80:83], v[160:163], v[220:223], v[80:83]
  ds_read_b64_tr_b16 v[232:233], v5 offset:20480
  ds_read_b64_tr_b16 v[234:235], v5 offset:20992
  v_mfma_f32_16x16x32_bf16 v[84:87], v[164:167], v[220:223], v[84:87]
  v_mfma_f32_16x16x32_bf16 v[88:91], v[168:171], v[220:223], v[88:91]
  v_mfma_f32_16x16x32_bf16 v[92:95], v[172:175], v[220:223], v[92:95]
  s_waitcnt lgkmcnt(4)
  v_mfma_f32_16x16x32_bf16 v[32:35], v[224:227], v[176:179], v[32:35]
  ds_read_b64_tr_b16 v[236:237], v11 offset:20480
  ds_read_b64_tr_b16 v[238:239], v11 offset:20992
  v_mfma_f32_16x16x32_bf16 v[36:39], v[224:227], v[180:183], v[36:39]
  v_mfma_f32_16x16x32_bf16 v[40:43], v[224:227], v[184:187], v[40:43]
  v_mfma_f32_16x16x32_bf16 v[44:47], v[224:227], v[188:191], v[44:47]
  s_barrier
  s_waitcnt lgkmcnt(4)
  v_mfma_f32_16x16x32_bf16 v[48:51], v[228:231], v[176:179], v[48:51]
  ds_read_b128 v[192:195], v24 offset:0
  ds_read_b128 v[196:199], v24 offset:2048
  v_mfma_f32_16x16x32_bf16 v[52:55], v[228:231], v[180:183], v[52:55]
  ds_read_b64_tr_b16 v[208:209], v26 offset:8192
  ds_read_b64_tr_b16 v[210:211], v26 offset:8704
  v_mfma_f32_16x16x32_bf16 v[56:59], v[228:231], v[184:187], v[56:59]
  v_mfma_f32_16x16x32_bf16 v[60:63], v[228:231], v[188:191], v[60:63]
  s_waitcnt lgkmcnt(6)
  v_mfma_f32_16x16x32_bf16 v[64:67], v[176:179], v[232:235], v[64:67]
  ds_read_b128 v[200:203], v24 offset:4096
  ds_read_b128 v[204:207], v24 offset:6144
  v_mfma_f32_16x16x32_bf16 v[68:71], v[180:183], v[232:235], v[68:71]
  ds_read_b64_tr_b16 v[212:213], v27 offset:8192
  ds_read_b64_tr_b16 v[214:215], v27 offset:8704
  v_mfma_f32_16x16x32_bf16 v[72:75], v[184:187], v[232:235], v[72:75]
  v_mfma_f32_16x16x32_bf16 v[76:79], v[188:191], v[232:235], v[76:79]
  s_waitcnt lgkmcnt(8)
  v_mfma_f32_16x16x32_bf16 v[80:83], v[176:179], v[236:239], v[80:83]
  ds_read_b64_tr_b16 v[216:217], v26 offset:16384
  ds_read_b64_tr_b16 v[218:219], v26 offset:16896
  v_mfma_f32_16x16x32_bf16 v[84:87], v[180:183], v[236:239], v[84:87]
  v_mfma_f32_16x16x32_bf16 v[88:91], v[184:187], v[236:239], v[88:91]
  v_mfma_f32_16x16x32_bf16 v[92:95], v[188:191], v[236:239], v[92:95]
  s_waitcnt lgkmcnt(4)
  v_mfma_f32_16x16x32_bf16 v[32:35], v[208:211], v[192:195], v[32:35]
  ds_read_b128 v[160:163], v25 offset:0
  ds_read_b128 v[164:167], v25 offset:2048
  v_mfma_f32_16x16x32_bf16 v[36:39], v[208:211], v[196:199], v[36:39]
  ds_read_b64_tr_b16 v[220:221], v27 offset:16384
  ds_read_b64_tr_b16 v[222:223], v27 offset:16896
  v_mfma_f32_16x16x32_bf16 v[40:43], v[208:211], v[200:203], v[40:43]
  v_mfma_f32_16x16x32_bf16 v[44:47], v[208:211], v[204:207], v[44:47]
  s_waitcnt lgkmcnt(6)
  v_mfma_f32_16x16x32_bf16 v[48:51], v[212:215], v[192:195], v[48:51]
  ds_read_b128 v[168:171], v25 offset:4096
  ds_read_b128 v[172:175], v25 offset:6144
  v_mfma_f32_16x16x32_bf16 v[52:55], v[212:215], v[196:199], v[52:55]
  ds_read_b64_tr_b16 v[224:225], v26 offset:12288
  ds_read_b64_tr_b16 v[226:227], v26 offset:12800
  v_mfma_f32_16x16x32_bf16 v[56:59], v[212:215], v[200:203], v[56:59]
  v_mfma_f32_16x16x32_bf16 v[60:63], v[212:215], v[204:207], v[60:63]
  s_waitcnt lgkmcnt(8)
  v_mfma_f32_16x16x32_bf16 v[64:67], v[192:195], v[216:219], v[64:67]
  ds_read_b64_tr_b16 v[228:229], v27 offset:12288
  ds_read_b64_tr_b16 v[230:231], v27 offset:12800
  v_mfma_f32_16x16x32_bf16 v[68:71], v[196:199], v[216:219], v[68:71]
  v_mfma_f32_16x16x32_bf16 v[72:75], v[200:203], v[216:219], v[72:75]
  v_mfma_f32_16x16x32_bf16 v[76:79], v[204:207], v[216:219], v[76:79]
  s_waitcnt lgkmcnt(6)
  v_mfma_f32_16x16x32_bf16 v[80:83], v[192:195], v[220:223], v[80:83]
  ds_read_b64_tr_b16 v[232:233], v26 offset:20480
  ds_read_b64_tr_b16 v[234:235], v26 offset:20992
  v_mfma_f32_16x16x32_bf16 v[84:87], v[196:199], v[220:223], v[84:87]
  v_mfma_f32_16x16x32_bf16 v[88:91], v[200:203], v[220:223], v[88:91]
  v_mfma_f32_16x16x32_bf16 v[92:95], v[204:207], v[220:223], v[92:95]
  s_waitcnt lgkmcnt(4)
  v_mfma_f32_16x16x32_bf16 v[32:35], v[224:227], v[160:163], v[32:35]
  ds_read_b64_tr_b16 v[236:237], v27 offset:20480
  ds_read_b64_tr_b16 v[238:239], v27 offset:20992
  v_mfma_f32_16x16x32_bf16 v[36:39], v[224:227], v[164:167], v[36:39]
  v_mfma_f32_16x16x32_bf16 v[40:43], v[224:227], v[168:171], v[40:43]
  v_mfma_f32_16x16x32_bf16 v[44:47], v[224:227], v[172:175], v[44:47]
  s_barrier
  s_waitcnt lgkmcnt(4)
  v_mfma_f32_16x16x32_bf16 v[48:51], v[228:231], v[160:163], v[48:51]
  ds_read_b128 v[176:179], v28 offset:0
  ds_read_b128 v[180:183], v28 offset:2048
  v_mfma_f32_16x16x32_bf16 v[52:55], v[228:231], v[164:167], v[52:55]
  ds_read_b64_tr_b16 v[208:209], v30 offset:8192
  ds_read_b64_tr_b16 v[210:211], v30 offset:8704
  v_mfma_f32_16x16x32_bf16 v[56:59], v[228:231], v[168:171], v[56:59]
  v_mfma_f32_16x16x32_bf16 v[60:63], v[228:231], v[172:175], v[60:63]
  s_waitcnt lgkmcnt(6)
  v_mfma_f32_16x16x32_bf16 v[64:67], v[160:163], v[232:235], v[64:67]
  ds_read_b128 v[184:187], v28 offset:4096
  ds_read_b128 v[188:191], v28 offset:6144
  v_mfma_f32_16x16x32_bf16 v[68:71], v[164:167], v[232:235], v[68:71]
  ds_read_b128 v[192:195], v29 offset:0
  ds_read_b128 v[196:199], v29 offset:2048
  v_mfma_f32_16x16x32_bf16 v[72:75], v[168:171], v[232:235], v[72:75]
  ds_read_b128 v[200:203], v29 offset:4096
  ds_read_b128 v[204:207], v29 offset:6144
  v_mfma_f32_16x16x32_bf16 v[76:79], v[172:175], v[232:235], v[76:79]
  ds_read_b64_tr_b16 v[212:213], v31 offset:8192
  ds_read_b64_tr_b16 v[214:215], v31 offset:8704
  s_waitcnt lgkmcnt(12)
  v_mfma_f32_16x16x32_bf16 v[80:83], v[160:163], v[236:239], v[80:83]
  ds_read_b64_tr_b16 v[216:217], v30 offset:12288
  ds_read_b64_tr_b16 v[218:219], v30 offset:12800
  v_mfma_f32_16x16x32_bf16 v[84:87], v[164:167], v[236:239], v[84:87]
  v_mfma_f32_16x16x32_bf16 v[88:91], v[168:171], v[236:239], v[88:91]
  v_mfma_f32_16x16x32_bf16 v[92:95], v[172:175], v[236:239], v[92:95]
  s_waitcnt lgkmcnt(8)
  v_mfma_f32_16x16x32_bf16 v[32:35], v[208:211], v[176:179], v[32:35]
  ds_read_b64_tr_b16 v[220:221], v31 offset:12288
  ds_read_b64_tr_b16 v[222:223], v31 offset:12800
  v_mfma_f32_16x16x32_bf16 v[36:39], v[208:211], v[180:183], v[36:39]
  v_mfma_f32_16x16x32_bf16 v[40:43], v[208:211], v[184:187], v[40:43]
  v_mfma_f32_16x16x32_bf16 v[44:47], v[208:211], v[188:191], v[44:47]
  s_waitcnt lgkmcnt(4)
  v_mfma_f32_16x16x32_bf16 v[48:51], v[212:215], v[176:179], v[48:51]
  ds_read_b64_tr_b16 v[224:225], v30 offset:16384
  ds_read_b64_tr_b16 v[226:227], v30 offset:16896
  v_mfma_f32_16x16x32_bf16 v[52:55], v[212:215], v[180:183], v[52:55]
  v_mfma_f32_16x16x32_bf16 v[56:59], v[212:215], v[184:187], v[56:59]
  v_mfma_f32_16x16x32_bf16 v[60:63], v[212:215], v[188:191], v[60:63]
  s_waitcnt lgkmcnt(4)
  v_mfma_f32_16x16x32_bf16 v[32:35], v[216:219], v[192:195], v[32:35]
  ds_read_b64_tr_b16 v[228:229], v31 offset:16384
  ds_read_b64_tr_b16 v[230:231], v31 offset:16896
  v_mfma_f32_16x16x32_bf16 v[36:39], v[216:219], v[196:199], v[36:39]
  v_mfma_f32_16x16x32_bf16 v[40:43], v[216:219], v[200:203], v[40:43]
  v_mfma_f32_16x16x32_bf16 v[44:47], v[216:219], v[204:207], v[44:47]
  s_waitcnt lgkmcnt(4)
  v_mfma_f32_16x16x32_bf16 v[48:51], v[220:223], v[192:195], v[48:51]
  ds_read_b64_tr_b16 v[232:233], v30 offset:20480
  ds_read_b64_tr_b16 v[234:235], v30 offset:20992
  v_mfma_f32_16x16x32_bf16 v[52:55], v[220:223], v[196:199], v[52:55]
  v_mfma_f32_16x16x32_bf16 v[56:59], v[220:223], v[200:203], v[56:59]
  v_mfma_f32_16x16x32_bf16 v[60:63], v[220:223], v[204:207], v[60:63]
  s_waitcnt lgkmcnt(4)
  v_mfma_f32_16x16x32_bf16 v[64:67], v[176:179], v[224:227], v[64:67]
  ds_read_b64_tr_b16 v[236:237], v31 offset:20480
  ds_read_b64_tr_b16 v[238:239], v31 offset:20992
  v_mfma_f32_16x16x32_bf16 v[68:71], v[180:183], v[224:227], v[68:71]
  v_mfma_f32_16x16x32_bf16 v[72:75], v[184:187], v[224:227], v[72:75]
  v_mfma_f32_16x16x32_bf16 v[76:79], v[188:191], v[224:227], v[76:79]
  s_waitcnt lgkmcnt(4)
  v_mfma_f32_16x16x32_bf16 v[80:83], v[176:179], v[228:231], v[80:83]
  ds_read_b64_tr_b16 v[208:209], v30 offset:4096
  ds_read_b64_tr_b16 v[210:211], v30 offset:4608
  v_mfma_f32_16x16x32_bf16 v[84:87], v[180:183], v[228:231], v[84:87]
  v_mfma_f32_16x16x32_bf16 v[88:91], v[184:187], v[228:231], v[88:91]
  v_mfma_f32_16x16x32_bf16 v[92:95], v[188:191], v[228:231], v[92:95]
  s_waitcnt lgkmcnt(4)
  v_mfma_f32_16x16x32_bf16 v[64:67], v[192:195], v[232:235], v[64:67]
  ds_read_b64_tr_b16 v[212:213], v31 offset:4096
  ds_read_b64_tr_b16 v[214:215], v31 offset:4608
  v_cvt_pk_bf16_f32 v32, v32, v33
  v_cvt_pk_bf16_f32 v33, v34, v35
  v_cvt_pk_bf16_f32 v34, v48, v49
  v_mfma_f32_16x16x32_bf16 v[68:71], v[196:199], v[232:235], v[68:71]
  v_cvt_pk_bf16_f32 v35, v50, v51
  buffer_store_dwordx4 v[32:35], v17, s[40:43], s29 offen offset:0 sc0 sc1
  ds_write_b128 v17, v[32:35] offset:0
  v_mfma_f32_16x16x32_bf16 v[72:75], v[200:203], v[232:235], v[72:75]
  v_cvt_pk_bf16_f32 v36, v36, v37
  v_cvt_pk_bf16_f32 v37, v38, v39
  v_cvt_pk_bf16_f32 v38, v52, v53
  v_mfma_f32_16x16x32_bf16 v[76:79], v[204:207], v[232:235], v[76:79]
  v_cvt_pk_bf16_f32 v39, v54, v55
  buffer_store_dwordx4 v[36:39], v17, s[40:43], s29 offen offset:128 sc0 sc1
  ds_write_b128 v17, v[36:39] offset:128
  s_waitcnt lgkmcnt(6)
  v_mfma_f32_16x16x32_bf16 v[80:83], v[192:195], v[236:239], v[80:83]
  ds_read_b64_tr_b16 v[216:217], v30 offset:0
  ds_read_b64_tr_b16 v[218:219], v30 offset:512
  v_cvt_pk_bf16_f32 v40, v40, v41
  v_cvt_pk_bf16_f32 v41, v42, v43
  v_cvt_pk_bf16_f32 v42, v56, v57
  v_mfma_f32_16x16x32_bf16 v[84:87], v[196:199], v[236:239], v[84:87]
  v_cvt_pk_bf16_f32 v43, v58, v59
  buffer_store_dwordx4 v[40:43], v17, s[40:43], s29 offen offset:2048 sc0 sc1
  ds_write_b128 v17, v[40:43] offset:2048
  v_mfma_f32_16x16x32_bf16 v[88:91], v[200:203], v[236:239], v[88:91]
  v_cvt_pk_bf16_f32 v44, v44, v45
  v_cvt_pk_bf16_f32 v45, v46, v47
  v_cvt_pk_bf16_f32 v46, v60, v61
  v_mfma_f32_16x16x32_bf16 v[92:95], v[204:207], v[236:239], v[92:95]
  v_cvt_pk_bf16_f32 v47, v62, v63
  buffer_store_dwordx4 v[44:47], v17, s[40:43], s29 offen offset:2176 sc0 sc1
  ds_write_b128 v17, v[44:47] offset:2176
  s_waitcnt lgkmcnt(8)
  v_mfma_f32_16x16x32_bf16 v[96:99], v[208:211], v[192:195], v[96:99]
  ds_read_b64_tr_b16 v[220:221], v31 offset:0
  ds_read_b64_tr_b16 v[222:223], v31 offset:512
  v_mfma_f32_16x16x32_bf16 v[100:103], v[208:211], v[196:199], v[100:103]
  v_mfma_f32_16x16x32_bf16 v[104:107], v[208:211], v[200:203], v[104:107]
  v_mfma_f32_16x16x32_bf16 v[108:111], v[208:211], v[204:207], v[108:111]
  s_waitcnt lgkmcnt(8)
  v_mfma_f32_16x16x32_bf16 v[112:115], v[212:215], v[192:195], v[112:115]
  ds_read_b64_tr_b16 v[224:225], v26 offset:4096
  ds_read_b64_tr_b16 v[226:227], v26 offset:4608
  v_mfma_f32_16x16x32_bf16 v[116:119], v[212:215], v[196:199], v[116:119]
  v_mfma_f32_16x16x32_bf16 v[120:123], v[212:215], v[200:203], v[120:123]
  v_mfma_f32_16x16x32_bf16 v[124:127], v[212:215], v[204:207], v[124:127]
  s_waitcnt lgkmcnt(6)
  v_mfma_f32_16x16x32_bf16 v[96:99], v[216:219], v[176:179], v[96:99]
  ds_read_b128 v[192:195], v24 offset:0
  ds_read_b128 v[196:199], v24 offset:2048
  v_mul_f32 v64, s31, v64
  v_mul_f32 v65, s31, v65
  v_mul_f32 v66, s31, v66
  v_mfma_f32_16x16x32_bf16 v[100:103], v[216:219], v[180:183], v[100:103]
  ds_read_b128 v[200:203], v24 offset:4096
  ds_read_b128 v[204:207], v24 offset:6144
  v_mul_f32 v67, s31, v67
  v_cvt_pk_bf16_f32 v64, v64, v65
  v_cvt_pk_bf16_f32 v65, v66, v67
  v_mfma_f32_16x16x32_bf16 v[104:107], v[216:219], v[184:187], v[104:107]
  ds_read_b64_tr_b16 v[228:229], v27 offset:4096
  ds_read_b64_tr_b16 v[230:231], v27 offset:4608
  v_mul_f32 v68, s31, v68
  v_mul_f32 v69, s31, v69
  v_mul_f32 v70, s31, v70
  v_mfma_f32_16x16x32_bf16 v[108:111], v[216:219], v[188:191], v[108:111]
  v_mul_f32 v71, s31, v71
  v_cvt_pk_bf16_f32 v66, v68, v69
  v_cvt_pk_bf16_f32 v67, v70, v71
  s_waitcnt lgkmcnt(8)
  v_mfma_f32_16x16x32_bf16 v[112:115], v[220:223], v[176:179], v[112:115]
  ds_read_b64_tr_b16 v[232:233], v26 offset:0
  ds_read_b64_tr_b16 v[234:235], v26 offset:512
  buffer_store_dwordx4 v[64:67], v18, s[40:43], s30 offen offset:0 sc0 sc1
  ds_write_b128 v18, v[64:67] offset:8192
  v_mul_f32 v80, s31, v80
  v_mfma_f32_16x16x32_bf16 v[116:119], v[220:223], v[180:183], v[116:119]
  v_mul_f32 v81, s31, v81
  v_mul_f32 v82, s31, v82
  v_mul_f32 v83, s31, v83
  v_mfma_f32_16x16x32_bf16 v[120:123], v[220:223], v[184:187], v[120:123]
  v_cvt_pk_bf16_f32 v80, v80, v81
  v_cvt_pk_bf16_f32 v81, v82, v83
  v_mul_f32 v84, s31, v84
  v_mfma_f32_16x16x32_bf16 v[124:127], v[220:223], v[188:191], v[124:127]
  v_mul_f32 v85, s31, v85
  v_mul_f32 v86, s31, v86
  v_mul_f32 v87, s31, v87
  s_waitcnt lgkmcnt(9)
  v_mfma_f32_16x16x32_bf16 v[96:99], v[224:227], v[160:163], v[96:99]
  ds_read_b128 v[176:179], v14 offset:0
  ds_read_b128 v[180:183], v14 offset:2048
  v_cvt_pk_bf16_f32 v82, v84, v85
  v_cvt_pk_bf16_f32 v83, v86, v87
  buffer_store_dwordx4 v[80:83], v18, s[40:43], s30 offen offset:256 sc0 sc1
  v_mfma_f32_16x16x32_bf16 v[100:103], v[224:227], v[164:167], v[100:103]
  ds_read_b128 v[184:187], v14 offset:4096
  ds_read_b128 v[188:191], v14 offset:6144
  ds_write_b128 v18, v[80:83] offset:8448
  v_mul_f32 v72, s31, v72
  v_mul_f32 v73, s31, v73
  v_mfma_f32_16x16x32_bf16 v[104:107], v[224:227], v[168:171], v[104:107]
  ds_read_b64_tr_b16 v[236:237], v27 offset:0
  s_waitcnt lgkmcnt(14)
  ds_read_b64_tr_b16 v[238:239], v27 offset:512
  v_mul_f32 v74, s31, v74
  v_mul_f32 v75, s31, v75
  v_cvt_pk_bf16_f32 v72, v72, v73
  v_mfma_f32_16x16x32_bf16 v[108:111], v[224:227], v[172:175], v[108:111]
  v_cvt_pk_bf16_f32 v73, v74, v75
  v_mul_f32 v76, s31, v76
  v_mul_f32 v77, s31, v77
  s_waitcnt lgkmcnt(10)
  v_mfma_f32_16x16x32_bf16 v[112:115], v[228:231], v[160:163], v[112:115]
  ds_read_b64_tr_b16 v[208:209], v5 offset:4096
  ds_read_b64_tr_b16 v[210:211], v5 offset:4608
  v_mul_f32 v78, s31, v78
  v_mul_f32 v79, s31, v79
  v_cvt_pk_bf16_f32 v74, v76, v77
  v_mfma_f32_16x16x32_bf16 v[116:119], v[228:231], v[164:167], v[116:119]
  v_cvt_pk_bf16_f32 v75, v78, v79
  buffer_store_dwordx4 v[72:75], v18, s[40:43], s30 offen offset:2048 sc0 sc1
  ds_write_b128 v18, v[72:75] offset:10240
  v_mfma_f32_16x16x32_bf16 v[120:123], v[228:231], v[168:171], v[120:123]
  v_mul_f32 v88, s31, v88
  v_mul_f32 v89, s31, v89
  v_mul_f32 v90, s31, v90
  v_mfma_f32_16x16x32_bf16 v[124:127], v[228:231], v[172:175], v[124:127]
  v_mul_f32 v91, s31, v91
  v_cvt_pk_bf16_f32 v88, v88, v89
  v_cvt_pk_bf16_f32 v89, v90, v91
  s_waitcnt lgkmcnt(11)
  v_mfma_f32_16x16x32_bf16 v[96:99], v[232:235], v[192:195], v[96:99]
  ds_read_b128 v[160:163], v3 offset:0
  ds_read_b128 v[164:167], v3 offset:2048
  v_mul_f32 v92, s31, v92
  v_mul_f32 v93, s31, v93
  v_mul_f32 v94, s31, v94
  v_mfma_f32_16x16x32_bf16 v[100:103], v[232:235], v[196:199], v[100:103]
  ds_read_b128 v[168:171], v3 offset:4096
  ds_read_b128 v[172:175], v3 offset:6144
  v_mul_f32 v95, s31, v95
  v_cvt_pk_bf16_f32 v90, v92, v93
  v_cvt_pk_bf16_f32 v91, v94, v95
  v_mfma_f32_16x16x32_bf16 v[104:107], v[232:235], v[200:203], v[104:107]
  s_waitcnt lgkmcnt(14)
  ds_read_b64_tr_b16 v[212:213], v11 offset:4096
  s_waitcnt lgkmcnt(14)
  ds_read_b64_tr_b16 v[214:215], v11 offset:4608
  buffer_store_dwordx4 v[88:91], v18, s[40:43], s30 offen offset:2304 sc0 sc1
  s_waitcnt lgkmcnt(14)
  ds_write_b128 v18, v[88:91] offset:10496
  v_mfma_f32_16x16x32_bf16 v[108:111], v[232:235], v[204:207], v[108:111]
  s_waitcnt lgkmcnt(10)
  v_mfma_f32_16x16x32_bf16 v[112:115], v[236:239], v[192:195], v[112:115]
  ds_read_b64_tr_b16 v[216:217], v5 offset:0
  ds_read_b64_tr_b16 v[218:219], v5 offset:512
  v_mfma_f32_16x16x32_bf16 v[116:119], v[236:239], v[196:199], v[116:119]
  v_mfma_f32_16x16x32_bf16 v[120:123], v[236:239], v[200:203], v[120:123]
  v_mfma_f32_16x16x32_bf16 v[124:127], v[236:239], v[204:207], v[124:127]
  s_waitcnt lgkmcnt(10)
  v_mfma_f32_16x16x32_bf16 v[96:99], v[208:211], v[176:179], v[96:99]
  ds_read_b64_tr_b16 v[220:221], v11 offset:0
  ds_read_b64_tr_b16 v[222:223], v11 offset:512
  v_mfma_f32_16x16x32_bf16 v[100:103], v[208:211], v[180:183], v[100:103]
  v_mfma_f32_16x16x32_bf16 v[104:107], v[208:211], v[184:187], v[104:107]
  v_mfma_f32_16x16x32_bf16 v[108:111], v[208:211], v[188:191], v[108:111]
  s_waitcnt lgkmcnt(5)
  v_mfma_f32_16x16x32_bf16 v[112:115], v[212:215], v[176:179], v[112:115]
  v_mfma_f32_16x16x32_bf16 v[116:119], v[212:215], v[180:183], v[116:119]
  v_mfma_f32_16x16x32_bf16 v[120:123], v[212:215], v[184:187], v[120:123]
  v_mfma_f32_16x16x32_bf16 v[124:127], v[212:215], v[188:191], v[124:127]
  s_waitcnt lgkmcnt(2)
  v_mfma_f32_16x16x32_bf16 v[96:99], v[216:219], v[160:163], v[96:99]
  v_mfma_f32_16x16x32_bf16 v[100:103], v[216:219], v[164:167], v[100:103]
  v_mfma_f32_16x16x32_bf16 v[104:107], v[216:219], v[168:171], v[104:107]
  v_mfma_f32_16x16x32_bf16 v[108:111], v[216:219], v[172:175], v[108:111]
  s_waitcnt lgkmcnt(0)
  v_mfma_f32_16x16x32_bf16 v[112:115], v[220:223], v[160:163], v[112:115]
  v_mfma_f32_16x16x32_bf16 v[116:119], v[220:223], v[164:167], v[116:119]
  v_mfma_f32_16x16x32_bf16 v[120:123], v[220:223], v[168:171], v[120:123]
  v_mfma_f32_16x16x32_bf16 v[124:127], v[220:223], v[172:175], v[124:127]
  s_nop 7
  v_mul_f32 v96, s32, v96
  v_mul_f32 v97, s32, v97
  v_mul_f32 v98, s32, v98
  v_mul_f32 v99, s32, v99
  v_cvt_pk_bf16_f32 v176, v96, v97
  v_cvt_pk_bf16_f32 v177, v98, v99
  v_mul_f32 v112, s32, v112
  v_mul_f32 v113, s32, v113
  v_mul_f32 v114, s32, v114
  v_mul_f32 v115, s32, v115
  v_cvt_pk_bf16_f32 v178, v112, v113
  v_cvt_pk_bf16_f32 v179, v114, v115
  v_mul_f32 v100, s32, v100
  v_mul_f32 v101, s32, v101
  v_mul_f32 v102, s32, v102
  v_mul_f32 v103, s32, v103
  v_cvt_pk_bf16_f32 v180, v100, v101
  v_cvt_pk_bf16_f32 v181, v102, v103
  v_mul_f32 v116, s32, v116
  v_mul_f32 v117, s32, v117
  v_mul_f32 v118, s32, v118
  v_mul_f32 v119, s32, v119
  v_cvt_pk_bf16_f32 v182, v116, v117
  v_cvt_pk_bf16_f32 v183, v118, v119
  v_mul_f32 v104, s32, v104
  v_mul_f32 v105, s32, v105
  v_mul_f32 v106, s32, v106
  v_mul_f32 v107, s32, v107
  v_cvt_pk_bf16_f32 v184, v104, v105
  v_cvt_pk_bf16_f32 v185, v106, v107
  v_mul_f32 v120, s32, v120
  v_mul_f32 v121, s32, v121
  v_mul_f32 v122, s32, v122
  v_mul_f32 v123, s32, v123
  v_cvt_pk_bf16_f32 v186, v120, v121
  v_cvt_pk_bf16_f32 v187, v122, v123
  v_mul_f32 v108, s32, v108
  v_mul_f32 v109, s32, v109
  v_mul_f32 v110, s32, v110
  v_mul_f32 v111, s32, v111
  v_cvt_pk_bf16_f32 v188, v108, v109
  v_cvt_pk_bf16_f32 v189, v110, v111
  v_mul_f32 v124, s32, v124
  v_mul_f32 v125, s32, v125
  v_mul_f32 v126, s32, v126
  v_mul_f32 v127, s32, v127
  v_cvt_pk_bf16_f32 v190, v124, v125
  v_cvt_pk_bf16_f32 v191, v126, v127
  s_nop 1
  v_permlane16_swap_b32 v176, v180
  v_permlane16_swap_b32 v177, v181
  v_permlane16_swap_b32 v178, v182
  v_permlane16_swap_b32 v179, v183
  v_permlane16_swap_b32 v184, v188
  v_permlane16_swap_b32 v185, v189
  v_permlane16_swap_b32 v186, v190
  v_permlane16_swap_b32 v187, v191
  v_permlane32_swap_b32 v176, v180
  v_permlane32_swap_b32 v177, v181
  v_permlane32_swap_b32 v178, v182
  v_permlane32_swap_b32 v179, v183
  v_permlane32_swap_b32 v184, v188
  v_permlane32_swap_b32 v185, v189
  v_permlane32_swap_b32 v186, v190
  v_permlane32_swap_b32 v187, v191
  s_setprio 0
  v_lshlrev_b32 v2, 4, v0
  s_and_b32 s20, s24, 1
  s_lshl_b32 s21, s20, 14
  v_add_u32 v5, s21, v2
  s_waitcnt lgkmcnt(0)
  s_barrier
  s_add_u32 s12, s6, 0x1100000
  s_addc_u32 s13, s7, 0
  s_mov_b32 s14, 0x400000
  s_mov_b32 s15, 0x20000
  v_and_b32 v7, 7, v0
  v_bfe_u32 v6, v0, 4, 1
  v_lshlrev_b32 v6, 2, v6
  v_cmp_eq_u32 vcc, v7, v6
  v_mov_b32 v7, 0x3f803f80
  s_nop 0
  v_cndmask_b32 v224, 0, v7, vcc
  v_mov_b32 v225, v224
  v_mov_b32 v226, v224
  v_mov_b32 v227, v224
  v_mov_b32 v64, 0
  v_mov_b32 v65, 0
  v_mov_b32 v66, 0
  v_mov_b32 v67, 0
  v_mov_b32 v68, 0
  v_mov_b32 v69, 0
  v_mov_b32 v70, 0
  v_mov_b32 v71, 0
  v_mov_b32 v72, 0
  v_mov_b32 v73, 0
  v_mov_b32 v74, 0
  v_mov_b32 v75, 0
  v_mov_b32 v76, 0
  v_mov_b32 v77, 0
  v_mov_b32 v78, 0
  v_mov_b32 v79, 0
  v_mov_b32 v128, 0
  v_mov_b32 v129, 0
  v_mov_b32 v130, 0
  v_mov_b32 v131, 0
  v_mov_b32 v228, 0xff61b1e6
  v_mov_b32 v96, 0
  v_mov_b32 v97, 0
  v_mov_b32 v98, 0
  v_mov_b32 v99, 0
  v_mov_b32 v100, 0
  v_mov_b32 v101, 0
  v_mov_b32 v102, 0
  v_mov_b32 v103, 0
  v_mov_b32 v104, 0
  v_mov_b32 v105, 0
  v_mov_b32 v106, 0
  v_mov_b32 v107, 0
  v_mov_b32 v108, 0
  v_mov_b32 v109, 0
  v_mov_b32 v110, 0
  v_mov_b32 v111, 0
  v_mov_b32 v136, 0
  v_mov_b32 v137, 0
  v_mov_b32 v138, 0
  v_mov_b32 v139, 0
  v_mov_b32 v229, 0xff61b1e6
  s_mov_b32 s32, 0x43800000
  s_mov_b32 s33, 32768
  s_mov_b32 s34, 0
  s_mov_b32 s37, 1
  s_waitcnt vmcnt(0)
  v_mov_b32 v234, 32832
  v_mov_b32 v235, 1
  s_mov_b64 exec, 1
  ds_add_rtn_u32 v236, v234, v235
  s_mov_b64 exec, -1
  s_lshl_b32 s29, s23, 8
  s_add_u32 s29, s29, 667648
  s_waitcnt lgkmcnt(0)
  v_readfirstlane_b32 s30, v236
  s_nop 3
  s_cmp_lg_u32 s30, 3
  s_cbranch_scc1 .Lattn_kernel_nolast_21
  v_mov_b32 v234, 0
  v_mov_b32 v235, 1
  s_mov_b64 exec, 1
  buffer_atomic_add v235, v234, s[16:19], s29 offen sc1
  s_mov_b64 exec, -1
.Lattn_kernel_nolast_21:
  s_branch .Lattn_kernel_slow0_19
.Lattn_kernel_loop_22:
  s_add_u32 s33, s33, 32768
  s_and_b32 s33, s33, 131071
  v_cmp_nge_f32 vcc, s32, v128
  v_cmp_nge_f32 s[50:51], s32, v136
  s_or_b64 vcc, vcc, s[50:51]
  s_cbranch_scc1 .Lattn_kernel_slow1_20
.Lattn_kernel_e0_17:
  s_waitcnt lgkmcnt(4)
  v_mfma_f32_32x32x16_bf16 v[16:31], v[200:203], v[176:179], v[144:159]
  v_exp_f32 v32, v32
  v_exp_f32 v33, v33
  v_exp_f32 v34, v34
  v_mfma_f32_32x32x16_bf16 v[80:95], v[208:211], v[48:51], v[64:79]
  v_exp_f32 v35, v35
  v_exp_f32 v36, v36
  v_cvt_pk_bf16_f32 v56, v32, v33
  v_exp_f32 v37, v37
  v_mfma_f32_32x32x16_bf16 v[16:31], v[204:207], v[180:183], v[16:31]
  v_exp_f32 v38, v38
  v_cvt_pk_bf16_f32 v57, v34, v35
  v_exp_f32 v39, v39
  v_cvt_pk_bf16_f32 v58, v36, v37
  v_mfma_f32_16x16x32_bf16 v[132:135], v[224:227], v[48:51], v[128:131]
  v_exp_f32 v40, v40
  v_exp_f32 v41, v41
  v_mfma_f32_32x32x16_bf16 v[80:95], v[212:215], v[52:55], v[80:95]
  v_cvt_pk_bf16_f32 v59, v38, v39
  v_exp_f32 v42, v42
  v_exp_f32 v43, v43
  v_cvt_pk_bf16_f32 v60, v40, v41
  v_exp_f32 v44, v44
  v_mfma_f32_16x16x32_bf16 v[132:135], v[224:227], v[52:55], v[132:135]
  v_exp_f32 v45, v45
  v_cvt_pk_bf16_f32 v61, v42, v43
  v_exp_f32 v46, v46
  v_exp_f32 v47, v47
  v_cvt_pk_bf16_f32 v62, v44, v45
  v_cvt_pk_bf16_f32 v63, v46, v47
  v_mfma_f32_32x32x16_bf16 v[32:47], v[200:203], v[184:187], v[160:175]
  v_exp_f32 v16, v16
  v_exp_f32 v17, v17
  v_exp_f32 v18, v18
  v_mfma_f32_32x32x16_bf16 v[112:127], v[208:211], v[56:59], v[96:111]
  v_exp_f32 v19, v19
  v_exp_f32 v20, v20
  v_cvt_pk_bf16_f32 v48, v16, v17
  v_exp_f32 v21, v21
  v_mfma_f32_32x32x16_bf16 v[32:47], v[204:207], v[188:191], v[32:47]
  ds_read_b128 v[200:203], v3 offset:6144
  ds_read_b128 v[204:207], v3 offset:7168
  v_exp_f32 v22, v22
  v_cvt_pk_bf16_f32 v49, v18, v19
  v_exp_f32 v23, v23
  v_cvt_pk_bf16_f32 v50, v20, v21
  v_mfma_f32_16x16x32_bf16 v[140:143], v[224:227], v[56:59], v[136:139]
  v_exp_f32 v24, v24
  v_exp_f32 v25, v25
  v_mfma_f32_32x32x16_bf16 v[112:127], v[212:215], v[60:63], v[112:127]
  ds_read_b128 v[208:211], v4 offset:12288
  ds_read_b128 v[212:215], v4 offset:13312
  v_cvt_pk_bf16_f32 v51, v22, v23
  v_exp_f32 v26, v26
  v_exp_f32 v27, v27
  v_cvt_pk_bf16_f32 v52, v24, v25
  v_exp_f32 v28, v28
  v_mfma_f32_16x16x32_bf16 v[140:143], v[224:227], v[60:63], v[140:143]
  v_exp_f32 v29, v29
  v_cvt_pk_bf16_f32 v53, v26, v27
  v_exp_f32 v30, v30
  v_exp_f32 v31, v31
  v_cvt_pk_bf16_f32 v54, v28, v29
  v_cvt_pk_bf16_f32 v55, v30, v31
  s_waitcnt lgkmcnt(4)
  v_mfma_f32_32x32x16_bf16 v[16:31], v[192:195], v[176:179], v[144:159]
  v_exp_f32 v32, v32
  v_exp_f32 v33, v33
  v_exp_f32 v34, v34
  v_mfma_f32_32x32x16_bf16 v[80:95], v[216:219], v[48:51], v[80:95]
  v_exp_f32 v35, v35
  v_exp_f32 v36, v36
  v_cvt_pk_bf16_f32 v56, v32, v33
  v_exp_f32 v37, v37
  v_mfma_f32_32x32x16_bf16 v[16:31], v[196:199], v[180:183], v[16:31]
  v_exp_f32 v38, v38
  v_cvt_pk_bf16_f32 v57, v34, v35
  v_exp_f32 v39, v39
  v_cvt_pk_bf16_f32 v58, v36, v37
  v_mfma_f32_16x16x32_bf16 v[132:135], v[224:227], v[48:51], v[132:135]
  v_exp_f32 v40, v40
  v_exp_f32 v41, v41
  v_mfma_f32_32x32x16_bf16 v[80:95], v[220:223], v[52:55], v[80:95]
  v_cvt_pk_bf16_f32 v59, v38, v39
  v_exp_f32 v42, v42
  v_exp_f32 v43, v43
  v_cvt_pk_bf16_f32 v60, v40, v41
  v_exp_f32 v44, v44
  v_mfma_f32_16x16x32_bf16 v[132:135], v[224:227], v[52:55], v[132:135]
  v_exp_f32 v45, v45
  v_cvt_pk_bf16_f32 v61, v42, v43
  v_exp_f32 v46, v46
  v_exp_f32 v47, v47
  v_cvt_pk_bf16_f32 v62, v44, v45
  v_cvt_pk_bf16_f32 v63, v46, v47
  v_mfma_f32_32x32x16_bf16 v[32:47], v[192:195], v[184:187], v[160:175]
  v_exp_f32 v16, v16
  v_exp_f32 v17, v17
  v_exp_f32 v18, v18
  v_mfma_f32_32x32x16_bf16 v[112:127], v[216:219], v[56:59], v[112:127]
  v_exp_f32 v19, v19
  v_exp_f32 v20, v20
  v_cvt_pk_bf16_f32 v48, v16, v17
  v_exp_f32 v21, v21
  v_mfma_f32_32x32x16_bf16 v[32:47], v[196:199], v[188:191], v[32:47]
  v_add_u32 v3, 32768, v3
  v_and_b32 v3, 131071, v3
  s_barrier
  ds_read_b128 v[192:195], v3 offset:0
  ds_read_b128 v[196:199], v3 offset:1024
  v_exp_f32 v22, v22
  v_cvt_pk_bf16_f32 v49, v18, v19
  v_exp_f32 v23, v23
  v_cvt_pk_bf16_f32 v50, v20, v21
  v_mfma_f32_16x16x32_bf16 v[140:143], v[224:227], v[56:59], v[140:143]
  v_exp_f32 v24, v24
  v_exp_f32 v25, v25
  v_mfma_f32_32x32x16_bf16 v[112:127], v[220:223], v[60:63], v[112:127]
  ds_read_b128 v[216:219], v4 offset:14336
  ds_read_b128 v[220:223], v4 offset:15360
  v_cvt_pk_bf16_f32 v51, v22, v23
  v_exp_f32 v26, v26
  v_exp_f32 v27, v27
  v_cvt_pk_bf16_f32 v52, v24, v25
  v_exp_f32 v28, v28
  v_mfma_f32_16x16x32_bf16 v[140:143], v[224:227], v[60:63], v[140:143]
  v_exp_f32 v29, v29
  v_cvt_pk_bf16_f32 v53, v26, v27
  v_exp_f32 v30, v30
  v_exp_f32 v31, v31
  v_cvt_pk_bf16_f32 v54, v28, v29
  v_cvt_pk_bf16_f32 v55, v30, v31
  s_waitcnt lgkmcnt(4)
  v_mfma_f32_32x32x16_bf16 v[16:31], v[200:203], v[176:179], v[144:159]
  v_exp_f32 v32, v32
  v_exp_f32 v33, v33
  v_exp_f32 v34, v34
  v_mfma_f32_32x32x16_bf16 v[80:95], v[208:211], v[48:51], v[80:95]
  v_exp_f32 v35, v35
  v_exp_f32 v36, v36
  v_cvt_pk_bf16_f32 v56, v32, v33
  v_exp_f32 v37, v37
  v_mfma_f32_32x32x16_bf16 v[16:31], v[204:207], v[180:183], v[16:31]
  v_exp_f32 v38, v38
  v_cvt_pk_bf16_f32 v57, v34, v35
  v_exp_f32 v39, v39
  v_cvt_pk_bf16_f32 v58, v36, v37
  v_mfma_f32_16x16x32_bf16 v[132:135], v[224:227], v[48:51], v[132:135]
  v_exp_f32 v40, v40
  v_exp_f32 v41, v41
  v_mfma_f32_32x32x16_bf16 v[80:95], v[212:215], v[52:55], v[80:95]
  v_cvt_pk_bf16_f32 v59, v38, v39
  v_exp_f32 v42, v42
  v_exp_f32 v43, v43
  v_cvt_pk_bf16_f32 v60, v40, v41
  v_exp_f32 v44, v44
  v_mfma_f32_16x16x32_bf16 v[132:135], v[224:227], v[52:55], v[132:135]
  v_exp_f32 v45, v45
  v_cvt_pk_bf16_f32 v61, v42, v43
  v_exp_f32 v46, v46
  v_exp_f32 v47, v47
  v_cvt_pk_bf16_f32 v62, v44, v45
  v_cvt_pk_bf16_f32 v63, v46, v47
  v_mfma_f32_32x32x16_bf16 v[32:47], v[200:203], v[184:187], v[160:175]
  v_exp_f32 v16, v16
  v_exp_f32 v17, v17
  v_exp_f32 v18, v18
  v_mfma_f32_32x32x16_bf16 v[112:127], v[208:211], v[56:59], v[112:127]
  v_exp_f32 v19, v19
  v_exp_f32 v20, v20
  v_cvt_pk_bf16_f32 v48, v16, v17
  v_exp_f32 v21, v21
  v_mfma_f32_32x32x16_bf16 v[32:47], v[204:207], v[188:191], v[32:47]
  ds_read_b128 v[200:203], v3 offset:2048
  ds_read_b128 v[204:207], v3 offset:3072
  v_exp_f32 v22, v22
  v_cvt_pk_bf16_f32 v49, v18, v19
  v_exp_f32 v23, v23
  v_cvt_pk_bf16_f32 v50, v20, v21
  v_mfma_f32_16x16x32_bf16 v[140:143], v[224:227], v[56:59], v[140:143]
  v_exp_f32 v24, v24
  v_exp_f32 v25, v25
  v_mfma_f32_32x32x16_bf16 v[112:127], v[212:215], v[60:63], v[112:127]
  v_add_u32 v4, 32768, v4
  v_and_b32 v4, 131071, v4
  ds_read_b128 v[208:211], v4 offset:8192
  ds_read_b128 v[212:215], v4 offset:9216
  v_cvt_pk_bf16_f32 v51, v22, v23
  v_exp_f32 v26, v26
  v_exp_f32 v27, v27
  v_cvt_pk_bf16_f32 v52, v24, v25
  v_exp_f32 v28, v28
  v_mfma_f32_16x16x32_bf16 v[140:143], v[224:227], v[60:63], v[140:143]
  v_exp_f32 v29, v29
  v_cvt_pk_bf16_f32 v53, v26, v27
  v_exp_f32 v30, v30
  v_exp_f32 v31, v31
  v_cvt_pk_bf16_f32 v54, v28, v29
  v_cvt_pk_bf16_f32 v55, v30, v31
  s_waitcnt lgkmcnt(4)
  v_mfma_f32_32x32x16_bf16 v[16:31], v[192:195], v[176:179], v[144:159]
  v_exp_f32 v32, v32
  v_exp_f32 v33, v33
  v_exp_f32 v34, v34
  v_mfma_f32_32x32x16_bf16 v[80:95], v[216:219], v[48:51], v[80:95]
  v_exp_f32 v35, v35
  v_exp_f32 v36, v36
  v_cvt_pk_bf16_f32 v56, v32, v33
  v_exp_f32 v37, v37
  v_mfma_f32_32x32x16_bf16 v[16:31], v[196:199], v[180:183], v[16:31]
  v_exp_f32 v38, v38
  v_cvt_pk_bf16_f32 v57, v34, v35
  v_exp_f32 v39, v39
  v_cvt_pk_bf16_f32 v58, v36, v37
  v_mfma_f32_16x16x32_bf16 v[132:135], v[224:227], v[48:51], v[132:135]
  v_exp_f32 v40, v40
  v_exp_f32 v41, v41
  v_mfma_f32_32x32x16_bf16 v[80:95], v[220:223], v[52:55], v[80:95]
  v_cvt_pk_bf16_f32 v59, v38, v39
  v_exp_f32 v42, v42
  v_exp_f32 v43, v43
  v_cvt_pk_bf16_f32 v60, v40, v41
  v_exp_f32 v44, v44
  v_mfma_f32_16x16x32_bf16 v[132:135], v[224:227], v[52:55], v[132:135]
  v_exp_f32 v45, v45
  v_cvt_pk_bf16_f32 v61, v42, v43
  v_exp_f32 v46, v46
  v_exp_f32 v47, v47
  v_cvt_pk_bf16_f32 v62, v44, v45
  v_cvt_pk_bf16_f32 v63, v46, v47
  v_mfma_f32_32x32x16_bf16 v[32:47], v[192:195], v[184:187], v[160:175]
  v_exp_f32 v16, v16
  v_exp_f32 v17, v17
  v_exp_f32 v18, v18
  v_mfma_f32_32x32x16_bf16 v[112:127], v[216:219], v[56:59], v[112:127]
  v_exp_f32 v19, v19
  v_exp_f32 v20, v20
  v_cvt_pk_bf16_f32 v48, v16, v17
  v_exp_f32 v21, v21
  v_mfma_f32_32x32x16_bf16 v[32:47], v[196:199], v[188:191], v[32:47]
  ds_read_b128 v[192:195], v3 offset:4096
  ds_read_b128 v[196:199], v3 offset:5120
  v_exp_f32 v22, v22
  v_cvt_pk_bf16_f32 v49, v18, v19
  v_exp_f32 v23, v23
  v_cvt_pk_bf16_f32 v50, v20, v21
  v_mfma_f32_16x16x32_bf16 v[140:143], v[224:227], v[56:59], v[140:143]
  v_exp_f32 v24, v24
  v_exp_f32 v25, v25
  v_mfma_f32_32x32x16_bf16 v[112:127], v[220:223], v[60:63], v[112:127]
  ds_read_b128 v[216:219], v4 offset:10240
  ds_read_b128 v[220:223], v4 offset:11264
  v_cvt_pk_bf16_f32 v51, v22, v23
  v_exp_f32 v26, v26
  v_exp_f32 v27, v27
  v_cvt_pk_bf16_f32 v52, v24, v25
  v_exp_f32 v28, v28
  v_mfma_f32_16x16x32_bf16 v[140:143], v[224:227], v[60:63], v[140:143]
  v_exp_f32 v29, v29
  v_cvt_pk_bf16_f32 v53, v26, v27
  v_exp_f32 v30, v30
  v_exp_f32 v31, v31
  v_cvt_pk_bf16_f32 v54, v28, v29
  v_cvt_pk_bf16_f32 v55, v30, v31
  s_add_u32 s33, s33, 32768
  s_and_b32 s33, s33, 131071
  v_cmp_nge_f32 vcc, s32, v132
  v_cmp_nge_f32 s[50:51], s32, v140
  s_or_b64 vcc, vcc, s[50:51]
  s_cbranch_scc1 .Lattn_kernel_slow0_19
.Lattn_kernel_e1_18:
  s_waitcnt lgkmcnt(4)
  v_mfma_f32_32x32x16_bf16 v[16:31], v[200:203], v[176:179], v[144:159]
  v_exp_f32 v32, v32
  v_exp_f32 v33, v33
  v_exp_f32 v34, v34
  v_mfma_f32_32x32x16_bf16 v[64:79], v[208:211], v[48:51], v[80:95]
  v_exp_f32 v35, v35
  v_exp_f32 v36, v36
  v_cvt_pk_bf16_f32 v56, v32, v33
  v_exp_f32 v37, v37
  v_mfma_f32_32x32x16_bf16 v[16:31], v[204:207], v[180:183], v[16:31]
  v_exp_f32 v38, v38
  v_cvt_pk_bf16_f32 v57, v34, v35
  v_exp_f32 v39, v39
  v_cvt_pk_bf16_f32 v58, v36, v37
  v_mfma_f32_16x16x32_bf16 v[128:131], v[224:227], v[48:51], v[132:135]
  v_exp_f32 v40, v40
  v_exp_f32 v41, v41
  v_mfma_f32_32x32x16_bf16 v[64:79], v[212:215], v[52:55], v[64:79]
  v_cvt_pk_bf16_f32 v59, v38, v39
  v_exp_f32 v42, v42
  v_exp_f32 v43, v43
  v_cvt_pk_bf16_f32 v60, v40, v41
  v_exp_f32 v44, v44
  v_mfma_f32_16x16x32_bf16 v[128:131], v[224:227], v[52:55], v[128:131]
  v_exp_f32 v45, v45
  v_cvt_pk_bf16_f32 v61, v42, v43
  v_exp_f32 v46, v46
  v_exp_f32 v47, v47
  v_cvt_pk_bf16_f32 v62, v44, v45
  v_cvt_pk_bf16_f32 v63, v46, v47
  v_mfma_f32_32x32x16_bf16 v[32:47], v[200:203], v[184:187], v[160:175]
  v_exp_f32 v16, v16
  v_exp_f32 v17, v17
  v_exp_f32 v18, v18
  v_mfma_f32_32x32x16_bf16 v[96:111], v[208:211], v[56:59], v[112:127]
  v_exp_f32 v19, v19
  v_exp_f32 v20, v20
  v_cvt_pk_bf16_f32 v48, v16, v17
  v_exp_f32 v21, v21
  v_mfma_f32_32x32x16_bf16 v[32:47], v[204:207], v[188:191], v[32:47]
  ds_read_b128 v[200:203], v3 offset:6144
  ds_read_b128 v[204:207], v3 offset:7168
  v_exp_f32 v22, v22
  v_cvt_pk_bf16_f32 v49, v18, v19
  v_exp_f32 v23, v23
  v_cvt_pk_bf16_f32 v50, v20, v21
  v_mfma_f32_16x16x32_bf16 v[136:139], v[224:227], v[56:59], v[140:143]
  v_exp_f32 v24, v24
  v_exp_f32 v25, v25
  v_mfma_f32_32x32x16_bf16 v[96:111], v[212:215], v[60:63], v[96:111]
  ds_read_b128 v[208:211], v4 offset:12288
  ds_read_b128 v[212:215], v4 offset:13312
  v_cvt_pk_bf16_f32 v51, v22, v23
  v_exp_f32 v26, v26
  v_exp_f32 v27, v27
  v_cvt_pk_bf16_f32 v52, v24, v25
  v_exp_f32 v28, v28
  v_mfma_f32_16x16x32_bf16 v[136:139], v[224:227], v[60:63], v[136:139]
  v_exp_f32 v29, v29
  v_cvt_pk_bf16_f32 v53, v26, v27
  v_exp_f32 v30, v30
  v_exp_f32 v31, v31
  v_cvt_pk_bf16_f32 v54, v28, v29
  v_cvt_pk_bf16_f32 v55, v30, v31
  s_waitcnt lgkmcnt(4)
  v_mfma_f32_32x32x16_bf16 v[16:31], v[192:195], v[176:179], v[144:159]
  v_exp_f32 v32, v32
  v_exp_f32 v33, v33
  v_exp_f32 v34, v34
  v_mfma_f32_32x32x16_bf16 v[64:79], v[216:219], v[48:51], v[64:79]
  v_exp_f32 v35, v35
  v_exp_f32 v36, v36
  v_cvt_pk_bf16_f32 v56, v32, v33
  v_exp_f32 v37, v37
  v_mfma_f32_32x32x16_bf16 v[16:31], v[196:199], v[180:183], v[16:31]
  v_exp_f32 v38, v38
  v_cvt_pk_bf16_f32 v57, v34, v35
  v_exp_f32 v39, v39
  v_cvt_pk_bf16_f32 v58, v36, v37
  v_mfma_f32_16x16x32_bf16 v[128:131], v[224:227], v[48:51], v[128:131]
  v_exp_f32 v40, v40
  v_exp_f32 v41, v41
  v_mfma_f32_32x32x16_bf16 v[64:79], v[220:223], v[52:55], v[64:79]
  v_cvt_pk_bf16_f32 v59, v38, v39
  v_exp_f32 v42, v42
  v_exp_f32 v43, v43
  v_cvt_pk_bf16_f32 v60, v40, v41
  v_exp_f32 v44, v44
  v_mfma_f32_16x16x32_bf16 v[128:131], v[224:227], v[52:55], v[128:131]
  v_exp_f32 v45, v45
  v_cvt_pk_bf16_f32 v61, v42, v43
  v_exp_f32 v46, v46
  v_exp_f32 v47, v47
  v_cvt_pk_bf16_f32 v62, v44, v45
  v_cvt_pk_bf16_f32 v63, v46, v47
  v_mfma_f32_32x32x16_bf16 v[32:47], v[192:195], v[184:187], v[160:175]
  v_exp_f32 v16, v16
  v_exp_f32 v17, v17
  v_exp_f32 v18, v18
  v_mfma_f32_32x32x16_bf16 v[96:111], v[216:219], v[56:59], v[96:111]
  v_exp_f32 v19, v19
  v_exp_f32 v20, v20
  v_cvt_pk_bf16_f32 v48, v16, v17
  v_exp_f32 v21, v21
  v_mfma_f32_32x32x16_bf16 v[32:47], v[196:199], v[188:191], v[32:47]
  v_add_u32 v3, 32768, v3
  v_and_b32 v3, 131071, v3
  s_barrier
  ds_read_b128 v[192:195], v3 offset:0
  ds_read_b128 v[196:199], v3 offset:1024
  v_exp_f32 v22, v22
  v_cvt_pk_bf16_f32 v49, v18, v19
  v_exp_f32 v23, v23
  v_cvt_pk_bf16_f32 v50, v20, v21
  v_mfma_f32_16x16x32_bf16 v[136:139], v[224:227], v[56:59], v[136:139]
  v_exp_f32 v24, v24
  v_exp_f32 v25, v25
  v_mfma_f32_32x32x16_bf16 v[96:111], v[220:223], v[60:63], v[96:111]
  ds_read_b128 v[216:219], v4 offset:14336
  ds_read_b128 v[220:223], v4 offset:15360
  v_cvt_pk_bf16_f32 v51, v22, v23
  v_exp_f32 v26, v26
  v_exp_f32 v27, v27
  v_cvt_pk_bf16_f32 v52, v24, v25
  v_exp_f32 v28, v28
  v_mfma_f32_16x16x32_bf16 v[136:139], v[224:227], v[60:63], v[136:139]
  v_exp_f32 v29, v29
  v_cvt_pk_bf16_f32 v53, v26, v27
  v_exp_f32 v30, v30
  v_exp_f32 v31, v31
  v_cvt_pk_bf16_f32 v54, v28, v29
  v_cvt_pk_bf16_f32 v55, v30, v31
  s_waitcnt lgkmcnt(4)
  v_mfma_f32_32x32x16_bf16 v[16:31], v[200:203], v[176:179], v[144:159]
  v_exp_f32 v32, v32
  v_exp_f32 v33, v33
  v_exp_f32 v34, v34
  v_mfma_f32_32x32x16_bf16 v[64:79], v[208:211], v[48:51], v[64:79]
  v_exp_f32 v35, v35
  v_exp_f32 v36, v36
  v_cvt_pk_bf16_f32 v56, v32, v33
  v_exp_f32 v37, v37
  v_mfma_f32_32x32x16_bf16 v[16:31], v[204:207], v[180:183], v[16:31]
  v_exp_f32 v38, v38
  v_cvt_pk_bf16_f32 v57, v34, v35
  v_exp_f32 v39, v39
  v_cvt_pk_bf16_f32 v58, v36, v37
  v_mfma_f32_16x16x32_bf16 v[128:131], v[224:227], v[48:51], v[128:131]
  v_exp_f32 v40, v40
  v_exp_f32 v41, v41
  v_mfma_f32_32x32x16_bf16 v[64:79], v[212:215], v[52:55], v[64:79]
  v_cvt_pk_bf16_f32 v59, v38, v39
  v_exp_f32 v42, v42
  v_exp_f32 v43, v43
  v_cvt_pk_bf16_f32 v60, v40, v41
  v_exp_f32 v44, v44
  v_mfma_f32_16x16x32_bf16 v[128:131], v[224:227], v[52:55], v[128:131]
  v_exp_f32 v45, v45
  v_cvt_pk_bf16_f32 v61, v42, v43
  v_exp_f32 v46, v46
  v_exp_f32 v47, v47
  v_cvt_pk_bf16_f32 v62, v44, v45
  v_cvt_pk_bf16_f32 v63, v46, v47
  v_mfma_f32_32x32x16_bf16 v[32:47], v[200:203], v[184:187], v[160:175]
  v_exp_f32 v16, v16
  v_exp_f32 v17, v17
  v_exp_f32 v18, v18
  v_mfma_f32_32x32x16_bf16 v[96:111], v[208:211], v[56:59], v[96:111]
  v_exp_f32 v19, v19
  v_exp_f32 v20, v20
  v_cvt_pk_bf16_f32 v48, v16, v17
  v_exp_f32 v21, v21
  v_mfma_f32_32x32x16_bf16 v[32:47], v[204:207], v[188:191], v[32:47]
  ds_read_b128 v[200:203], v3 offset:2048
  ds_read_b128 v[204:207], v3 offset:3072
  v_exp_f32 v22, v22
  v_cvt_pk_bf16_f32 v49, v18, v19
  v_exp_f32 v23, v23
  v_cvt_pk_bf16_f32 v50, v20, v21
  v_mfma_f32_16x16x32_bf16 v[136:139], v[224:227], v[56:59], v[136:139]
  v_exp_f32 v24, v24
  v_exp_f32 v25, v25
  v_mfma_f32_32x32x16_bf16 v[96:111], v[212:215], v[60:63], v[96:111]
  v_add_u32 v4, 32768, v4
  v_and_b32 v4, 131071, v4
  ds_read_b128 v[208:211], v4 offset:8192
  ds_read_b128 v[212:215], v4 offset:9216
  v_cvt_pk_bf16_f32 v51, v22, v23
  v_exp_f32 v26, v26
  v_exp_f32 v27, v27
  v_cvt_pk_bf16_f32 v52, v24, v25
  v_exp_f32 v28, v28
  v_mfma_f32_16x16x32_bf16 v[136:139], v[224:227], v[60:63], v[136:139]
  v_exp_f32 v29, v29
  v_cvt_pk_bf16_f32 v53, v26, v27
  v_exp_f32 v30, v30
  v_exp_f32 v31, v31
  v_cvt_pk_bf16_f32 v54, v28, v29
  v_cvt_pk_bf16_f32 v55, v30, v31
  s_waitcnt lgkmcnt(4)
  v_mfma_f32_32x32x16_bf16 v[16:31], v[192:195], v[176:179], v[144:159]
  v_exp_f32 v32, v32
  v_exp_f32 v33, v33
  v_exp_f32 v34, v34
  v_mfma_f32_32x32x16_bf16 v[64:79], v[216:219], v[48:51], v[64:79]
  v_exp_f32 v35, v35
  v_exp_f32 v36, v36
  v_cvt_pk_bf16_f32 v56, v32, v33
  v_exp_f32 v37, v37
  v_mfma_f32_32x32x16_bf16 v[16:31], v[196:199], v[180:183], v[16:31]
  v_exp_f32 v38, v38
  v_cvt_pk_bf16_f32 v57, v34, v35
  v_exp_f32 v39, v39
  v_cvt_pk_bf16_f32 v58, v36, v37
  v_mfma_f32_16x16x32_bf16 v[128:131], v[224:227], v[48:51], v[128:131]
  v_exp_f32 v40, v40
  v_exp_f32 v41, v41
  v_mfma_f32_32x32x16_bf16 v[64:79], v[220:223], v[52:55], v[64:79]
  v_cvt_pk_bf16_f32 v59, v38, v39
  v_exp_f32 v42, v42
  v_exp_f32 v43, v43
  v_cvt_pk_bf16_f32 v60, v40, v41
  v_exp_f32 v44, v44
  v_mfma_f32_16x16x32_bf16 v[128:131], v[224:227], v[52:55], v[128:131]
  v_exp_f32 v45, v45
  v_cvt_pk_bf16_f32 v61, v42, v43
  v_exp_f32 v46, v46
  v_exp_f32 v47, v47
  v_cvt_pk_bf16_f32 v62, v44, v45
  v_cvt_pk_bf16_f32 v63, v46, v47
  s_cmp_eq_u32 s34, 7
  s_cbranch_scc1 .Lattn_kernel_tail_23
  v_mfma_f32_32x32x16_bf16 v[32:47], v[192:195], v[184:187], v[160:175]
  v_exp_f32 v16, v16
  v_exp_f32 v17, v17
  v_exp_f32 v18, v18
  v_mfma_f32_32x32x16_bf16 v[96:111], v[216:219], v[56:59], v[96:111]
  v_exp_f32 v19, v19
  v_exp_f32 v20, v20
  v_cvt_pk_bf16_f32 v48, v16, v17
  v_exp_f32 v21, v21
  v_mfma_f32_32x32x16_bf16 v[32:47], v[196:199], v[188:191], v[32:47]
  ds_read_b128 v[192:195], v3 offset:4096
  ds_read_b128 v[196:199], v3 offset:5120
  v_exp_f32 v22, v22
  v_cvt_pk_bf16_f32 v49, v18, v19
  v_exp_f32 v23, v23
  v_cvt_pk_bf16_f32 v50, v20, v21
  v_mfma_f32_16x16x32_bf16 v[136:139], v[224:227], v[56:59], v[136:139]
  v_exp_f32 v24, v24
  v_exp_f32 v25, v25
  v_mfma_f32_32x32x16_bf16 v[96:111], v[220:223], v[60:63], v[96:111]
  ds_read_b128 v[216:219], v4 offset:10240
  ds_read_b128 v[220:223], v4 offset:11264
  v_cvt_pk_bf16_f32 v51, v22, v23
  v_exp_f32 v26, v26
  v_exp_f32 v27, v27
  v_cvt_pk_bf16_f32 v52, v24, v25
  v_exp_f32 v28, v28
  v_mfma_f32_16x16x32_bf16 v[136:139], v[224:227], v[60:63], v[136:139]
  v_exp_f32 v29, v29
  v_cvt_pk_bf16_f32 v53, v26, v27
  v_exp_f32 v30, v30
  v_exp_f32 v31, v31
  v_cvt_pk_bf16_f32 v54, v28, v29
  v_cvt_pk_bf16_f32 v55, v30, v31
  s_add_u32 s34, s34, 1
  s_branch .Lattn_kernel_loop_22
.Lattn_kernel_tail_23:
  v_mfma_f32_16x16x32_bf16 v[136:139], v[224:227], v[56:59], v[136:139]
  v_mfma_f32_16x16x32_bf16 v[136:139], v[224:227], v[60:63], v[136:139]
  v_mfma_f32_32x32x16_bf16 v[96:111], v[216:219], v[56:59], v[96:111]
  v_mfma_f32_32x32x16_bf16 v[96:111], v[220:223], v[60:63], v[96:111]
  s_add_u32 s33, s33, 32768
  s_and_b32 s33, s33, 131071
  s_mov_b32 s34, 8
  s_waitcnt lgkmcnt(0)
  s_nop 1
  v_cmp_nge_f32 vcc, s32, v128
  v_cmp_nge_f32 s[50:51], s32, v136
  s_or_b64 vcc, vcc, s[50:51]
  s_cbranch_scc1 .Lattn_kernel_slow1_20
.Lattn_kernel_fin_24:
  v_rcp_f32 v230, v128
  v_rcp_f32 v232, v136
  s_lshl_b32 s30, s22, 18
  s_lshl_b32 s31, s23, 14
  s_add_u32 s30, s30, s31
  s_lshl_b32 s31, s20, 13
  s_add_u32 s30, s30, s31
  s_and_b32 s31, s24, 2
  s_lshl_b32 s31, s31, 10
  s_add_u32 s30, s30, s31
  s_add_u32 s31, s30, 4096
  v_mul_f32 v230, 0x2f800000, v230
  v_mul_f32 v232, 0x2f800000, v232
  v_pk_mul_f32 v[64:65], v[64:65], v[230:231] op_sel_hi:[1,0]
  v_pk_mul_f32 v[66:67], v[66:67], v[230:231] op_sel_hi:[1,0]
  v_pk_mul_f32 v[68:69], v[68:69], v[230:231] op_sel_hi:[1,0]
  v_pk_mul_f32 v[70:71], v[70:71], v[230:231] op_sel_hi:[1,0]
  v_pk_mul_f32 v[72:73], v[72:73], v[230:231] op_sel_hi:[1,0]
  v_pk_mul_f32 v[74:75], v[74:75], v[230:231] op_sel_hi:[1,0]
  v_pk_mul_f32 v[76:77], v[76:77], v[230:231] op_sel_hi:[1,0]
  v_pk_mul_f32 v[78:79], v[78:79], v[230:231] op_sel_hi:[1,0]
  v_cvt_pk_bf16_f32 v48, v64, v65
  v_cvt_pk_bf16_f32 v49, v66, v67
  v_cvt_pk_bf16_f32 v50, v68, v69
  v_cvt_pk_bf16_f32 v51, v70, v71
  v_cvt_pk_bf16_f32 v52, v72, v73
  v_cvt_pk_bf16_f32 v53, v74, v75
  v_cvt_pk_bf16_f32 v54, v76, v77
  v_cvt_pk_bf16_f32 v55, v78, v79
  buffer_store_dwordx4 v[48:51], v2, s[12:15], s30 offen offset:0 sc0 sc1
  buffer_store_dwordx4 v[52:55], v2, s[12:15], s31 offen offset:0 sc0 sc1
  v_pk_mul_f32 v[96:97], v[96:97], v[232:233] op_sel_hi:[1,0]
  v_pk_mul_f32 v[98:99], v[98:99], v[232:233] op_sel_hi:[1,0]
  v_pk_mul_f32 v[100:101], v[100:101], v[232:233] op_sel_hi:[1,0]
  v_pk_mul_f32 v[102:103], v[102:103], v[232:233] op_sel_hi:[1,0]
  v_pk_mul_f32 v[104:105], v[104:105], v[232:233] op_sel_hi:[1,0]
  v_pk_mul_f32 v[106:107], v[106:107], v[232:233] op_sel_hi:[1,0]
  v_pk_mul_f32 v[108:109], v[108:109], v[232:233] op_sel_hi:[1,0]
  v_pk_mul_f32 v[110:111], v[110:111], v[232:233] op_sel_hi:[1,0]
  v_cvt_pk_bf16_f32 v56, v96, v97
  v_cvt_pk_bf16_f32 v57, v98, v99
  v_cvt_pk_bf16_f32 v58, v100, v101
  v_cvt_pk_bf16_f32 v59, v102, v103
  v_cvt_pk_bf16_f32 v60, v104, v105
  v_cvt_pk_bf16_f32 v61, v106, v107
  v_cvt_pk_bf16_f32 v62, v108, v109
  v_cvt_pk_bf16_f32 v63, v110, v111
  buffer_store_dwordx4 v[56:59], v2, s[12:15], s30 offen offset:1024 sc0 sc1
  buffer_store_dwordx4 v[60:63], v2, s[12:15], s31 offen offset:1024 sc0 sc1
  s_load_dwordx2 s[4:5], s[0:1], 16
  s_load_dwordx2 s[36:37], s[0:1], 0
  s_load_dwordx2 s[56:57], s[0:1], 32
  s_load_dwordx2 s[58:59], s[0:1], 64
  s_load_dwordx2 s[62:63], s[0:1], 40
  v_lshlrev_b32 v1, 4, v0
  v_lshrrev_b32 v7, 5, v0
  v_and_b32 v9, 31, v0
  s_lshl_b32 s60, s22, 8
  s_add_u32 s60, s60, 679936
  s_branch .Lattn_kernel_tc_2
.Lattn_kernel_slow0_19:
  s_waitcnt lgkmcnt(0)
  s_sub_u32 s35, s33, 32768
  s_and_b32 s35, s35, 131071
  v_add_u32 v3, s35, v5
  ds_read_b128 v[192:195], v3 offset:0
  ds_read_b128 v[196:199], v3 offset:1024
  v_mov_b32 v230, 0xff61b1e6
  v_mov_b32 v232, 0xff61b1e6
  v_mov_b32 v4, v3
  s_mov_b32 s36, 0
  s_nop 15
.Lattn_kernel_p1_26:
  s_waitcnt lgkmcnt(0)
  v_mfma_f32_32x32x16_bf16 v[16:31], v[192:195], v[176:179], 0
  v_mfma_f32_32x32x16_bf16 v[16:31], v[196:199], v[180:183], v[16:31]
  v_mfma_f32_32x32x16_bf16 v[32:47], v[192:195], v[184:187], 0
  v_mfma_f32_32x32x16_bf16 v[32:47], v[196:199], v[188:191], v[32:47]
  ds_read_b128 v[192:195], v4 offset:2048
  ds_read_b128 v[196:199], v4 offset:3072
  v_add_u32 v4, 2048, v4
  s_add_u32 s36, s36, 1
  s_nop 5
  v_max3_f32 v230, v230, v16, v17
  v_max3_f32 v230, v230, v18, v19
  v_max3_f32 v230, v230, v20, v21
  v_max3_f32 v230, v230, v22, v23
  v_max3_f32 v230, v230, v24, v25
  v_max3_f32 v230, v230, v26, v27
  v_max3_f32 v230, v230, v28, v29
  v_max3_f32 v230, v230, v30, v31
  v_max3_f32 v232, v232, v32, v33
  v_max3_f32 v232, v232, v34, v35
  v_max3_f32 v232, v232, v36, v37
  v_max3_f32 v232, v232, v38, v39
  v_max3_f32 v232, v232, v40, v41
  v_max3_f32 v232, v232, v42, v43
  v_max3_f32 v232, v232, v44, v45
  v_max3_f32 v232, v232, v46, v47
  s_cmp_lt_u32 s36, 4
  s_cbranch_scc1 .Lattn_kernel_p1_26
  s_waitcnt lgkmcnt(0)
  ds_read_b128 v[192:195], v3 offset:0
  ds_read_b128 v[196:199], v3 offset:1024
  v_mov_b32 v231, v230
  s_nop 1
  v_permlane32_swap_b32 v230, v231
  s_nop 1
  v_max_f32 v230, v230, v231
  v_add_f32 v230, 0x42c00000, v230
  v_max_f32 v230, v230, v228
  v_sub_f32 v231, v228, v230
  v_exp_f32 v231, v231
  v_mov_b32 v228, v230
  v_sub_f32 v144, 0, v230
  v_mov_b32 v145, v144
  v_mov_b32 v146, v144
  v_mov_b32 v147, v144
  v_mov_b32 v148, v144
  v_mov_b32 v149, v144
  v_mov_b32 v150, v144
  v_mov_b32 v151, v144
  v_mov_b32 v152, v144
  v_mov_b32 v153, v144
  v_mov_b32 v154, v144
  v_mov_b32 v155, v144
  v_mov_b32 v156, v144
  v_mov_b32 v157, v144
  v_mov_b32 v158, v144
  v_mov_b32 v159, v144
  v_mov_b32 v233, v232
  s_nop 1
  v_permlane32_swap_b32 v232, v233
  s_nop 1
  v_max_f32 v232, v232, v233
  v_add_f32 v232, 0x42c00000, v232
  v_max_f32 v232, v232, v229
  v_sub_f32 v233, v229, v232
  v_exp_f32 v233, v233
  v_mov_b32 v229, v232
  v_sub_f32 v160, 0, v232
  v_mov_b32 v161, v160
  v_mov_b32 v162, v160
  v_mov_b32 v163, v160
  v_mov_b32 v164, v160
  v_mov_b32 v165, v160
  v_mov_b32 v166, v160
  v_mov_b32 v167, v160
  v_mov_b32 v168, v160
  v_mov_b32 v169, v160
  v_mov_b32 v170, v160
  v_mov_b32 v171, v160
  v_mov_b32 v172, v160
  v_mov_b32 v173, v160
  v_mov_b32 v174, v160
  v_mov_b32 v175, v160
  s_cmp_lg_u32 s37, 0
  s_cselect_b32 s33, 0, s33
  s_mov_b32 s37, 0
  s_waitcnt lgkmcnt(0)
  s_cbranch_scc1 .Lattn_kernel_rst1_25
  v_mul_f32 v80, v64, v231
  v_mul_f32 v81, v65, v231
  v_mul_f32 v82, v66, v231
  v_mul_f32 v83, v67, v231
  v_mul_f32 v84, v68, v231
  v_mul_f32 v85, v69, v231
  v_mul_f32 v86, v70, v231
  v_mul_f32 v87, v71, v231
  v_mul_f32 v88, v72, v231
  v_mul_f32 v89, v73, v231
  v_mul_f32 v90, v74, v231
  v_mul_f32 v91, v75, v231
  v_mul_f32 v92, v76, v231
  v_mul_f32 v93, v77, v231
  v_mul_f32 v94, v78, v231
  v_mul_f32 v95, v79, v231
  v_mul_f32 v132, v128, v231
  v_mul_f32 v133, v129, v231
  v_mul_f32 v134, v130, v231
  v_mul_f32 v135, v131, v231
  v_mul_f32 v112, v96, v233
  v_mul_f32 v113, v97, v233
  v_mul_f32 v114, v98, v233
  v_mul_f32 v115, v99, v233
  v_mul_f32 v116, v100, v233
  v_mul_f32 v117, v101, v233
  v_mul_f32 v118, v102, v233
  v_mul_f32 v119, v103, v233
  v_mul_f32 v120, v104, v233
  v_mul_f32 v121, v105, v233
  v_mul_f32 v122, v106, v233
  v_mul_f32 v123, v107, v233
  v_mul_f32 v124, v108, v233
  v_mul_f32 v125, v109, v233
  v_mul_f32 v126, v110, v233
  v_mul_f32 v127, v111, v233
  v_mul_f32 v140, v136, v233
  v_mul_f32 v141, v137, v233
  v_mul_f32 v142, v138, v233
  v_mul_f32 v143, v139, v233
  s_mov_b32 s36, 0
.Lattn_kernel_p2_27:
  s_waitcnt lgkmcnt(0)
  v_mfma_f32_32x32x16_bf16 v[16:31], v[192:195], v[176:179], v[144:159]
  v_mfma_f32_32x32x16_bf16 v[16:31], v[196:199], v[180:183], v[16:31]
  v_mfma_f32_32x32x16_bf16 v[32:47], v[192:195], v[184:187], v[160:175]
  v_mfma_f32_32x32x16_bf16 v[32:47], v[196:199], v[188:191], v[32:47]
  ds_read_b128 v[208:211], v3 offset:8192
  ds_read_b128 v[212:215], v3 offset:9216
  ds_read_b128 v[192:195], v3 offset:2048
  ds_read_b128 v[196:199], v3 offset:3072
  v_add_u32 v3, 2048, v3
  s_add_u32 s36, s36, 1
  s_nop 3
  v_exp_f32 v16, v16
  v_exp_f32 v17, v17
  v_exp_f32 v18, v18
  v_exp_f32 v19, v19
  v_exp_f32 v20, v20
  v_exp_f32 v21, v21
  v_exp_f32 v22, v22
  v_exp_f32 v23, v23
  v_exp_f32 v24, v24
  v_exp_f32 v25, v25
  v_exp_f32 v26, v26
  v_exp_f32 v27, v27
  v_exp_f32 v28, v28
  v_exp_f32 v29, v29
  v_exp_f32 v30, v30
  v_exp_f32 v31, v31
  s_nop 0
  v_cvt_pk_bf16_f32 v48, v16, v17
  v_cvt_pk_bf16_f32 v49, v18, v19
  v_cvt_pk_bf16_f32 v50, v20, v21
  v_cvt_pk_bf16_f32 v51, v22, v23
  v_cvt_pk_bf16_f32 v52, v24, v25
  v_cvt_pk_bf16_f32 v53, v26, v27
  v_cvt_pk_bf16_f32 v54, v28, v29
  v_cvt_pk_bf16_f32 v55, v30, v31
  s_waitcnt lgkmcnt(2)
  s_nop 0
  v_mfma_f32_32x32x16_bf16 v[80:95], v[208:211], v[48:51], v[80:95]
  v_mfma_f32_32x32x16_bf16 v[80:95], v[212:215], v[52:55], v[80:95]
  v_mfma_f32_16x16x32_bf16 v[132:135], v[224:227], v[48:51], v[132:135]
  v_mfma_f32_16x16x32_bf16 v[132:135], v[224:227], v[52:55], v[132:135]
  v_exp_f32 v32, v32
  v_exp_f32 v33, v33
  v_exp_f32 v34, v34
  v_exp_f32 v35, v35
  v_exp_f32 v36, v36
  v_exp_f32 v37, v37
  v_exp_f32 v38, v38
  v_exp_f32 v39, v39
  v_exp_f32 v40, v40
  v_exp_f32 v41, v41
  v_exp_f32 v42, v42
  v_exp_f32 v43, v43
  v_exp_f32 v44, v44
  v_exp_f32 v45, v45
  v_exp_f32 v46, v46
  v_exp_f32 v47, v47
  s_nop 0
  v_cvt_pk_bf16_f32 v56, v32, v33
  v_cvt_pk_bf16_f32 v57, v34, v35
  v_cvt_pk_bf16_f32 v58, v36, v37
  v_cvt_pk_bf16_f32 v59, v38, v39
  v_cvt_pk_bf16_f32 v60, v40, v41
  v_cvt_pk_bf16_f32 v61, v42, v43
  v_cvt_pk_bf16_f32 v62, v44, v45
  v_cvt_pk_bf16_f32 v63, v46, v47
  s_waitcnt lgkmcnt(2)
  s_nop 0
  v_mfma_f32_32x32x16_bf16 v[112:127], v[208:211], v[56:59], v[112:127]
  v_mfma_f32_32x32x16_bf16 v[112:127], v[212:215], v[60:63], v[112:127]
  v_mfma_f32_16x16x32_bf16 v[140:143], v[224:227], v[56:59], v[140:143]
  v_mfma_f32_16x16x32_bf16 v[140:143], v[224:227], v[60:63], v[140:143]
  s_cmp_lt_u32 s36, 4
  s_cbranch_scc1 .Lattn_kernel_p2_27
  s_waitcnt lgkmcnt(0)
  v_add_u32 v3, s33, v5
  v_add_u32 v4, s33, v5
  ds_read_b128 v[192:195], v3 offset:0
  ds_read_b128 v[196:199], v3 offset:1024
  ds_read_b128 v[200:203], v3 offset:2048
  ds_read_b128 v[204:207], v3 offset:3072
  ds_read_b128 v[208:211], v4 offset:8192
  ds_read_b128 v[212:215], v4 offset:9216
  s_waitcnt lgkmcnt(4)
  v_mfma_f32_32x32x16_bf16 v[16:31], v[192:195], v[176:179], v[144:159]
  v_mfma_f32_32x32x16_bf16 v[16:31], v[196:199], v[180:183], v[16:31]
  v_mfma_f32_32x32x16_bf16 v[32:47], v[192:195], v[184:187], v[160:175]
  v_mfma_f32_32x32x16_bf16 v[32:47], v[196:199], v[188:191], v[32:47]
  ds_read_b128 v[192:195], v3 offset:4096
  ds_read_b128 v[196:199], v3 offset:5120
  ds_read_b128 v[216:219], v4 offset:10240
  ds_read_b128 v[220:223], v4 offset:11264
  s_nop 7
  v_exp_f32 v16, v16
  v_exp_f32 v17, v17
  v_exp_f32 v18, v18
  v_exp_f32 v19, v19
  v_exp_f32 v20, v20
  v_exp_f32 v21, v21
  v_exp_f32 v22, v22
  v_exp_f32 v23, v23
  v_exp_f32 v24, v24
  v_exp_f32 v25, v25
  v_exp_f32 v26, v26
  v_exp_f32 v27, v27
  v_exp_f32 v28, v28
  v_exp_f32 v29, v29
  v_exp_f32 v30, v30
  v_exp_f32 v31, v31
  s_nop 0
  v_cvt_pk_bf16_f32 v48, v16, v17
  v_cvt_pk_bf16_f32 v49, v18, v19
  v_cvt_pk_bf16_f32 v50, v20, v21
  v_cvt_pk_bf16_f32 v51, v22, v23
  v_cvt_pk_bf16_f32 v52, v24, v25
  v_cvt_pk_bf16_f32 v53, v26, v27
  v_cvt_pk_bf16_f32 v54, v28, v29
  v_cvt_pk_bf16_f32 v55, v30, v31
  s_branch .Lattn_kernel_e1_18
.Lattn_kernel_slow1_20:
  s_waitcnt lgkmcnt(0)
  s_sub_u32 s35, s33, 32768
  s_and_b32 s35, s35, 131071
  v_add_u32 v3, s35, v5
  ds_read_b128 v[192:195], v3 offset:0
  ds_read_b128 v[196:199], v3 offset:1024
  v_mov_b32 v230, 0xff61b1e6
  v_mov_b32 v232, 0xff61b1e6
  v_mov_b32 v4, v3
  s_mov_b32 s36, 0
  s_nop 15
.Lattn_kernel_p1_28:
  s_waitcnt lgkmcnt(0)
  v_mfma_f32_32x32x16_bf16 v[16:31], v[192:195], v[176:179], 0
  v_mfma_f32_32x32x16_bf16 v[16:31], v[196:199], v[180:183], v[16:31]
  v_mfma_f32_32x32x16_bf16 v[32:47], v[192:195], v[184:187], 0
  v_mfma_f32_32x32x16_bf16 v[32:47], v[196:199], v[188:191], v[32:47]
  ds_read_b128 v[192:195], v4 offset:2048
  ds_read_b128 v[196:199], v4 offset:3072
  v_add_u32 v4, 2048, v4
  s_add_u32 s36, s36, 1
  s_nop 5
  v_max3_f32 v230, v230, v16, v17
  v_max3_f32 v230, v230, v18, v19
  v_max3_f32 v230, v230, v20, v21
  v_max3_f32 v230, v230, v22, v23
  v_max3_f32 v230, v230, v24, v25
  v_max3_f32 v230, v230, v26, v27
  v_max3_f32 v230, v230, v28, v29
  v_max3_f32 v230, v230, v30, v31
  v_max3_f32 v232, v232, v32, v33
  v_max3_f32 v232, v232, v34, v35
  v_max3_f32 v232, v232, v36, v37
  v_max3_f32 v232, v232, v38, v39
  v_max3_f32 v232, v232, v40, v41
  v_max3_f32 v232, v232, v42, v43
  v_max3_f32 v232, v232, v44, v45
  v_max3_f32 v232, v232, v46, v47
  s_cmp_lt_u32 s36, 4
  s_cbranch_scc1 .Lattn_kernel_p1_28
  s_waitcnt lgkmcnt(0)
  ds_read_b128 v[192:195], v3 offset:0
  ds_read_b128 v[196:199], v3 offset:1024
  v_mov_b32 v231, v230
  s_nop 1
  v_permlane32_swap_b32 v230, v231
  s_nop 1
  v_max_f32 v230, v230, v231
  v_add_f32 v230, 0x42c00000, v230
  v_max_f32 v230, v230, v228
  v_sub_f32 v231, v228, v230
  v_exp_f32 v231, v231
  v_mov_b32 v228, v230
  v_sub_f32 v144, 0, v230
  v_mov_b32 v145, v144
  v_mov_b32 v146, v144
  v_mov_b32 v147, v144
  v_mov_b32 v148, v144
  v_mov_b32 v149, v144
  v_mov_b32 v150, v144
  v_mov_b32 v151, v144
  v_mov_b32 v152, v144
  v_mov_b32 v153, v144
  v_mov_b32 v154, v144
  v_mov_b32 v155, v144
  v_mov_b32 v156, v144
  v_mov_b32 v157, v144
  v_mov_b32 v158, v144
  v_mov_b32 v159, v144
  v_mov_b32 v233, v232
  s_nop 1
  v_permlane32_swap_b32 v232, v233
  s_nop 1
  v_max_f32 v232, v232, v233
  v_add_f32 v232, 0x42c00000, v232
  v_max_f32 v232, v232, v229
  v_sub_f32 v233, v229, v232
  v_exp_f32 v233, v233
  v_mov_b32 v229, v232
  v_sub_f32 v160, 0, v232
  v_mov_b32 v161, v160
  v_mov_b32 v162, v160
  v_mov_b32 v163, v160
  v_mov_b32 v164, v160
  v_mov_b32 v165, v160
  v_mov_b32 v166, v160
  v_mov_b32 v167, v160
  v_mov_b32 v168, v160
  v_mov_b32 v169, v160
  v_mov_b32 v170, v160
  v_mov_b32 v171, v160
  v_mov_b32 v172, v160
  v_mov_b32 v173, v160
  v_mov_b32 v174, v160
  v_mov_b32 v175, v160
  v_mul_f32 v64, v80, v231
  v_mul_f32 v65, v81, v231
  v_mul_f32 v66, v82, v231
  v_mul_f32 v67, v83, v231
  v_mul_f32 v68, v84, v231
  v_mul_f32 v69, v85, v231
  v_mul_f32 v70, v86, v231
  v_mul_f32 v71, v87, v231
  v_mul_f32 v72, v88, v231
  v_mul_f32 v73, v89, v231
  v_mul_f32 v74, v90, v231
  v_mul_f32 v75, v91, v231
  v_mul_f32 v76, v92, v231
  v_mul_f32 v77, v93, v231
  v_mul_f32 v78, v94, v231
  v_mul_f32 v79, v95, v231
  v_mul_f32 v128, v132, v231
  v_mul_f32 v129, v133, v231
  v_mul_f32 v130, v134, v231
  v_mul_f32 v131, v135, v231
  v_mul_f32 v96, v112, v233
  v_mul_f32 v97, v113, v233
  v_mul_f32 v98, v114, v233
  v_mul_f32 v99, v115, v233
  v_mul_f32 v100, v116, v233
  v_mul_f32 v101, v117, v233
  v_mul_f32 v102, v118, v233
  v_mul_f32 v103, v119, v233
  v_mul_f32 v104, v120, v233
  v_mul_f32 v105, v121, v233
  v_mul_f32 v106, v122, v233
  v_mul_f32 v107, v123, v233
  v_mul_f32 v108, v124, v233
  v_mul_f32 v109, v125, v233
  v_mul_f32 v110, v126, v233
  v_mul_f32 v111, v127, v233
  v_mul_f32 v136, v140, v233
  v_mul_f32 v137, v141, v233
  v_mul_f32 v138, v142, v233
  v_mul_f32 v139, v143, v233
  s_mov_b32 s36, 0
.Lattn_kernel_p2_29:
  s_waitcnt lgkmcnt(0)
  v_mfma_f32_32x32x16_bf16 v[16:31], v[192:195], v[176:179], v[144:159]
  v_mfma_f32_32x32x16_bf16 v[16:31], v[196:199], v[180:183], v[16:31]
  v_mfma_f32_32x32x16_bf16 v[32:47], v[192:195], v[184:187], v[160:175]
  v_mfma_f32_32x32x16_bf16 v[32:47], v[196:199], v[188:191], v[32:47]
  ds_read_b128 v[208:211], v3 offset:8192
  ds_read_b128 v[212:215], v3 offset:9216
  ds_read_b128 v[192:195], v3 offset:2048
  ds_read_b128 v[196:199], v3 offset:3072
  v_add_u32 v3, 2048, v3
  s_add_u32 s36, s36, 1
  s_nop 3
  v_exp_f32 v16, v16
  v_exp_f32 v17, v17
  v_exp_f32 v18, v18
  v_exp_f32 v19, v19
  v_exp_f32 v20, v20
  v_exp_f32 v21, v21
  v_exp_f32 v22, v22
  v_exp_f32 v23, v23
  v_exp_f32 v24, v24
  v_exp_f32 v25, v25
  v_exp_f32 v26, v26
  v_exp_f32 v27, v27
  v_exp_f32 v28, v28
  v_exp_f32 v29, v29
  v_exp_f32 v30, v30
  v_exp_f32 v31, v31
  s_nop 0
  v_cvt_pk_bf16_f32 v48, v16, v17
  v_cvt_pk_bf16_f32 v49, v18, v19
  v_cvt_pk_bf16_f32 v50, v20, v21
  v_cvt_pk_bf16_f32 v51, v22, v23
  v_cvt_pk_bf16_f32 v52, v24, v25
  v_cvt_pk_bf16_f32 v53, v26, v27
  v_cvt_pk_bf16_f32 v54, v28, v29
  v_cvt_pk_bf16_f32 v55, v30, v31
  s_waitcnt lgkmcnt(2)
  s_nop 0
  v_mfma_f32_32x32x16_bf16 v[64:79], v[208:211], v[48:51], v[64:79]
  v_mfma_f32_32x32x16_bf16 v[64:79], v[212:215], v[52:55], v[64:79]
  v_mfma_f32_16x16x32_bf16 v[128:131], v[224:227], v[48:51], v[128:131]
  v_mfma_f32_16x16x32_bf16 v[128:131], v[224:227], v[52:55], v[128:131]
  v_exp_f32 v32, v32
  v_exp_f32 v33, v33
  v_exp_f32 v34, v34
  v_exp_f32 v35, v35
  v_exp_f32 v36, v36
  v_exp_f32 v37, v37
  v_exp_f32 v38, v38
  v_exp_f32 v39, v39
  v_exp_f32 v40, v40
  v_exp_f32 v41, v41
  v_exp_f32 v42, v42
  v_exp_f32 v43, v43
  v_exp_f32 v44, v44
  v_exp_f32 v45, v45
  v_exp_f32 v46, v46
  v_exp_f32 v47, v47
  s_nop 0
  v_cvt_pk_bf16_f32 v56, v32, v33
  v_cvt_pk_bf16_f32 v57, v34, v35
  v_cvt_pk_bf16_f32 v58, v36, v37
  v_cvt_pk_bf16_f32 v59, v38, v39
  v_cvt_pk_bf16_f32 v60, v40, v41
  v_cvt_pk_bf16_f32 v61, v42, v43
  v_cvt_pk_bf16_f32 v62, v44, v45
  v_cvt_pk_bf16_f32 v63, v46, v47
  s_waitcnt lgkmcnt(2)
  s_nop 0
  v_mfma_f32_32x32x16_bf16 v[96:111], v[208:211], v[56:59], v[96:111]
  v_mfma_f32_32x32x16_bf16 v[96:111], v[212:215], v[60:63], v[96:111]
  v_mfma_f32_16x16x32_bf16 v[136:139], v[224:227], v[56:59], v[136:139]
  v_mfma_f32_16x16x32_bf16 v[136:139], v[224:227], v[60:63], v[136:139]
  s_cmp_lt_u32 s36, 4
  s_cbranch_scc1 .Lattn_kernel_p2_29
  s_waitcnt lgkmcnt(0)
  s_nop 15
  s_cmp_eq_u32 s34, 8
  s_cbranch_scc1 .Lattn_kernel_fin_24
.Lattn_kernel_rst1_25:
  v_add_u32 v3, s33, v5
  v_add_u32 v4, s33, v5
  ds_read_b128 v[192:195], v3 offset:0
  ds_read_b128 v[196:199], v3 offset:1024
  ds_read_b128 v[200:203], v3 offset:2048
  ds_read_b128 v[204:207], v3 offset:3072
  ds_read_b128 v[208:211], v4 offset:8192
  ds_read_b128 v[212:215], v4 offset:9216
  s_waitcnt lgkmcnt(4)
  v_mfma_f32_32x32x16_bf16 v[16:31], v[192:195], v[176:179], v[144:159]
  v_mfma_f32_32x32x16_bf16 v[16:31], v[196:199], v[180:183], v[16:31]
  v_mfma_f32_32x32x16_bf16 v[32:47], v[192:195], v[184:187], v[160:175]
  v_mfma_f32_32x32x16_bf16 v[32:47], v[196:199], v[188:191], v[32:47]
  ds_read_b128 v[192:195], v3 offset:4096
  ds_read_b128 v[196:199], v3 offset:5120
  ds_read_b128 v[216:219], v4 offset:10240
  ds_read_b128 v[220:223], v4 offset:11264
  s_nop 7
  v_exp_f32 v16, v16
  v_exp_f32 v17, v17
  v_exp_f32 v18, v18
  v_exp_f32 v19, v19
  v_exp_f32 v20, v20
  v_exp_f32 v21, v21
  v_exp_f32 v22, v22
  v_exp_f32 v23, v23
  v_exp_f32 v24, v24
  v_exp_f32 v25, v25
  v_exp_f32 v26, v26
  v_exp_f32 v27, v27
  v_exp_f32 v28, v28
  v_exp_f32 v29, v29
  v_exp_f32 v30, v30
  v_exp_f32 v31, v31
  s_nop 0
  v_cvt_pk_bf16_f32 v48, v16, v17
  v_cvt_pk_bf16_f32 v49, v18, v19
  v_cvt_pk_bf16_f32 v50, v20, v21
  v_cvt_pk_bf16_f32 v51, v22, v23
  v_cvt_pk_bf16_f32 v52, v24, v25
  v_cvt_pk_bf16_f32 v53, v26, v27
  v_cvt_pk_bf16_f32 v54, v28, v29
  v_cvt_pk_bf16_f32 v55, v30, v31
  s_branch .Lattn_kernel_e0_17
.Lattn_kernel_helper_5:
  s_setprio 3
  v_lshlrev_b32 v2, 4, v0
  s_sub_u32 s21, s24, 4
  s_cmp_ge_u32 s21, 2
  s_cbranch_scc1 .Lattn_kernel_copier_30
  s_lshl_b32 s26, s21, 14
  s_mov_b32 s25, 0
  s_lshl_b32 s29, s23, 19
  s_add_u32 s29, s29, s26
  s_add_u32 s8, s6, 0x500000
  s_addc_u32 s9, s7, 0
  s_mov_b32 s10, 0x800000
  s_mov_b32 s11, 0x20000
  s_lshl_b32 s38, s23, 8
  s_add_u32 s38, s38, 667648
  s_barrier
  s_mov_b32 s39, 0
.Lattn_kernel_spin_32:
  v_mov_b32 v30, 0
  v_mov_b32 v31, 0
  s_mov_b64 exec, 1
  buffer_atomic_add v30, v31, s[16:19], s38 offen sc0 sc1
  s_mov_b64 exec, -1
  s_waitcnt vmcnt(0)
.Lattn_kernel_chk_33:
  v_cmp_gt_u32 vcc, 16, v30
  s_add_u32 s39, s39, 1
  s_and_b32 s61, vcc_lo, 1
  s_cbranch_scc0 .Lattn_kernel_go_34
  s_sleep 1
  s_cmp_lt_u32 s39, 131072
  s_cbranch_scc1 .Lattn_kernel_spin_32
.Lattn_kernel_go_34:
  s_cmp_eq_u32 s25, s22
  s_addc_u32 s25, s25, 0
  s_lshl_b32 s27, s25, 15
  s_add_u32 s27, s27, s29
  s_add_u32 s25, s25, 1
  s_add_u32 s26, s26, 32768
  s_and_b32 s26, s26, 131071
  s_add_u32 m0, s26, 0
  s_nop 0
  buffer_load_dwordx4 v2, s[8:11], s27 offen offset:0 sc1 lds
  buffer_load_dwordx4 v2, s[8:11], s27 offen offset:1024 sc1 lds
  buffer_load_dwordx4 v2, s[8:11], s27 offen offset:2048 sc1 lds
  buffer_load_dwordx4 v2, s[8:11], s27 offen offset:3072 sc1 lds
  s_add_u32 s27, s27, 4096
  s_add_u32 m0, s26, 4096
  s_nop 0
  buffer_load_dwordx4 v2, s[8:11], s27 offen offset:0 sc1 lds
  buffer_load_dwordx4 v2, s[8:11], s27 offen offset:1024 sc1 lds
  buffer_load_dwordx4 v2, s[8:11], s27 offen offset:2048 sc1 lds
  buffer_load_dwordx4 v2, s[8:11], s27 offen offset:3072 sc1 lds
  s_add_u32 s27, s27, 4096
  s_add_u32 m0, s26, 8192
  s_nop 0
  buffer_load_dwordx4 v2, s[8:11], s27 offen offset:0 sc1 lds
  buffer_load_dwordx4 v2, s[8:11], s27 offen offset:1024 sc1 lds
  buffer_load_dwordx4 v2, s[8:11], s27 offen offset:2048 sc1 lds
  buffer_load_dwordx4 v2, s[8:11], s27 offen offset:3072 sc1 lds
  s_add_u32 s27, s27, 4096
  s_add_u32 m0, s26, 12288
  s_nop 0
  buffer_load_dwordx4 v2, s[8:11], s27 offen offset:0 sc1 lds
  buffer_load_dwordx4 v2, s[8:11], s27 offen offset:1024 sc1 lds
  buffer_load_dwordx4 v2, s[8:11], s27 offen offset:2048 sc1 lds
  buffer_load_dwordx4 v2, s[8:11], s27 offen offset:3072 sc1 lds
  s_add_u32 s27, s27, 4096
  s_waitcnt vmcnt(0)
  s_barrier
  s_cmp_eq_u32 s25, s22
  s_addc_u32 s25, s25, 0
  s_lshl_b32 s27, s25, 15
  s_add_u32 s27, s27, s29
  s_add_u32 s25, s25, 1
  s_add_u32 s26, s26, 32768
  s_and_b32 s26, s26, 131071
  s_add_u32 m0, s26, 0
  s_nop 0
  buffer_load_dwordx4 v2, s[8:11], s27 offen offset:0 sc1 lds
  buffer_load_dwordx4 v2, s[8:11], s27 offen offset:1024 sc1 lds
  buffer_load_dwordx4 v2, s[8:11], s27 offen offset:2048 sc1 lds
  buffer_load_dwordx4 v2, s[8:11], s27 offen offset:3072 sc1 lds
  s_add_u32 s27, s27, 4096
  s_add_u32 m0, s26, 4096
  s_nop 0
  buffer_load_dwordx4 v2, s[8:11], s27 offen offset:0 sc1 lds
  buffer_load_dwordx4 v2, s[8:11], s27 offen offset:1024 sc1 lds
  buffer_load_dwordx4 v2, s[8:11], s27 offen offset:2048 sc1 lds
  buffer_load_dwordx4 v2, s[8:11], s27 offen offset:3072 sc1 lds
  s_add_u32 s27, s27, 4096
  s_add_u32 m0, s26, 8192
  s_nop 0
  buffer_load_dwordx4 v2, s[8:11], s27 offen offset:0 sc1 lds
  buffer_load_dwordx4 v2, s[8:11], s27 offen offset:1024 sc1 lds
  buffer_load_dwordx4 v2, s[8:11], s27 offen offset:2048 sc1 lds
  buffer_load_dwordx4 v2, s[8:11], s27 offen offset:3072 sc1 lds
  s_add_u32 s27, s27, 4096
  s_add_u32 m0, s26, 12288
  s_nop 0
  buffer_load_dwordx4 v2, s[8:11], s27 offen offset:0 sc1 lds
  buffer_load_dwordx4 v2, s[8:11], s27 offen offset:1024 sc1 lds
  buffer_load_dwordx4 v2, s[8:11], s27 offen offset:2048 sc1 lds
  buffer_load_dwordx4 v2, s[8:11], s27 offen offset:3072 sc1 lds
  s_add_u32 s27, s27, 4096
  s_cmp_eq_u32 s25, s22
  s_addc_u32 s25, s25, 0
  s_lshl_b32 s27, s25, 15
  s_add_u32 s27, s27, s29
  s_add_u32 s25, s25, 1
  s_add_u32 s26, s26, 32768
  s_and_b32 s26, s26, 131071
  s_add_u32 m0, s26, 0
  s_nop 0
  buffer_load_dwordx4 v2, s[8:11], s27 offen offset:0 sc1 lds
  buffer_load_dwordx4 v2, s[8:11], s27 offen offset:1024 sc1 lds
  buffer_load_dwordx4 v2, s[8:11], s27 offen offset:2048 sc1 lds
  buffer_load_dwordx4 v2, s[8:11], s27 offen offset:3072 sc1 lds
  s_add_u32 s27, s27, 4096
  s_add_u32 m0, s26, 4096
  s_nop 0
  buffer_load_dwordx4 v2, s[8:11], s27 offen offset:0 sc1 lds
  buffer_load_dwordx4 v2, s[8:11], s27 offen offset:1024 sc1 lds
  buffer_load_dwordx4 v2, s[8:11], s27 offen offset:2048 sc1 lds
  buffer_load_dwordx4 v2, s[8:11], s27 offen offset:3072 sc1 lds
  s_add_u32 s27, s27, 4096
  s_add_u32 m0, s26, 8192
  s_nop 0
  buffer_load_dwordx4 v2, s[8:11], s27 offen offset:0 sc1 lds
  buffer_load_dwordx4 v2, s[8:11], s27 offen offset:1024 sc1 lds
  buffer_load_dwordx4 v2, s[8:11], s27 offen offset:2048 sc1 lds
  buffer_load_dwordx4 v2, s[8:11], s27 offen offset:3072 sc1 lds
  s_add_u32 s27, s27, 4096
  s_add_u32 m0, s26, 12288
  s_nop 0
  buffer_load_dwordx4 v2, s[8:11], s27 offen offset:0 sc1 lds
  buffer_load_dwordx4 v2, s[8:11], s27 offen offset:1024 sc1 lds
  buffer_load_dwordx4 v2, s[8:11], s27 offen offset:2048 sc1 lds
  buffer_load_dwordx4 v2, s[8:11], s27 offen offset:3072 sc1 lds
  s_add_u32 s27, s27, 4096
  s_mov_b32 s28, 2
.Lattn_kernel_hl_35:
  s_waitcnt vmcnt(16)
  s_barrier
  s_cmp_eq_u32 s25, s22
  s_addc_u32 s25, s25, 0
  s_lshl_b32 s27, s25, 15
  s_add_u32 s27, s27, s29
  s_add_u32 s25, s25, 1
  s_add_u32 s26, s26, 32768
  s_and_b32 s26, s26, 131071
  s_add_u32 m0, s26, 0
  s_nop 0
  buffer_load_dwordx4 v2, s[8:11], s27 offen offset:0 sc1 lds
  buffer_load_dwordx4 v2, s[8:11], s27 offen offset:1024 sc1 lds
  buffer_load_dwordx4 v2, s[8:11], s27 offen offset:2048 sc1 lds
  buffer_load_dwordx4 v2, s[8:11], s27 offen offset:3072 sc1 lds
  s_add_u32 s27, s27, 4096
  s_add_u32 m0, s26, 4096
  s_nop 0
  buffer_load_dwordx4 v2, s[8:11], s27 offen offset:0 sc1 lds
  buffer_load_dwordx4 v2, s[8:11], s27 offen offset:1024 sc1 lds
  buffer_load_dwordx4 v2, s[8:11], s27 offen offset:2048 sc1 lds
  buffer_load_dwordx4 v2, s[8:11], s27 offen offset:3072 sc1 lds
  s_add_u32 s27, s27, 4096
  s_add_u32 m0, s26, 8192
  s_nop 0
  buffer_load_dwordx4 v2, s[8:11], s27 offen offset:0 sc1 lds
  buffer_load_dwordx4 v2, s[8:11], s27 offen offset:1024 sc1 lds
  buffer_load_dwordx4 v2, s[8:11], s27 offen offset:2048 sc1 lds
  buffer_load_dwordx4 v2, s[8:11], s27 offen offset:3072 sc1 lds
  s_add_u32 s27, s27, 4096
  s_add_u32 m0, s26, 12288
  s_nop 0
  buffer_load_dwordx4 v2, s[8:11], s27 offen offset:0 sc1 lds
  buffer_load_dwordx4 v2, s[8:11], s27 offen offset:1024 sc1 lds
  buffer_load_dwordx4 v2, s[8:11], s27 offen offset:2048 sc1 lds
  buffer_load_dwordx4 v2, s[8:11], s27 offen offset:3072 sc1 lds
  s_add_u32 s27, s27, 4096
  s_add_u32 s28, s28, 1
  s_cmp_lt_u32 s28, 14
  s_cbranch_scc1 .Lattn_kernel_hl_35
  s_waitcnt vmcnt(16)
  s_branch .Lattn_kernel_gemv_31
.Lattn_kernel_copier_30:
  v_lshrrev_b32 v5, 3, v0
  v_and_b32 v6, 7, v0
  s_cmp_eq_u32 s21, 3
  s_cbranch_scc1 .Lattn_kernel_stager2_36
  s_load_dwordx2 s[40:41], s[0:1], 40
  s_load_dwordx2 s[54:55], s[0:1], 0
  s_load_dwordx2 s[62:63], s[0:1], 16
  s_mul_hi_u32 s43, s2, 0x12492493
  s_mul_i32 s39, s43, 14
  s_sub_u32 s39, s2, s39
  s_lshl_b32 s39, s39, 19
  s_lshl_b32 s43, s43, 7
  s_add_u32 s27, s39, s43
  s_lshl_b32 s28, s2, 15
  v_bfe_u32 v8, v0, 4, 2
  v_lshlrev_b32 v8, 1, v8
  v_xor_b32 v6, v6, v8
  v_lshlrev_b32 v6, 4, v6
  v_lshl_add_u32 v7, v5, 11, v6
  s_waitcnt lgkmcnt(0)
  s_mov_b32 s8, s40
  s_mov_b32 s9, s41
  s_mov_b32 s10, 0x700000
  s_mov_b32 s11, 0x20000
  s_add_u32 s48, s6, 0x3000000
  s_addc_u32 s49, s7, 0
  s_mov_b32 s50, 0x700000
  s_mov_b32 s51, 0x20000
  s_cmp_lt_u32 s2, 224
  s_cselect_b32 s10, s10, 0
  s_cselect_b32 s50, s50, 0
  s_bfe_u32 s39, s43, 0x30007
  s_cmp_eq_u32 s39, 3
  s_cselect_b32 s50, s50, 0
  s_add_u32 s16, s6, 0x0
  s_addc_u32 s17, s7, 0
  s_mov_b32 s18, 0x100000
  s_mov_b32 s19, 0x20000
  s_mov_b32 s32, s62
  s_mov_b32 s33, s63
  s_mov_b32 s34, 0x200000
  s_mov_b32 s35, 0x20000
  s_mov_b32 s12, s54
  s_mov_b32 s13, s55
  s_mov_b32 s14, 0x400000
  s_mov_b32 s15, 0x20000
  s_lshr_b32 s29, s2, 3
  s_bfe_u32 s30, s2, 0x10002
  s_lshl_b32 s30, s30, 10
  s_lshl_b32 s31, s29, 15
  s_add_u32 s31, s31, s30
  s_lshl_b32 s29, s29, 16
  s_add_u32 s29, s29, s30
  s_and_b32 s30, s2, 3
  s_lshl_b32 s30, s30, 20
  s_add_u32 s31, s31, s30
  s_barrier
  s_barrier
  buffer_load_dwordx4 v[16:19], v7, s[8:11], s27 offen
  s_add_u32 s27, s27, 16384
  buffer_load_dwordx4 v[20:23], v7, s[8:11], s27 offen
  s_add_u32 s27, s27, 16384
  buffer_load_dwordx4 v[24:27], v7, s[8:11], s27 offen
  s_add_u32 s27, s27, 16384
  buffer_load_dwordx4 v[28:31], v7, s[8:11], s27 offen
  s_add_u32 s27, s27, 16384
  s_barrier
  buffer_load_dwordx4 v[32:35], v7, s[8:11], s27 offen
  s_add_u32 s27, s27, 16384
  buffer_load_dwordx4 v[36:39], v7, s[8:11], s27 offen
  s_add_u32 s27, s27, 16384
  buffer_load_dwordx4 v[40:43], v7, s[8:11], s27 offen
  s_add_u32 s27, s27, 16384
  buffer_load_dwordx4 v[44:47], v7, s[8:11], s27 offen
  s_add_u32 s27, s27, 16384
  s_barrier
  buffer_load_dwordx4 v[48:51], v7, s[8:11], s27 offen
  s_add_u32 s27, s27, 16384
  buffer_load_dwordx4 v[52:55], v7, s[8:11], s27 offen
  s_add_u32 s27, s27, 16384
  buffer_load_dwordx4 v[56:59], v7, s[8:11], s27 offen
  s_add_u32 s27, s27, 16384
  buffer_load_dwordx4 v[60:63], v7, s[8:11], s27 offen
  s_add_u32 s27, s27, 16384
  s_barrier
  s_waitcnt vmcnt(8)
  buffer_store_dwordx4 v[16:19], v2, s[48:51], s28 offen offset:0 sc0 sc1
  buffer_store_dwordx4 v[20:23], v2, s[48:51], s28 offen offset:1024 sc0 sc1
  buffer_store_dwordx4 v[24:27], v2, s[48:51], s28 offen offset:2048 sc0 sc1
  buffer_store_dwordx4 v[28:31], v2, s[48:51], s28 offen offset:3072 sc0 sc1
  s_add_u32 s28, s28, 4096
  buffer_load_dwordx4 v[64:67], v7, s[8:11], s27 offen
  s_add_u32 s27, s27, 16384
  buffer_load_dwordx4 v[68:71], v7, s[8:11], s27 offen
  s_add_u32 s27, s27, 16384
  buffer_load_dwordx4 v[72:75], v7, s[8:11], s27 offen
  s_add_u32 s27, s27, 16384
  buffer_load_dwordx4 v[76:79], v7, s[8:11], s27 offen
  s_add_u32 s27, s27, 16384
  s_barrier
  s_waitcnt vmcnt(12)
  buffer_store_dwordx4 v[32:35], v2, s[48:51], s28 offen offset:0 sc0 sc1
  buffer_store_dwordx4 v[36:39], v2, s[48:51], s28 offen offset:1024 sc0 sc1
  buffer_store_dwordx4 v[40:43], v2, s[48:51], s28 offen offset:2048 sc0 sc1
  buffer_store_dwordx4 v[44:47], v2, s[48:51], s28 offen offset:3072 sc0 sc1
  s_add_u32 s28, s28, 4096
  buffer_load_dwordx4 v[16:19], v7, s[8:11], s27 offen
  s_add_u32 s27, s27, 16384
  buffer_load_dwordx4 v[20:23], v7, s[8:11], s27 offen
  s_add_u32 s27, s27, 16384
  buffer_load_dwordx4 v[24:27], v7, s[8:11], s27 offen
  s_add_u32 s27, s27, 16384
  buffer_load_dwordx4 v[28:31], v7, s[8:11], s27 offen
  s_add_u32 s27, s27, 16384
  s_barrier
  s_waitcnt vmcnt(16)
  buffer_store_dwordx4 v[48:51], v2, s[48:51], s28 offen offset:0 sc0 sc1
  buffer_store_dwordx4 v[52:55], v2, s[48:51], s28 offen offset:1024 sc0 sc1
  buffer_store_dwordx4 v[56:59], v2, s[48:51], s28 offen offset:2048 sc0 sc1
  buffer_store_dwordx4 v[60:63], v2, s[48:51], s28 offen offset:3072 sc0 sc1
  s_add_u32 s28, s28, 4096
  buffer_load_dwordx4 v[32:35], v7, s[8:11], s27 offen
  s_add_u32 s27, s27, 16384
  buffer_load_dwordx4 v[36:39], v7, s[8:11], s27 offen
  s_add_u32 s27, s27, 16384
  buffer_load_dwordx4 v[40:43], v7, s[8:11], s27 offen
  s_add_u32 s27, s27, 16384
  buffer_load_dwordx4 v[44:47], v7, s[8:11], s27 offen
  s_add_u32 s27, s27, 16384
  s_barrier
  s_waitcnt vmcnt(16)
  buffer_store_dwordx4 v[64:67], v2, s[48:51], s28 offen offset:0 sc0 sc1
  buffer_store_dwordx4 v[68:71], v2, s[48:51], s28 offen offset:1024 sc0 sc1
  buffer_store_dwordx4 v[72:75], v2, s[48:51], s28 offen offset:2048 sc0 sc1
  buffer_store_dwordx4 v[76:79], v2, s[48:51], s28 offen offset:3072 sc0 sc1
  s_add_u32 s28, s28, 4096
  buffer_load_dwordx4 v[48:51], v7, s[8:11], s27 offen
  s_add_u32 s27, s27, 16384
  buffer_load_dwordx4 v[52:55], v7, s[8:11], s27 offen
  s_add_u32 s27, s27, 16384
  buffer_load_dwordx4 v[56:59], v7, s[8:11], s27 offen
  s_add_u32 s27, s27, 16384
  buffer_load_dwordx4 v[60:63], v7, s[8:11], s27 offen
  s_add_u32 s27, s27, 16384
  s_barrier
  s_waitcnt vmcnt(16)
  buffer_store_dwordx4 v[16:19], v2, s[48:51], s28 offen offset:0 sc0 sc1
  buffer_store_dwordx4 v[20:23], v2, s[48:51], s28 offen offset:1024 sc0 sc1
  buffer_store_dwordx4 v[24:27], v2, s[48:51], s28 offen offset:2048 sc0 sc1
  buffer_store_dwordx4 v[28:31], v2, s[48:51], s28 offen offset:3072 sc0 sc1
  s_add_u32 s28, s28, 4096
  buffer_load_dwordx4 v[64:67], v7, s[8:11], s27 offen
  s_add_u32 s27, s27, 16384
  buffer_load_dwordx4 v[68:71], v7, s[8:11], s27 offen
  s_add_u32 s27, s27, 16384
  buffer_load_dwordx4 v[72:75], v7, s[8:11], s27 offen
  s_add_u32 s27, s27, 16384
  buffer_load_dwordx4 v[76:79], v7, s[8:11], s27 offen
  s_add_u32 s27, s27, 16384
  s_barrier
  s_waitcnt vmcnt(16)
  buffer_store_dwordx4 v[32:35], v2, s[48:51], s28 offen offset:0 sc0 sc1
  buffer_store_dwordx4 v[36:39], v2, s[48:51], s28 offen offset:1024 sc0 sc1
  buffer_store_dwordx4 v[40:43], v2, s[48:51], s28 offen offset:2048 sc0 sc1
  buffer_store_dwordx4 v[44:47], v2, s[48:51], s28 offen offset:3072 sc0 sc1
  s_add_u32 s28, s28, 4096
  s_lshl_b32 s29, s2, 13
  buffer_load_dwordx4 v[156:159], v2, s[32:35], s29 offen offset:0
  buffer_load_dwordx4 v[156:159], v2, s[32:35], s29 offen offset:1024
  buffer_load_dwordx4 v[156:159], v2, s[32:35], s29 offen offset:2048
  buffer_load_dwordx4 v[156:159], v2, s[32:35], s29 offen offset:3072
  s_add_u32 s29, s29, 4096
  s_barrier
  s_waitcnt vmcnt(16)
  buffer_store_dwordx4 v[48:51], v2, s[48:51], s28 offen offset:0 sc0 sc1
  buffer_store_dwordx4 v[52:55], v2, s[48:51], s28 offen offset:1024 sc0 sc1
  buffer_store_dwordx4 v[56:59], v2, s[48:51], s28 offen offset:2048 sc0 sc1
  buffer_store_dwordx4 v[60:63], v2, s[48:51], s28 offen offset:3072 sc0 sc1
  s_add_u32 s28, s28, 4096
  buffer_load_dwordx4 v[156:159], v2, s[32:35], s29 offen offset:0
  buffer_load_dwordx4 v[156:159], v2, s[32:35], s29 offen offset:1024
  buffer_load_dwordx4 v[156:159], v2, s[32:35], s29 offen offset:2048
  buffer_load_dwordx4 v[156:159], v2, s[32:35], s29 offen offset:3072
  s_add_u32 s29, s29, 4096
  s_barrier
  s_waitcnt vmcnt(16)
  buffer_store_dwordx4 v[64:67], v2, s[48:51], s28 offen offset:0 sc0 sc1
  buffer_store_dwordx4 v[68:71], v2, s[48:51], s28 offen offset:1024 sc0 sc1
  buffer_store_dwordx4 v[72:75], v2, s[48:51], s28 offen offset:2048 sc0 sc1
  buffer_store_dwordx4 v[76:79], v2, s[48:51], s28 offen offset:3072 sc0 sc1
  s_add_u32 s28, s28, 4096
  s_barrier
  s_barrier
  s_waitcnt vmcnt(0)
  s_branch .Lattn_kernel_gemv_31
.Lattn_kernel_stager2_36:
  s_load_dwordx2 s[40:41], s[0:1], 32
  s_load_dwordx2 s[52:53], s[0:1], 56
  v_mul_u32_u24 v7, 7168, v5
  v_lshl_add_u32 v7, v6, 4, v7
  v_mul_u32_u24 v8, 12288, v5
  v_lshl_add_u32 v8, v6, 4, v8
  s_and_b32 s25, s2, 3
  s_lshr_b32 s26, s2, 2
  s_lshl_b32 s26, s26, 7
  s_mul_i32 s27, s25, 1835008
  s_add_u32 s27, s27, s26
  s_mul_i32 s28, s25, 3145728
  s_add_u32 s28, s28, s26
  s_add_u32 s28, s28, 4096
  s_mul_i32 s29, s25, 24576
  s_lshl_b32 s26, s26, 1
  s_add_u32 s29, s29, s26
  s_add_u32 s29, s29, 8192
  s_lshl_b32 s26, s25, 9
  s_add_u32 s26, s26, 147456
  v_lshrrev_b32 v5, 4, v0
  v_lshlrev_b32 v9, 10, v5
  v_bfe_u32 v10, v0, 2, 2
  v_lshl_add_u32 v9, v10, 7, v9
  v_and_b32 v10, 3, v0
  v_lshl_add_u32 v9, v10, 3, v9
  v_add_u32 v9, 131072, v9
  v_lshlrev_b32 v6, 4, v5
  v_lshlrev_b32 v11, 2, v0
  s_waitcnt lgkmcnt(0)
  s_mov_b32 s8, s40
  s_mov_b32 s9, s41
  s_mov_b32 s10, 0x700000
  s_mov_b32 s11, 0x20000
  s_mov_b32 s12, s52
  s_mov_b32 s13, s53
  s_mov_b32 s14, 0xc00000
  s_mov_b32 s15, 0x20000
  s_cmp_lt_u32 s2, 224
  s_cselect_b32 s10, s10, 0
  s_add_u32 s16, s6, 0x0
  s_addc_u32 s17, s7, 0
  s_mov_b32 s18, 0x100000
  s_mov_b32 s19, 0x20000
  s_barrier
  s_barrier
  buffer_load_dwordx4 v[16:19], v6, s[16:19], s26 offen offset:0
  buffer_load_dwordx4 v[20:23], v6, s[16:19], s26 offen offset:64
  buffer_load_dwordx4 v[24:27], v6, s[16:19], s26 offen offset:128
  buffer_load_dwordx4 v[28:31], v6, s[16:19], s26 offen offset:192
  buffer_load_dwordx4 v[32:35], v6, s[16:19], s26 offen offset:256
  buffer_load_dwordx4 v[36:39], v6, s[16:19], s26 offen offset:320
  buffer_load_dwordx4 v[40:43], v6, s[16:19], s26 offen offset:384
  buffer_load_dwordx4 v[44:47], v6, s[16:19], s26 offen offset:448
  s_mov_b32 m0, 131072
  s_nop 0
  buffer_load_dwordx4 v8, s[12:15], s28 offen nt lds
  s_add_u32 s28, s28, 98304
  s_mov_b32 m0, 132096
  s_nop 0
  buffer_load_dwordx4 v8, s[12:15], s28 offen nt lds
  s_add_u32 s28, s28, 98304
  s_mov_b32 m0, 133120
  s_nop 0
  buffer_load_dwordx4 v8, s[12:15], s28 offen nt lds
  s_add_u32 s28, s28, 98304
  s_mov_b32 m0, 134144
  s_nop 0
  buffer_load_dwordx4 v8, s[12:15], s28 offen nt lds
  s_add_u32 s28, s28, 98304
  s_mov_b32 m0, 135168
  s_nop 0
  buffer_load_dwordx4 v8, s[12:15], s28 offen nt lds
  s_add_u32 s28, s28, 98304
  s_mov_b32 m0, 136192
  s_nop 0
  buffer_load_dwordx4 v8, s[12:15], s28 offen nt lds
  s_add_u32 s28, s28, 98304
  s_mov_b32 m0, 137216
  s_nop 0
  buffer_load_dwordx4 v8, s[12:15], s28 offen nt lds
  s_add_u32 s28, s28, 98304
  s_mov_b32 m0, 138240
  s_nop 0
  buffer_load_dwordx4 v8, s[12:15], s28 offen nt lds
  s_add_u32 s28, s28, 98304
  s_mov_b32 m0, 139264
  s_nop 0
  buffer_load_dwordx4 v8, s[12:15], s28 offen nt lds
  s_add_u32 s28, s28, 98304
  s_mov_b32 m0, 140288
  s_nop 0
  buffer_load_dwordx4 v8, s[12:15], s28 offen nt lds
  s_add_u32 s28, s28, 98304
  s_mov_b32 m0, 141312
  s_nop 0
  buffer_load_dwordx4 v8, s[12:15], s28 offen nt lds
  s_add_u32 s28, s28, 98304
  s_mov_b32 m0, 142336
  s_nop 0
  buffer_load_dwordx4 v8, s[12:15], s28 offen nt lds
  s_add_u32 s28, s28, 98304
  s_mov_b32 m0, 143360
  s_nop 0
  buffer_load_dwordx4 v8, s[12:15], s28 offen nt lds
  s_add_u32 s28, s28, 98304
  s_mov_b32 m0, 144384
  s_nop 0
  buffer_load_dwordx4 v8, s[12:15], s28 offen nt lds
  s_add_u32 s28, s28, 98304
  s_mov_b32 m0, 145408
  s_nop 0
  buffer_load_dwordx4 v8, s[12:15], s28 offen nt lds
  s_add_u32 s28, s28, 98304
  s_mov_b32 m0, 146432
  s_nop 0
  buffer_load_dwordx4 v8, s[12:15], s28 offen nt lds
  s_add_u32 s28, s28, 98304
  s_barrier
  s_mov_b32 m0, 147456
  s_nop 0
  buffer_load_dwordx4 v8, s[12:15], s28 offen nt lds
  s_add_u32 s28, s28, 98304
  s_mov_b32 m0, 148480
  s_nop 0
  buffer_load_dwordx4 v8, s[12:15], s28 offen nt lds
  s_add_u32 s28, s28, 98304
  s_mov_b32 m0, 149504
  s_nop 0
  buffer_load_dwordx4 v8, s[12:15], s28 offen nt lds
  s_add_u32 s28, s28, 98304
  s_mov_b32 m0, 150528
  s_nop 0
  buffer_load_dwordx4 v8, s[12:15], s28 offen nt lds
  s_add_u32 s28, s28, 98304
  s_mov_b32 m0, 151552
  s_nop 0
  buffer_load_dwordx4 v8, s[12:15], s28 offen nt lds
  s_add_u32 s28, s28, 98304
  s_mov_b32 m0, 152576
  s_nop 0
  buffer_load_dwordx4 v8, s[12:15], s28 offen nt lds
  s_add_u32 s28, s28, 98304
  s_mov_b32 m0, 153600
  s_nop 0
  buffer_load_dwordx4 v8, s[12:15], s28 offen nt lds
  s_add_u32 s28, s28, 98304
  s_mov_b32 m0, 154624
  s_nop 0
  buffer_load_dwordx4 v8, s[12:15], s28 offen nt lds
  s_add_u32 s28, s28, 98304
  s_mov_b32 m0, 155648
  s_nop 0
  buffer_load_dwordx4 v8, s[12:15], s28 offen nt lds
  s_add_u32 s28, s28, 98304
  s_mov_b32 m0, 156672
  s_nop 0
  buffer_load_dwordx4 v8, s[12:15], s28 offen nt lds
  s_add_u32 s28, s28, 98304
  s_mov_b32 m0, 157696
  s_nop 0
  buffer_load_dwordx4 v8, s[12:15], s28 offen nt lds
  s_add_u32 s28, s28, 98304
  s_mov_b32 m0, 158720
  s_nop 0
  buffer_load_dwordx4 v8, s[12:15], s28 offen nt lds
  s_add_u32 s28, s28, 98304
  s_mov_b32 m0, 159744
  s_nop 0
  buffer_load_dwordx4 v8, s[12:15], s28 offen nt lds
  s_add_u32 s28, s28, 98304
  s_mov_b32 m0, 160768
  s_nop 0
  buffer_load_dwordx4 v8, s[12:15], s28 offen nt lds
  s_add_u32 s28, s28, 98304
  s_mov_b32 m0, 161792
  s_nop 0
  buffer_load_dwordx4 v8, s[12:15], s28 offen nt lds
  s_add_u32 s28, s28, 98304
  s_mov_b32 m0, 162816
  s_nop 0
  buffer_load_dwordx4 v8, s[12:15], s28 offen nt lds
  s_add_u32 s28, s28, 98304
  s_barrier
  s_barrier
  s_barrier
  s_waitcnt vmcnt(0)
  s_nop 1
  v_mov_b32 v144, 0
  v_mov_b32 v145, 0
  v_mov_b32 v146, 0
  v_mov_b32 v147, 0
  ds_read_b64_tr_b16 v[48:49], v9 offset:0
  ds_read_b64_tr_b16 v[50:51], v9 offset:512
  ds_read_b64_tr_b16 v[52:53], v9 offset:4096
  ds_read_b64_tr_b16 v[54:55], v9 offset:4608
  ds_read_b64_tr_b16 v[56:57], v9 offset:8192
  ds_read_b64_tr_b16 v[58:59], v9 offset:8704
  ds_read_b64_tr_b16 v[60:61], v9 offset:12288
  ds_read_b64_tr_b16 v[62:63], v9 offset:12800
  s_waitcnt lgkmcnt(4)
  ds_read_b64_tr_b16 v[64:65], v9 offset:16384
  ds_read_b64_tr_b16 v[66:67], v9 offset:16896
  ds_read_b64_tr_b16 v[68:69], v9 offset:20480
  ds_read_b64_tr_b16 v[70:71], v9 offset:20992
  ds_read_b64_tr_b16 v[72:73], v9 offset:24576
  ds_read_b64_tr_b16 v[74:75], v9 offset:25088
  ds_read_b64_tr_b16 v[76:77], v9 offset:28672
  ds_read_b64_tr_b16 v[78:79], v9 offset:29184
  s_waitcnt lgkmcnt(0)
  v_mfma_f32_16x16x32_bf16 v[144:147], v[16:19], v[48:51], v[144:147]
  v_mfma_f32_16x16x32_bf16 v[144:147], v[20:23], v[52:55], v[144:147]
  v_mfma_f32_16x16x32_bf16 v[144:147], v[24:27], v[56:59], v[144:147]
  v_mfma_f32_16x16x32_bf16 v[144:147], v[28:31], v[60:63], v[144:147]
  v_mfma_f32_16x16x32_bf16 v[144:147], v[32:35], v[64:67], v[144:147]
  v_mfma_f32_16x16x32_bf16 v[144:147], v[36:39], v[68:71], v[144:147]
  v_mfma_f32_16x16x32_bf16 v[144:147], v[40:43], v[72:75], v[144:147]
  v_mfma_f32_16x16x32_bf16 v[144:147], v[44:47], v[76:79], v[144:147]
  s_nop 7
  s_mov_b64 exec, 0xffff
  buffer_store_dword v144, v11, s[16:19], s29 offen offset:0 sc0 sc1
  s_mov_b64 exec, -1
  s_nop 1
  v_mov_b32 v144, 0
  v_mov_b32 v145, 0
  v_mov_b32 v146, 0
  v_mov_b32 v147, 0
  ds_read_b64_tr_b16 v[48:49], v9 offset:32
  ds_read_b64_tr_b16 v[50:51], v9 offset:544
  ds_read_b64_tr_b16 v[52:53], v9 offset:4128
  ds_read_b64_tr_b16 v[54:55], v9 offset:4640
  ds_read_b64_tr_b16 v[56:57], v9 offset:8224
  ds_read_b64_tr_b16 v[58:59], v9 offset:8736
  ds_read_b64_tr_b16 v[60:61], v9 offset:12320
  ds_read_b64_tr_b16 v[62:63], v9 offset:12832
  s_waitcnt lgkmcnt(4)
  ds_read_b64_tr_b16 v[64:65], v9 offset:16416
  ds_read_b64_tr_b16 v[66:67], v9 offset:16928
  ds_read_b64_tr_b16 v[68:69], v9 offset:20512
  ds_read_b64_tr_b16 v[70:71], v9 offset:21024
  ds_read_b64_tr_b16 v[72:73], v9 offset:24608
  ds_read_b64_tr_b16 v[74:75], v9 offset:25120
  ds_read_b64_tr_b16 v[76:77], v9 offset:28704
  ds_read_b64_tr_b16 v[78:79], v9 offset:29216
  s_waitcnt lgkmcnt(0)
  v_mfma_f32_16x16x32_bf16 v[144:147], v[16:19], v[48:51], v[144:147]
  v_mfma_f32_16x16x32_bf16 v[144:147], v[20:23], v[52:55], v[144:147]
  v_mfma_f32_16x16x32_bf16 v[144:147], v[24:27], v[56:59], v[144:147]
  v_mfma_f32_16x16x32_bf16 v[144:147], v[28:31], v[60:63], v[144:147]
  v_mfma_f32_16x16x32_bf16 v[144:147], v[32:35], v[64:67], v[144:147]
  v_mfma_f32_16x16x32_bf16 v[144:147], v[36:39], v[68:71], v[144:147]
  v_mfma_f32_16x16x32_bf16 v[144:147], v[40:43], v[72:75], v[144:147]
  v_mfma_f32_16x16x32_bf16 v[144:147], v[44:47], v[76:79], v[144:147]
  s_nop 7
  s_mov_b64 exec, 0xffff
  buffer_store_dword v144, v11, s[16:19], s29 offen offset:64 sc0 sc1
  s_mov_b64 exec, -1
  s_barrier
  s_nop 1
  v_mov_b32 v144, 0
  v_mov_b32 v145, 0
  v_mov_b32 v146, 0
  v_mov_b32 v147, 0
  ds_read_b64_tr_b16 v[48:49], v9 offset:64
  ds_read_b64_tr_b16 v[50:51], v9 offset:576
  ds_read_b64_tr_b16 v[52:53], v9 offset:4160
  ds_read_b64_tr_b16 v[54:55], v9 offset:4672
  ds_read_b64_tr_b16 v[56:57], v9 offset:8256
  ds_read_b64_tr_b16 v[58:59], v9 offset:8768
  ds_read_b64_tr_b16 v[60:61], v9 offset:12352
  ds_read_b64_tr_b16 v[62:63], v9 offset:12864
  s_waitcnt lgkmcnt(4)
  ds_read_b64_tr_b16 v[64:65], v9 offset:16448
  ds_read_b64_tr_b16 v[66:67], v9 offset:16960
  ds_read_b64_tr_b16 v[68:69], v9 offset:20544
  ds_read_b64_tr_b16 v[70:71], v9 offset:21056
  ds_read_b64_tr_b16 v[72:73], v9 offset:24640
  ds_read_b64_tr_b16 v[74:75], v9 offset:25152
  ds_read_b64_tr_b16 v[76:77], v9 offset:28736
  ds_read_b64_tr_b16 v[78:79], v9 offset:29248
  s_waitcnt lgkmcnt(0)
  v_mfma_f32_16x16x32_bf16 v[144:147], v[16:19], v[48:51], v[144:147]
  v_mfma_f32_16x16x32_bf16 v[144:147], v[20:23], v[52:55], v[144:147]
  v_mfma_f32_16x16x32_bf16 v[144:147], v[24:27], v[56:59], v[144:147]
  v_mfma_f32_16x16x32_bf16 v[144:147], v[28:31], v[60:63], v[144:147]
  v_mfma_f32_16x16x32_bf16 v[144:147], v[32:35], v[64:67], v[144:147]
  v_mfma_f32_16x16x32_bf16 v[144:147], v[36:39], v[68:71], v[144:147]
  v_mfma_f32_16x16x32_bf16 v[144:147], v[40:43], v[72:75], v[144:147]
  v_mfma_f32_16x16x32_bf16 v[144:147], v[44:47], v[76:79], v[144:147]
  s_nop 7
  s_mov_b64 exec, 0xffff
  buffer_store_dword v144, v11, s[16:19], s29 offen offset:128 sc0 sc1
  s_mov_b64 exec, -1
  s_nop 1
  v_mov_b32 v144, 0
  v_mov_b32 v145, 0
  v_mov_b32 v146, 0
  v_mov_b32 v147, 0
  ds_read_b64_tr_b16 v[48:49], v9 offset:96
  ds_read_b64_tr_b16 v[50:51], v9 offset:608
  ds_read_b64_tr_b16 v[52:53], v9 offset:4192
  ds_read_b64_tr_b16 v[54:55], v9 offset:4704
  ds_read_b64_tr_b16 v[56:57], v9 offset:8288
  ds_read_b64_tr_b16 v[58:59], v9 offset:8800
  ds_read_b64_tr_b16 v[60:61], v9 offset:12384
  ds_read_b64_tr_b16 v[62:63], v9 offset:12896
  s_waitcnt lgkmcnt(4)
  ds_read_b64_tr_b16 v[64:65], v9 offset:16480
  ds_read_b64_tr_b16 v[66:67], v9 offset:16992
  ds_read_b64_tr_b16 v[68:69], v9 offset:20576
  ds_read_b64_tr_b16 v[70:71], v9 offset:21088
  ds_read_b64_tr_b16 v[72:73], v9 offset:24672
  ds_read_b64_tr_b16 v[74:75], v9 offset:25184
  ds_read_b64_tr_b16 v[76:77], v9 offset:28768
  ds_read_b64_tr_b16 v[78:79], v9 offset:29280
  s_waitcnt lgkmcnt(0)
  v_mfma_f32_16x16x32_bf16 v[144:147], v[16:19], v[48:51], v[144:147]
  v_mfma_f32_16x16x32_bf16 v[144:147], v[20:23], v[52:55], v[144:147]
  v_mfma_f32_16x16x32_bf16 v[144:147], v[24:27], v[56:59], v[144:147]
  v_mfma_f32_16x16x32_bf16 v[144:147], v[28:31], v[60:63], v[144:147]
  v_mfma_f32_16x16x32_bf16 v[144:147], v[32:35], v[64:67], v[144:147]
  v_mfma_f32_16x16x32_bf16 v[144:147], v[36:39], v[68:71], v[144:147]
  v_mfma_f32_16x16x32_bf16 v[144:147], v[40:43], v[72:75], v[144:147]
  v_mfma_f32_16x16x32_bf16 v[144:147], v[44:47], v[76:79], v[144:147]
  s_nop 7
  s_mov_b64 exec, 0xffff
  buffer_store_dword v144, v11, s[16:19], s29 offen offset:192 sc0 sc1
  s_mov_b64 exec, -1
  s_barrier
  s_mov_b32 m0, 131072
  s_nop 0
  buffer_load_dwordx4 v7, s[8:11], s27 offen lds
  s_add_u32 s27, s27, 57344
  s_mov_b32 m0, 132096
  s_nop 0
  buffer_load_dwordx4 v7, s[8:11], s27 offen lds
  s_add_u32 s27, s27, 57344
  s_mov_b32 m0, 133120
  s_nop 0
  buffer_load_dwordx4 v7, s[8:11], s27 offen lds
  s_add_u32 s27, s27, 57344
  s_mov_b32 m0, 134144
  s_nop 0
  buffer_load_dwordx4 v7, s[8:11], s27 offen lds
  s_add_u32 s27, s27, 57344
  s_mov_b32 m0, 135168
  s_nop 0
  buffer_load_dwordx4 v7, s[8:11], s27 offen lds
  s_add_u32 s27, s27, 57344
  s_mov_b32 m0, 136192
  s_nop 0
  buffer_load_dwordx4 v7, s[8:11], s27 offen lds
  s_add_u32 s27, s27, 57344
  s_mov_b32 m0, 137216
  s_nop 0
  buffer_load_dwordx4 v7, s[8:11], s27 offen lds
  s_add_u32 s27, s27, 57344
  s_mov_b32 m0, 138240
  s_nop 0
  buffer_load_dwordx4 v7, s[8:11], s27 offen lds
  s_add_u32 s27, s27, 57344
  s_barrier
  s_barrier
  s_waitcnt vmcnt(0)
  s_sub_u32 s30, s2, 64
  s_cmp_ge_u32 s30, 128
  s_cbranch_scc1 .Lattn_kernel_noinc_37
  s_bfe_u32 s30, s2, 0x20004
  s_lshl_b32 s38, s30, 8
  s_add_u32 s38, s38, 675840
  v_mov_b32 v12, 0
  v_mov_b32 v13, 1
  s_mov_b64 exec, 1
  buffer_atomic_add v13, v12, s[16:19], s38 offen sc1
  s_mov_b64 exec, -1
.Lattn_kernel_noinc_37:
  s_mov_b32 m0, 139264
  s_nop 0
  buffer_load_dwordx4 v7, s[8:11], s27 offen lds
  s_add_u32 s27, s27, 57344
  s_mov_b32 m0, 140288
  s_nop 0
  buffer_load_dwordx4 v7, s[8:11], s27 offen lds
  s_add_u32 s27, s27, 57344
  s_mov_b32 m0, 141312
  s_nop 0
  buffer_load_dwordx4 v7, s[8:11], s27 offen lds
  s_add_u32 s27, s27, 57344
  s_mov_b32 m0, 142336
  s_nop 0
  buffer_load_dwordx4 v7, s[8:11], s27 offen lds
  s_add_u32 s27, s27, 57344
  s_mov_b32 m0, 143360
  s_nop 0
  buffer_load_dwordx4 v7, s[8:11], s27 offen lds
  s_add_u32 s27, s27, 57344
  s_mov_b32 m0, 144384
  s_nop 0
  buffer_load_dwordx4 v7, s[8:11], s27 offen lds
  s_add_u32 s27, s27, 57344
  s_mov_b32 m0, 145408
  s_nop 0
  buffer_load_dwordx4 v7, s[8:11], s27 offen lds
  s_add_u32 s27, s27, 57344
  s_mov_b32 m0, 146432
  s_nop 0
  buffer_load_dwordx4 v7, s[8:11], s27 offen lds
  s_add_u32 s27, s27, 57344
  s_barrier
  s_mov_b32 m0, 147456
  s_nop 0
  buffer_load_dwordx4 v7, s[8:11], s27 offen lds
  s_add_u32 s27, s27, 57344
  s_mov_b32 m0, 148480
  s_nop 0
  buffer_load_dwordx4 v7, s[8:11], s27 offen lds
  s_add_u32 s27, s27, 57344
  s_mov_b32 m0, 149504
  s_nop 0
  buffer_load_dwordx4 v7, s[8:11], s27 offen lds
  s_add_u32 s27, s27, 57344
  s_mov_b32 m0, 150528
  s_nop 0
  buffer_load_dwordx4 v7, s[8:11], s27 offen lds
  s_add_u32 s27, s27, 57344
  s_mov_b32 m0, 151552
  s_nop 0
  buffer_load_dwordx4 v7, s[8:11], s27 offen lds
  s_add_u32 s27, s27, 57344
  s_mov_b32 m0, 152576
  s_nop 0
  buffer_load_dwordx4 v7, s[8:11], s27 offen lds
  s_add_u32 s27, s27, 57344
  s_mov_b32 m0, 153600
  s_nop 0
  buffer_load_dwordx4 v7, s[8:11], s27 offen lds
  s_add_u32 s27, s27, 57344
  s_mov_b32 m0, 154624
  s_nop 0
  buffer_load_dwordx4 v7, s[8:11], s27 offen lds
  s_add_u32 s27, s27, 57344
  s_barrier
  s_mov_b32 m0, 155648
  s_nop 0
  buffer_load_dwordx4 v7, s[8:11], s27 offen lds
  s_add_u32 s27, s27, 57344
  s_mov_b32 m0, 156672
  s_nop 0
  buffer_load_dwordx4 v7, s[8:11], s27 offen lds
  s_add_u32 s27, s27, 57344
  s_mov_b32 m0, 157696
  s_nop 0
  buffer_load_dwordx4 v7, s[8:11], s27 offen lds
  s_add_u32 s27, s27, 57344
  s_mov_b32 m0, 158720
  s_nop 0
  buffer_load_dwordx4 v7, s[8:11], s27 offen lds
  s_add_u32 s27, s27, 57344
  s_mov_b32 m0, 159744
  s_nop 0
  buffer_load_dwordx4 v7, s[8:11], s27 offen lds
  s_add_u32 s27, s27, 57344
  s_mov_b32 m0, 160768
  s_nop 0
  buffer_load_dwordx4 v7, s[8:11], s27 offen lds
  s_add_u32 s27, s27, 57344
  s_mov_b32 m0, 161792
  s_nop 0
  buffer_load_dwordx4 v7, s[8:11], s27 offen lds
  s_add_u32 s27, s27, 57344
  s_mov_b32 m0, 162816
  s_nop 0
  buffer_load_dwordx4 v7, s[8:11], s27 offen lds
  s_add_u32 s27, s27, 57344
  s_barrier
  s_barrier
  s_lshl_b32 s38, s25, 8
  s_add_u32 s38, s38, 675840
  s_mov_b32 s39, 0
.Lattn_kernel_spin_38:
  v_mov_b32 v12, 0
  v_mov_b32 v13, 0
  s_mov_b64 exec, 1
  buffer_atomic_add v12, v13, s[16:19], s38 offen sc0 sc1
  s_mov_b64 exec, -1
  s_waitcnt vmcnt(0)
.Lattn_kernel_chk_39:
  v_cmp_gt_u32 vcc, 32, v12
  s_add_u32 s39, s39, 1
  s_and_b32 s61, vcc_lo, 1
  s_cbranch_scc0 .Lattn_kernel_go_40
  s_sleep 6
  s_cmp_lt_u32 s39, 131072
  s_cbranch_scc1 .Lattn_kernel_spin_38
.Lattn_kernel_go_40:
  s_waitcnt vmcnt(0)
.Lattn_kernel_gemv_31:
  s_lshl_b32 s27, s21, 5
  s_add_u32 s27, s27, 131072
  v_lshrrev_b32 v5, 4, v0
  v_lshlrev_b32 v7, 10, v5
  v_bfe_u32 v10, v0, 2, 2
  v_lshl_add_u32 v7, v10, 7, v7
  v_and_b32 v10, 3, v0
  v_lshl_add_u32 v7, v10, 3, v7
  v_add_u32 v7, s27, v7
  v_lshlrev_b32 v6, 4, v5
  v_and_b32 v8, 1, v0
  v_lshl_add_u32 v9, v8, 9, v6
  v_add_u32 v9, 0, v9
  s_and_b32 s25, s2, 3
  s_lshl_b32 s27, s25, 10
  s_lshl_b32 s28, s21, 8
  s_add_u32 s27, s27, s28
  v_lshlrev_b32 v11, 2, v0
  s_barrier
  s_lshl_b32 s29, s21, 6
  v_add_u32 v10, s29, v0
  s_getpc_b64 s[60:61]
.Lattn_kernel_pc_41:
  s_add_u32 s60, s60, .Lattn_kernel_tl_1-.Lattn_kernel_pc_41
  s_addc_u32 s61, s61, 0
  v_lshlrev_b32 v152, 7, v10
  v_min_u32 v152, .Ltext_end-.Lattn_kernel_tl_1-128, v152
  v_mov_b32 v153, s61
  v_add_co_u32 v152, vcc, s60, v152
  s_nop 1
  v_addc_co_u32 v153, vcc, 0, v153, vcc
  global_load_dword v154, v[152:153], off
  global_load_dword v155, v[152:153], off offset:64
  s_add_u32 s28, s27, 16384
  buffer_load_dword v16, v11, s[16:19], s28 offen sc1
  s_add_u32 s28, s27, 40960
  buffer_load_dword v17, v11, s[16:19], s28 offen sc1
  s_add_u32 s28, s27, 65536
  buffer_load_dword v18, v11, s[16:19], s28 offen sc1
  s_add_u32 s28, s27, 90112
  buffer_load_dword v19, v11, s[16:19], s28 offen sc1
  s_add_u32 s28, s27, 12288
  buffer_load_dword v20, v11, s[16:19], s28 offen sc1
  s_add_u32 s28, s27, 36864
  buffer_load_dword v21, v11, s[16:19], s28 offen sc1
  s_add_u32 s28, s27, 61440
  buffer_load_dword v22, v11, s[16:19], s28 offen sc1
  s_add_u32 s28, s27, 86016
  buffer_load_dword v23, v11, s[16:19], s28 offen sc1
  ds_read_b64_tr_b16 v[48:49], v7 offset:0
  ds_read_b64_tr_b16 v[50:51], v7 offset:512
  ds_read_b64_tr_b16 v[52:53], v7 offset:4096
  ds_read_b64_tr_b16 v[54:55], v7 offset:4608
  ds_read_b64_tr_b16 v[56:57], v7 offset:8192
  ds_read_b64_tr_b16 v[58:59], v7 offset:8704
  ds_read_b64_tr_b16 v[60:61], v7 offset:12288
  ds_read_b64_tr_b16 v[62:63], v7 offset:12800
  s_waitcnt lgkmcnt(4)
  ds_read_b64_tr_b16 v[64:65], v7 offset:16384
  ds_read_b64_tr_b16 v[66:67], v7 offset:16896
  ds_read_b64_tr_b16 v[68:69], v7 offset:20480
  ds_read_b64_tr_b16 v[70:71], v7 offset:20992
  ds_read_b64_tr_b16 v[72:73], v7 offset:24576
  ds_read_b64_tr_b16 v[74:75], v7 offset:25088
  ds_read_b64_tr_b16 v[76:77], v7 offset:28672
  ds_read_b64_tr_b16 v[78:79], v7 offset:29184
  v_mov_b32 v144, 0
  v_mov_b32 v145, 0
  v_mov_b32 v146, 0
  v_mov_b32 v147, 0
  s_lshr_b32 s26, s2, 2
  s_lshl_b32 s26, s26, 8
  s_lshl_b32 s27, s21, 6
  s_add_u32 s26, s26, s27
  s_mul_i32 s27, s25, 28672
  s_add_u32 s27, s27, s26
  s_add_u32 s27, s27, 524288
  s_add_u32 s28, s27, 14336
  s_waitcnt vmcnt(0)
  v_add_f32 v16, v16, v17
  v_add_f32 v18, v18, v19
  v_add_f32 v16, v16, v18
  v_cvt_pk_bf16_f32 v16, v16, v16
  v_and_b32 v16, 0xffff0000, v16
  v_add_f32 v16, 1.0, v16
  v_cvt_pk_bf16_f32 v16, v16, v16
  v_and_b32 v16, 0xffff0000, v16
  v_add_f32 v20, v20, v21
  v_add_f32 v22, v22, v23
  v_add_f32 v20, v20, v22
  v_cvt_pk_bf16_f32 v20, v20, v20
  v_and_b32 v20, 0xffff0000, v20
  s_lshl_b32 s26, s21, 7
  s_add_u32 s26, s26, 0
  v_lshl_add_u32 v10, v0, 1, s26
  ds_write_b16_d16_hi v10, v16
  ds_write_b16_d16_hi v10, v20 offset:512
  s_waitcnt lgkmcnt(0)
  s_barrier
  ds_read_b128 v[16:19], v9 offset:0
  ds_read_b128 v[20:23], v9 offset:64
  ds_read_b128 v[24:27], v9 offset:128
  ds_read_b128 v[28:31], v9 offset:192
  ds_read_b128 v[32:35], v9 offset:256
  ds_read_b128 v[36:39], v9 offset:320
  ds_read_b128 v[40:43], v9 offset:384
  ds_read_b128 v[44:47], v9 offset:448
  s_waitcnt lgkmcnt(0)
  v_mfma_f32_16x16x32_bf16 v[144:147], v[16:19], v[48:51], v[144:147]
  v_mfma_f32_16x16x32_bf16 v[144:147], v[20:23], v[52:55], v[144:147]
  v_mfma_f32_16x16x32_bf16 v[144:147], v[24:27], v[56:59], v[144:147]
  v_mfma_f32_16x16x32_bf16 v[144:147], v[28:31], v[60:63], v[144:147]
  v_mfma_f32_16x16x32_bf16 v[144:147], v[32:35], v[64:67], v[144:147]
  v_mfma_f32_16x16x32_bf16 v[144:147], v[36:39], v[68:71], v[144:147]
  v_mfma_f32_16x16x32_bf16 v[144:147], v[40:43], v[72:75], v[144:147]
  v_mfma_f32_16x16x32_bf16 v[144:147], v[44:47], v[76:79], v[144:147]
  s_cmp_ge_u32 s2, 224
  s_cbranch_scc1 .Lattn_kernel_nouv_42
  s_nop 7
  s_mov_b64 exec, 0xffff
  buffer_store_dword v144, v11, s[16:19], s27 offen sc0 sc1
  buffer_store_dword v145, v11, s[16:19], s28 offen sc0 sc1
  s_mov_b64 exec, -1
.Lattn_kernel_nouv_42:
  s_load_dwordx2 s[4:5], s[0:1], 16
  s_load_dwordx2 s[36:37], s[0:1], 0
  s_load_dwordx2 s[56:57], s[0:1], 32
  s_load_dwordx2 s[58:59], s[0:1], 64
  s_load_dwordx2 s[62:63], s[0:1], 40
  v_lshlrev_b32 v1, 4, v0
  v_lshrrev_b32 v7, 5, v0
  v_and_b32 v9, 31, v0
  s_waitcnt vmcnt(0)
  s_barrier
  s_setprio 0
.Lattn_kernel_tl_1:
  s_and_b32 s20, s2, 7
  s_lshr_b32 s21, s2, 3
  s_and_b32 s22, s20, 3
  s_lshr_b32 s23, s20, 2
  s_and_b32 s20, s21, 3
  s_lshr_b32 s21, s21, 2
  s_mul_i32 s22, s22, 4
  s_add_u32 s22, s22, s20
  s_mul_i32 s23, s23, 8
  s_add_u32 s23, s23, s21
  s_sub_u32 s25, s24, 4
  s_lshl_b32 s26, s25, 12
  v_add_u32 v2, s26, v1
  s_mul_i32 s28, s22, 262144
  s_mov_b32 s29, 0
  v_lshrrev_b32 v4, 3, v0
  v_and_b32 v3, 7, v0
  v_bfe_u32 v5, v0, 4, 1
  v_lshlrev_b32 v5, 2, v5
  v_xor_b32 v3, v3, v5
  s_lshl_b32 s26, s25, 4
  v_add_u32 v4, s26, v4
  v_mul_u32_u24 v4, 2048, v4
  v_lshl_add_u32 v4, v3, 4, v4
  s_mul_i32 s26, s23, 128
  v_add_u32 v4, s26, v4
  v_add_u32 v104, 0, v4
  v_add_u32 v105, 15360, v4
  s_mov_b32 s54, 131072
  s_mov_b32 s53, 7208960
  s_and_b32 s26, s23, 7
  s_cmp_lg_u32 s26, 3
  s_cbranch_scc1 .Lattn_kernel_untiled_43
  s_mov_b32 s54, 8192
  s_mov_b32 s53, 450560
  s_lshr_b32 s26, s23, 3
  s_lshl_b32 s29, s26, 17
  s_add_u32 s29, s29, 786432
  s_lshl_b32 s26, s25, 11
  v_add_u32 v4, s26, v1
  v_add_u32 v104, 0, v4
  v_add_u32 v105, 0, v4
.Lattn_kernel_untiled_43:
  s_lshl_b32 s31, s25, 12
  s_lshl_b32 s32, s25, 11
  s_add_u32 s32, s32, 16384
  s_mov_b32 s30, 0
  s_mov_b32 s34, 0
  s_mov_b32 s35, 0
  v_lshlrev_b32 v12, 2, v0
  s_waitcnt lgkmcnt(0)
  s_add_u32 s8, s6, 0x1100000
  s_addc_u32 s9, s7, 0
  s_mov_b32 s10, 0x400000
  s_mov_b32 s11, 0x20000
  s_mov_b32 s12, s4
  s_mov_b32 s13, s5
  s_mov_b32 s14, 0x200000
  s_mov_b32 s15, 0x20000
  s_add_u32 s26, s6, 0x3800000
  s_addc_u32 s27, s7, 0
  s_cmp_eq_u32 s54, 8192
  s_cselect_b32 s12, s26, s12
  s_cselect_b32 s13, s27, s13
  s_cselect_b32 s14, 1048576, s14
  s_add_u32 s16, s6, 0x0
  s_addc_u32 s17, s7, 0
  s_mov_b32 s18, 0x100000
  s_mov_b32 s19, 0x20000
  s_mul_i32 s26, s54, 0
  s_add_u32 s26, s26, s29
  s_add_u32 s33, 0, s32
  s_add_u32 m0, s33, 0
  s_nop 0
  buffer_load_dwordx4 v104, s[12:15], s26 offen offset:0 lds
  buffer_load_dwordx4 v105, s[12:15], s26 offen offset:1024 lds
  s_mul_i32 s26, s54, 1
  s_add_u32 s26, s26, s29
  s_add_u32 s33, 24576, s32
  s_add_u32 m0, s33, 0
  s_nop 0
  buffer_load_dwordx4 v104, s[12:15], s26 offen offset:0 lds
  buffer_load_dwordx4 v105, s[12:15], s26 offen offset:1024 lds
  s_mul_i32 s26, s54, 2
  s_add_u32 s26, s26, s29
  s_add_u32 s33, 49152, s32
  s_add_u32 m0, s33, 0
  s_nop 0
  buffer_load_dwordx4 v104, s[12:15], s26 offen offset:0 lds
  buffer_load_dwordx4 v105, s[12:15], s26 offen offset:1024 lds
  s_barrier
  s_barrier
  s_add_u32 m0, s30, s31
  s_nop 0
  buffer_load_dwordx4 v2, s[8:11], s28 offen offset:0 sc1 lds
  buffer_load_dwordx4 v2, s[8:11], s28 offen offset:1024 sc1 lds
  buffer_load_dwordx4 v2, s[8:11], s28 offen offset:2048 sc1 lds
  buffer_load_dwordx4 v2, s[8:11], s28 offen offset:3072 sc1 lds
  s_add_u32 s28, s28, 16384
  s_add_u32 s29, s29, s54
  s_add_u32 s30, s30, 24576
  s_cmp_eq_u32 s30, 122880
  s_cselect_b32 s30, 0, s30
  s_add_u32 s34, s34, 1
  s_add_u32 m0, s30, s31
  s_nop 0
  buffer_load_dwordx4 v2, s[8:11], s28 offen offset:0 sc1 lds
  buffer_load_dwordx4 v2, s[8:11], s28 offen offset:1024 sc1 lds
  buffer_load_dwordx4 v2, s[8:11], s28 offen offset:2048 sc1 lds
  buffer_load_dwordx4 v2, s[8:11], s28 offen offset:3072 sc1 lds
  s_add_u32 s28, s28, 16384
  s_add_u32 s29, s29, s54
  s_add_u32 s30, s30, 24576
  s_cmp_eq_u32 s30, 122880
  s_cselect_b32 s30, 0, s30
  s_add_u32 s34, s34, 1
  s_add_u32 m0, s30, s31
  s_nop 0
  buffer_load_dwordx4 v2, s[8:11], s28 offen offset:0 sc1 lds
  buffer_load_dwordx4 v2, s[8:11], s28 offen offset:1024 sc1 lds
  buffer_load_dwordx4 v2, s[8:11], s28 offen offset:2048 sc1 lds
  buffer_load_dwordx4 v2, s[8:11], s28 offen offset:3072 sc1 lds
  s_add_u32 s28, s28, 16384
  s_add_u32 s29, s29, s54
  s_add_u32 s30, s30, 24576
  s_cmp_eq_u32 s30, 122880
  s_cselect_b32 s30, 0, s30
  s_add_u32 s34, s34, 1
  s_waitcnt vmcnt(8)
  s_barrier
  s_add_u32 m0, s30, s31
  s_nop 0
  buffer_load_dwordx4 v2, s[8:11], s28 offen offset:0 sc1 lds
  buffer_load_dwordx4 v2, s[8:11], s28 offen offset:1024 sc1 lds
  buffer_load_dwordx4 v2, s[8:11], s28 offen offset:2048 sc1 lds
  buffer_load_dwordx4 v2, s[8:11], s28 offen offset:3072 sc1 lds
  s_add_u32 s33, s30, s32
  s_add_u32 m0, s33, 0
  s_nop 0
  buffer_load_dwordx4 v104, s[12:15], s29 offen offset:0 lds
  buffer_load_dwordx4 v105, s[12:15], s29 offen offset:1024 lds
  s_add_u32 s28, s28, 16384
  s_add_u32 s29, s29, s54
  s_add_u32 s30, s30, 24576
  s_cmp_eq_u32 s30, 122880
  s_cselect_b32 s30, 0, s30
  s_add_u32 s34, s34, 1
  s_waitcnt vmcnt(10)
  s_barrier
  s_add_u32 m0, s30, s31
  s_nop 0
  buffer_load_dwordx4 v2, s[8:11], s28 offen offset:0 sc1 lds
  buffer_load_dwordx4 v2, s[8:11], s28 offen offset:1024 sc1 lds
  buffer_load_dwordx4 v2, s[8:11], s28 offen offset:2048 sc1 lds
  buffer_load_dwordx4 v2, s[8:11], s28 offen offset:3072 sc1 lds
  s_add_u32 s33, s30, s32
  s_add_u32 m0, s33, 0
  s_nop 0
  buffer_load_dwordx4 v104, s[12:15], s29 offen offset:0 lds
  buffer_load_dwordx4 v105, s[12:15], s29 offen offset:1024 lds
  s_add_u32 s28, s28, 16384
  s_add_u32 s29, s29, s54
  s_add_u32 s30, s30, 24576
  s_cmp_eq_u32 s30, 122880
  s_cselect_b32 s30, 0, s30
  s_add_u32 s34, s34, 1
.Lattn_kernel_lmain_46:
  s_waitcnt vmcnt(12)
  s_barrier
  s_add_u32 m0, s30, s31
  s_nop 0
  buffer_load_dwordx4 v2, s[8:11], s28 offen offset:0 sc1 lds
  buffer_load_dwordx4 v2, s[8:11], s28 offen offset:1024 sc1 lds
  buffer_load_dwordx4 v2, s[8:11], s28 offen offset:2048 sc1 lds
  buffer_load_dwordx4 v2, s[8:11], s28 offen offset:3072 sc1 lds
  s_add_u32 s33, s30, s32
  s_add_u32 m0, s33, 0
  s_nop 0
  buffer_load_dwordx4 v104, s[12:15], s29 offen offset:0 lds
  buffer_load_dwordx4 v105, s[12:15], s29 offen offset:1024 lds
  s_add_u32 s28, s28, 16384
  s_add_u32 s29, s29, s54
  s_add_u32 s30, s30, 24576
  s_cmp_eq_u32 s30, 122880
  s_cselect_b32 s30, 0, s30
  s_add_u32 s34, s34, 1
  s_cmp_lt_u32 s34, 7
  s_cbranch_scc1 .Lattn_kernel_lmain_46
  s_cmp_lg_u32 s25, 0
  s_cbranch_scc1 .Lattn_kernel_nopoll_44
  s_lshl_b32 s38, s22, 8
  s_add_u32 s38, s38, 684032
  v_mov_b32 v30, 0
  v_mov_b32 v31, 0
  s_mov_b64 exec, 1
  buffer_atomic_add v30, v31, s[16:19], s38 offen sc0 sc1
  s_mov_b64 exec, -1
.Lattn_kernel_nopoll_44:
.Lattn_kernel_lmain_47:
  s_waitcnt vmcnt(12)
  s_barrier
  s_add_u32 m0, s30, s31
  s_nop 0
  buffer_load_dwordx4 v2, s[8:11], s28 offen offset:0 sc1 lds
  buffer_load_dwordx4 v2, s[8:11], s28 offen offset:1024 sc1 lds
  buffer_load_dwordx4 v2, s[8:11], s28 offen offset:2048 sc1 lds
  buffer_load_dwordx4 v2, s[8:11], s28 offen offset:3072 sc1 lds
  s_add_u32 s33, s30, s32
  s_add_u32 m0, s33, 0
  s_nop 0
  buffer_load_dwordx4 v104, s[12:15], s29 offen offset:0 lds
  buffer_load_dwordx4 v105, s[12:15], s29 offen offset:1024 lds
  s_add_u32 s28, s28, 16384
  s_add_u32 s29, s29, s54
  s_add_u32 s30, s30, 24576
  s_cmp_eq_u32 s30, 122880
  s_cselect_b32 s30, 0, s30
  s_add_u32 s34, s34, 1
  s_cmp_lt_u32 s34, 10
  s_cbranch_scc1 .Lattn_kernel_lmain_47
  s_cmp_lg_u32 s25, 0
  s_cbranch_scc1 .Lattn_kernel_nopoll_45
  s_mov_b32 s39, 0
  s_branch .Lattn_kernel_chk_49
.Lattn_kernel_spin_48:
  v_mov_b32 v30, 0
  v_mov_b32 v31, 0
  s_mov_b64 exec, 1
  buffer_atomic_add v30, v31, s[16:19], s38 offen sc0 sc1
  s_mov_b64 exec, -1
  s_waitcnt vmcnt(0)
.Lattn_kernel_chk_49:
  v_cmp_gt_u32 vcc, 16, v30
  s_add_u32 s39, s39, 1
  s_and_b32 s61, vcc_lo, 1
  s_cbranch_scc0 .Lattn_kernel_go_50
  s_sleep 6
  s_cmp_lt_u32 s39, 131072
  s_cbranch_scc1 .Lattn_kernel_spin_48
.Lattn_kernel_go_50:
.Lattn_kernel_nopoll_45:
.Lattn_kernel_lmain_51:
  s_waitcnt vmcnt(12)
  s_barrier
  s_add_u32 m0, s30, s31
  s_nop 0
  buffer_load_dwordx4 v2, s[8:11], s28 offen offset:0 sc1 lds
  buffer_load_dwordx4 v2, s[8:11], s28 offen offset:1024 sc1 lds
  buffer_load_dwordx4 v2, s[8:11], s28 offen offset:2048 sc1 lds
  buffer_load_dwordx4 v2, s[8:11], s28 offen offset:3072 sc1 lds
  s_add_u32 s33, s30, s32
  s_add_u32 m0, s33, 0
  s_nop 0
  buffer_load_dwordx4 v104, s[12:15], s29 offen offset:0 lds
  buffer_load_dwordx4 v105, s[12:15], s29 offen offset:1024 lds
  s_add_u32 s28, s28, 16384
  s_add_u32 s29, s29, s54
  s_add_u32 s30, s30, 24576
  s_cmp_eq_u32 s30, 122880
  s_cselect_b32 s30, 0, s30
  s_add_u32 s34, s34, 1
  s_cmp_lt_u32 s34, 11
  s_cbranch_scc1 .Lattn_kernel_lmain_51
  s_lshl_b32 s26, s23, 8
  s_bitcmp1_b32 s25, 0
  s_cselect_b32 s27, 8192, 0
  s_add_u32 s26, s26, s27
  s_add_u32 s27, s26, 8192
  buffer_load_dword v32, v12, s[16:19], s27 offen sc1
  s_add_u32 s27, s26, 32768
  buffer_load_dword v33, v12, s[16:19], s27 offen sc1
  s_add_u32 s27, s26, 57344
  buffer_load_dword v34, v12, s[16:19], s27 offen sc1
  s_add_u32 s27, s26, 81920
  buffer_load_dword v35, v12, s[16:19], s27 offen sc1
  s_mov_b32 s40, s36
  s_mov_b32 s41, s37
  s_mov_b32 s42, 0x400000
  s_mov_b32 s43, 0x20000
  v_lshrrev_b32 v13, 3, v0
  v_and_b32 v14, 7, v0
  v_xor_b32 v14, v14, v13
  v_lshlrev_b32 v14, 4, v14
  v_lshl_add_u32 v13, v13, 11, v14
  s_lshl_b32 s26, s22, 18
  s_lshl_b32 s27, s25, 16
  s_add_u32 s26, s26, s27
  s_lshl_b32 s27, s23, 7
  s_add_u32 s26, s26, s27
  s_add_u32 m0, s31, 123904
  s_nop 0
  buffer_load_dwordx4 v13, s[40:43], s26 offen lds
  s_add_u32 s26, s26, 16384
  s_add_u32 m0, s31, 124928
  s_nop 0
  buffer_load_dwordx4 v13, s[40:43], s26 offen lds
  s_add_u32 s26, s26, 16384
  s_add_u32 m0, s31, 125952
  s_nop 0
  buffer_load_dwordx4 v13, s[40:43], s26 offen lds
  s_add_u32 s26, s26, 16384
  s_add_u32 m0, s31, 126976
  s_nop 0
  buffer_load_dwordx4 v13, s[40:43], s26 offen lds
  s_add_u32 s26, s26, 16384
.Lattn_kernel_lmain_52:
  s_waitcnt vmcnt(12)
  s_barrier
  s_add_u32 m0, s30, s31
  s_nop 0
  buffer_load_dwordx4 v2, s[8:11], s28 offen offset:0 sc1 lds
  buffer_load_dwordx4 v2, s[8:11], s28 offen offset:1024 sc1 lds
  buffer_load_dwordx4 v2, s[8:11], s28 offen offset:2048 sc1 lds
  buffer_load_dwordx4 v2, s[8:11], s28 offen offset:3072 sc1 lds
  s_add_u32 s33, s30, s32
  s_add_u32 m0, s33, 0
  s_nop 0
  buffer_load_dwordx4 v104, s[12:15], s29 offen offset:0 lds
  buffer_load_dwordx4 v105, s[12:15], s29 offen offset:1024 lds
  s_add_u32 s28, s28, 16384
  s_add_u32 s29, s29, s54
  s_add_u32 s30, s30, 24576
  s_cmp_eq_u32 s30, 122880
  s_cselect_b32 s30, 0, s30
  s_add_u32 s34, s34, 1
  s_cmp_lt_u32 s34, 16
  s_cbranch_scc1 .Lattn_kernel_lmain_52
  v_add_u32 v15, 122880, v12
  v_add_f32 v32, v32, v33
  v_add_f32 v34, v34, v35
  v_add_f32 v32, v32, v34
  v_cvt_pk_bf16_f32 v32, v32, v32
  v_and_b32 v32, 0xffff0000, v32
  s_and_b32 s27, s25, 1
  v_cvt_f32_u32 v14, s27
  s_lshl_b32 s27, s27, 8
  v_add_u32 v15, s27, v15
  v_add_f32 v32, v14, v32
  v_cvt_pk_bf16_f32 v32, v32, v32
  v_and_b32 v32, 0xffff0000, v32
  ds_write_b32 v15, v32
  s_waitcnt lgkmcnt(0)
  s_waitcnt vmcnt(12)
  s_barrier
  s_waitcnt vmcnt(6)
  s_barrier
  s_waitcnt vmcnt(0)
  s_barrier
  s_barrier
  s_cmp_ge_u32 s2, 224
  s_cbranch_scc1 .Lattn_kernel_skip_53
  s_mov_b32 s55, s23
  s_and_b32 s20, s2, 7
  s_lshr_b32 s21, s2, 3
  s_and_b32 s22, s20, 3
  s_lshr_b32 s23, s20, 2
  s_and_b32 s20, s21, 3
  s_lshr_b32 s21, s21, 2
  s_mul_i32 s22, s22, 4
  s_add_u32 s22, s22, s20
  s_mul_i32 s23, s23, 7
  s_add_u32 s23, s23, s21
  s_sub_u32 s25, s24, 4
  s_lshl_b32 s26, s25, 12
  v_add_u32 v2, s26, v1
  s_mul_i32 s28, s22, 262144
  s_mov_b32 s29, 0
  v_lshrrev_b32 v4, 3, v0
  v_and_b32 v3, 7, v0
  v_bfe_u32 v5, v0, 4, 2
  v_lshlrev_b32 v5, 1, v5
  v_xor_b32 v3, v3, v5
  s_lshl_b32 s26, s25, 4
  v_add_u32 v4, s26, v4
  v_mul_u32_u24 v4, 7168, v4
  v_lshl_add_u32 v4, v3, 4, v4
  s_mul_i32 s26, s23, 512
  v_add_u32 v4, s26, v4
  v_add_u32 v104, 0, v4
  v_add_u32 v105, 56320, v4
  v_add_u32 v106, 128, v4
  v_add_u32 v107, 56448, v4
  v_add_u32 v108, 256, v4
  v_add_u32 v109, 56576, v4
  v_add_u32 v110, 384, v4
  v_add_u32 v111, 56704, v4
  s_lshl_b32 s31, s25, 12
  s_lshl_b32 s32, s25, 11
  s_add_u32 s32, s32, 16384
  s_mov_b32 s30, 0
  s_mov_b32 s34, 0
  s_mov_b32 s35, 0
  v_lshlrev_b32 v12, 2, v0
  s_add_u32 s8, s6, 0x1900000
  s_addc_u32 s9, s7, 0
  s_mov_b32 s10, 0x400000
  s_mov_b32 s11, 0x20000
  s_mov_b32 s12, s56
  s_mov_b32 s13, s57
  s_mov_b32 s14, 0x700000
  s_mov_b32 s15, 0x20000
  s_add_u32 s16, s6, 0x0
  s_addc_u32 s17, s7, 0
  s_mov_b32 s18, 0x100000
  s_mov_b32 s19, 0x20000
  s_cmp_eq_u32 s35, s55
  s_cselect_b32 s27, 16384, 0
  s_cselect_b32 s26, 458752, 0
  s_addc_u32 s35, s35, 0
  s_add_u32 s28, s28, s27
  s_add_u32 s29, s29, s26
  s_barrier
  s_mul_i32 s26, s55, 458752
  s_add_u32 s33, 0, s32
  s_add_u32 m0, s33, 0
  s_nop 0
  buffer_load_dwordx4 v104, s[12:15], s26 offen offset:0 lds
  buffer_load_dwordx4 v105, s[12:15], s26 offen offset:1024 lds
  s_add_u32 m0, s33, 8192
  s_nop 0
  buffer_load_dwordx4 v106, s[12:15], s26 offen offset:0 lds
  buffer_load_dwordx4 v107, s[12:15], s26 offen offset:1024 lds
  s_add_u32 m0, s33, 16384
  s_nop 0
  buffer_load_dwordx4 v108, s[12:15], s26 offen offset:0 lds
  buffer_load_dwordx4 v109, s[12:15], s26 offen offset:1024 lds
  s_add_u32 m0, s33, 24576
  s_nop 0
  buffer_load_dwordx4 v110, s[12:15], s26 offen offset:0 lds
  buffer_load_dwordx4 v111, s[12:15], s26 offen offset:1024 lds
  s_add_u32 s33, 49152, s32
  s_add_u32 m0, s33, 0
  s_nop 0
  buffer_load_dwordx4 v104, s[12:15], s29 offen offset:0 lds
  buffer_load_dwordx4 v105, s[12:15], s29 offen offset:1024 lds
  s_add_u32 m0, s33, 8192
  s_nop 0
  buffer_load_dwordx4 v106, s[12:15], s29 offen offset:0 lds
  buffer_load_dwordx4 v107, s[12:15], s29 offen offset:1024 lds
  s_add_u32 m0, s33, 16384
  s_nop 0
  buffer_load_dwordx4 v108, s[12:15], s29 offen offset:0 lds
  buffer_load_dwordx4 v109, s[12:15], s29 offen offset:1024 lds
  s_add_u32 m0, s33, 24576
  s_nop 0
  buffer_load_dwordx4 v110, s[12:15], s29 offen offset:0 lds
  buffer_load_dwordx4 v111, s[12:15], s29 offen offset:1024 lds
  s_add_u32 s26, s35, 1
  s_cmp_eq_u32 s26, s55
  s_addc_u32 s26, s26, 0
  s_mul_i32 s26, s26, 458752
  s_waitcnt vmcnt(8)
  s_barrier
  s_add_u32 s33, 98304, s32
  s_add_u32 m0, s33, 0
  s_nop 0
  buffer_load_dwordx4 v104, s[12:15], s26 offen offset:0 lds
  buffer_load_dwordx4 v105, s[12:15], s26 offen offset:1024 lds
  s_add_u32 m0, s33, 8192
  s_nop 0
  buffer_load_dwordx4 v106, s[12:15], s26 offen offset:0 lds
  buffer_load_dwordx4 v107, s[12:15], s26 offen offset:1024 lds
  s_add_u32 m0, s33, 16384
  s_nop 0
  buffer_load_dwordx4 v108, s[12:15], s26 offen offset:0 lds
  buffer_load_dwordx4 v109, s[12:15], s26 offen offset:1024 lds
  s_add_u32 m0, s33, 24576
  s_nop 0
  buffer_load_dwordx4 v110, s[12:15], s26 offen offset:0 lds
  buffer_load_dwordx4 v111, s[12:15], s26 offen offset:1024 lds
  v_mov_b32 v13, 163788
  s_cmp_lg_u32 s25, 0
  s_cbranch_scc1 .Lattn_kernel_others_54
  s_lshl_b32 s38, s22, 8
  s_add_u32 s38, s38, 655360
  s_mov_b32 s39, 0
.Lattn_kernel_spin_56:
  v_mov_b32 v30, 0
  v_mov_b32 v31, 0
  s_mov_b64 exec, 1
  buffer_atomic_add v30, v31, s[16:19], s38 offen sc0 sc1
  s_mov_b64 exec, -1
  s_waitcnt vmcnt(0)
.Lattn_kernel_chk_57:
  v_cmp_gt_u32 vcc, 16, v30
  s_add_u32 s39, s39, 1
  s_and_b32 s61, vcc_lo, 1
  s_cbranch_scc0 .Lattn_kernel_go_58
  s_sleep 1
  s_cmp_lt_u32 s39, 131072
  s_cbranch_scc1 .Lattn_kernel_spin_56
.Lattn_kernel_go_58:
  v_mov_b32 v14, 1
  ds_write_b32 v13, v14
  s_branch .Lattn_kernel_lgo_55
.Lattn_kernel_others_54:
  s_sleep 1
  ds_read_b32 v14, v13
  s_waitcnt lgkmcnt(0)
  v_readfirstlane_b32 s26, v14
  s_nop 3
  s_cmp_eq_u32 s26, 0
  s_cbranch_scc1 .Lattn_kernel_others_54
.Lattn_kernel_lgo_55:
  s_mov_b32 s30, 49152
  s_mov_b32 s34, 1
  s_add_u32 m0, s30, s31
  s_nop 0
  buffer_load_dwordx4 v2, s[8:11], s28 offen offset:0 sc1 lds
  buffer_load_dwordx4 v2, s[8:11], s28 offen offset:1024 sc1 lds
  buffer_load_dwordx4 v2, s[8:11], s28 offen offset:2048 sc1 lds
  buffer_load_dwordx4 v2, s[8:11], s28 offen offset:3072 sc1 lds
  s_add_u32 s28, s28, 16384
  s_add_u32 s29, s29, 458752
  s_add_u32 s35, s35, 1
  s_cmp_eq_u32 s35, s55
  s_cselect_b32 s27, 16384, 0
  s_cselect_b32 s26, 458752, 0
  s_addc_u32 s35, s35, 0
  s_add_u32 s28, s28, s27
  s_add_u32 s29, s29, s26
  s_add_u32 s30, s30, 49152
  s_cmp_eq_u32 s30, 147456
  s_cselect_b32 s30, 0, s30
  s_add_u32 s34, s34, 1
  s_add_u32 m0, s30, s31
  s_nop 0
  buffer_load_dwordx4 v2, s[8:11], s28 offen offset:0 sc1 lds
  buffer_load_dwordx4 v2, s[8:11], s28 offen offset:1024 sc1 lds
  buffer_load_dwordx4 v2, s[8:11], s28 offen offset:2048 sc1 lds
  buffer_load_dwordx4 v2, s[8:11], s28 offen offset:3072 sc1 lds
  s_add_u32 s28, s28, 16384
  s_add_u32 s29, s29, 458752
  s_add_u32 s35, s35, 1
  s_cmp_eq_u32 s35, s55
  s_cselect_b32 s27, 16384, 0
  s_cselect_b32 s26, 458752, 0
  s_addc_u32 s35, s35, 0
  s_add_u32 s28, s28, s27
  s_add_u32 s29, s29, s26
  s_add_u32 s30, s30, 49152
  s_cmp_eq_u32 s30, 147456
  s_cselect_b32 s30, 0, s30
  s_add_u32 s34, s34, 1
  s_waitcnt vmcnt(4)
  s_barrier
  s_add_u32 m0, s30, s31
  s_nop 0
  buffer_load_dwordx4 v2, s[8:11], s28 offen offset:0 sc1 lds
  buffer_load_dwordx4 v2, s[8:11], s28 offen offset:1024 sc1 lds
  buffer_load_dwordx4 v2, s[8:11], s28 offen offset:2048 sc1 lds
  buffer_load_dwordx4 v2, s[8:11], s28 offen offset:3072 sc1 lds
  s_add_u32 s33, s30, s32
  s_add_u32 m0, s33, 0
  s_nop 0
  buffer_load_dwordx4 v104, s[12:15], s29 offen offset:0 lds
  buffer_load_dwordx4 v105, s[12:15], s29 offen offset:1024 lds
  s_add_u32 m0, s33, 8192
  s_nop 0
  buffer_load_dwordx4 v106, s[12:15], s29 offen offset:0 lds
  buffer_load_dwordx4 v107, s[12:15], s29 offen offset:1024 lds
  s_add_u32 m0, s33, 16384
  s_nop 0
  buffer_load_dwordx4 v108, s[12:15], s29 offen offset:0 lds
  buffer_load_dwordx4 v109, s[12:15], s29 offen offset:1024 lds
  s_add_u32 m0, s33, 24576
  s_nop 0
  buffer_load_dwordx4 v110, s[12:15], s29 offen offset:0 lds
  buffer_load_dwordx4 v111, s[12:15], s29 offen offset:1024 lds
  s_add_u32 s28, s28, 16384
  s_add_u32 s29, s29, 458752
  s_add_u32 s35, s35, 1
  s_cmp_eq_u32 s35, s55
  s_cselect_b32 s27, 16384, 0
  s_cselect_b32 s26, 458752, 0
  s_addc_u32 s35, s35, 0
  s_add_u32 s28, s28, s27
  s_add_u32 s29, s29, s26
  s_add_u32 s30, s30, 49152
  s_cmp_eq_u32 s30, 147456
  s_cselect_b32 s30, 0, s30
  s_add_u32 s34, s34, 1
.Lattn_kernel_lmain_59:
  s_waitcnt vmcnt(12)
  s_barrier
  s_add_u32 m0, s30, s31
  s_nop 0
  buffer_load_dwordx4 v2, s[8:11], s28 offen offset:0 sc1 lds
  buffer_load_dwordx4 v2, s[8:11], s28 offen offset:1024 sc1 lds
  buffer_load_dwordx4 v2, s[8:11], s28 offen offset:2048 sc1 lds
  buffer_load_dwordx4 v2, s[8:11], s28 offen offset:3072 sc1 lds
  s_add_u32 s33, s30, s32
  s_add_u32 m0, s33, 0
  s_nop 0
  buffer_load_dwordx4 v104, s[12:15], s29 offen offset:0 lds
  buffer_load_dwordx4 v105, s[12:15], s29 offen offset:1024 lds
  s_add_u32 m0, s33, 8192
  s_nop 0
  buffer_load_dwordx4 v106, s[12:15], s29 offen offset:0 lds
  buffer_load_dwordx4 v107, s[12:15], s29 offen offset:1024 lds
  s_add_u32 m0, s33, 16384
  s_nop 0
  buffer_load_dwordx4 v108, s[12:15], s29 offen offset:0 lds
  buffer_load_dwordx4 v109, s[12:15], s29 offen offset:1024 lds
  s_add_u32 m0, s33, 24576
  s_nop 0
  buffer_load_dwordx4 v110, s[12:15], s29 offen offset:0 lds
  buffer_load_dwordx4 v111, s[12:15], s29 offen offset:1024 lds
  s_add_u32 s28, s28, 16384
  s_add_u32 s29, s29, 458752
  s_add_u32 s35, s35, 1
  s_cmp_eq_u32 s35, s55
  s_cselect_b32 s27, 16384, 0
  s_cselect_b32 s26, 458752, 0
  s_addc_u32 s35, s35, 0
  s_add_u32 s28, s28, s27
  s_add_u32 s29, s29, s26
  s_add_u32 s30, s30, 49152
  s_cmp_eq_u32 s30, 147456
  s_cselect_b32 s30, 0, s30
  s_add_u32 s34, s34, 1
  s_cmp_lt_u32 s34, 12
  s_cbranch_scc1 .Lattn_kernel_lmain_59
  s_lshl_b32 s26, s22, 7
  s_lshl_b32 s27, s25, 5
  s_add_u32 s26, s26, s27
  v_add_u32 v13, s26, v9
  v_lshlrev_b32 v14, 3, v13
  v_lshl_add_u32 v14, v7, 17, v14
  s_mov_b32 s27, 262144
  buffer_load_dwordx2 v[36:37], v14, s[16:19], s27 offen sc1
  s_mov_b32 s27, 278528
  buffer_load_dwordx2 v[38:39], v14, s[16:19], s27 offen sc1
  s_mov_b32 s27, 294912
  buffer_load_dwordx2 v[40:41], v14, s[16:19], s27 offen sc1
  s_mov_b32 s27, 311296
  buffer_load_dwordx2 v[42:43], v14, s[16:19], s27 offen sc1
  s_mov_b32 s27, 327680
  buffer_load_dwordx2 v[44:45], v14, s[16:19], s27 offen sc1
  s_mov_b32 s27, 344064
  buffer_load_dwordx2 v[46:47], v14, s[16:19], s27 offen sc1
  s_mov_b32 s27, 360448
  buffer_load_dwordx2 v[48:49], v14, s[16:19], s27 offen sc1
  s_mov_b32 s27, 376832
  buffer_load_dwordx2 v[50:51], v14, s[16:19], s27 offen sc1
  s_lshl_b32 s26, s23, 10
  s_lshl_b32 s27, s25, 8
  s_add_u32 s26, s26, s27
  s_add_u32 s27, s26, 524288
  buffer_load_dword v52, v12, s[16:19], s27 offen sc1
  s_add_u32 s27, s26, 552960
  buffer_load_dword v53, v12, s[16:19], s27 offen sc1
  s_add_u32 s27, s26, 581632
  buffer_load_dword v54, v12, s[16:19], s27 offen sc1
  s_add_u32 s27, s26, 610304
  buffer_load_dword v55, v12, s[16:19], s27 offen sc1
  s_add_u32 s27, s26, 538624
  buffer_load_dword v56, v12, s[16:19], s27 offen sc1
  s_add_u32 s27, s26, 567296
  buffer_load_dword v57, v12, s[16:19], s27 offen sc1
  s_add_u32 s27, s26, 595968
  buffer_load_dword v58, v12, s[16:19], s27 offen sc1
  s_add_u32 s27, s26, 624640
  buffer_load_dword v59, v12, s[16:19], s27 offen sc1
.Lattn_kernel_lmain_60:
  s_waitcnt vmcnt(12)
  s_barrier
  s_add_u32 m0, s30, s31
  s_nop 0
  buffer_load_dwordx4 v2, s[8:11], s28 offen offset:0 sc1 lds
  buffer_load_dwordx4 v2, s[8:11], s28 offen offset:1024 sc1 lds
  buffer_load_dwordx4 v2, s[8:11], s28 offen offset:2048 sc1 lds
  buffer_load_dwordx4 v2, s[8:11], s28 offen offset:3072 sc1 lds
  s_add_u32 s33, s30, s32
  s_add_u32 m0, s33, 0
  s_nop 0
  buffer_load_dwordx4 v104, s[12:15], s29 offen offset:0 lds
  buffer_load_dwordx4 v105, s[12:15], s29 offen offset:1024 lds
  s_add_u32 m0, s33, 8192
  s_nop 0
  buffer_load_dwordx4 v106, s[12:15], s29 offen offset:0 lds
  buffer_load_dwordx4 v107, s[12:15], s29 offen offset:1024 lds
  s_add_u32 m0, s33, 16384
  s_nop 0
  buffer_load_dwordx4 v108, s[12:15], s29 offen offset:0 lds
  buffer_load_dwordx4 v109, s[12:15], s29 offen offset:1024 lds
  s_add_u32 m0, s33, 24576
  s_nop 0
  buffer_load_dwordx4 v110, s[12:15], s29 offen offset:0 lds
  buffer_load_dwordx4 v111, s[12:15], s29 offen offset:1024 lds
  s_add_u32 s28, s28, 16384
  s_add_u32 s29, s29, 458752
  s_add_u32 s35, s35, 1
  s_cmp_eq_u32 s35, s55
  s_cselect_b32 s27, 16384, 0
  s_cselect_b32 s26, 458752, 0
  s_addc_u32 s35, s35, 0
  s_add_u32 s28, s28, s27
  s_add_u32 s29, s29, s26
  s_add_u32 s30, s30, 49152
  s_cmp_eq_u32 s30, 147456
  s_cselect_b32 s30, 0, s30
  s_add_u32 s34, s34, 1
  s_cmp_lt_u32 s34, 16
  s_cbranch_scc1 .Lattn_kernel_lmain_60
  v_add_f32 v16, v36, v38
  v_add_f32 v18, v37, v39
  v_add_f32 v16, v16, v40
  v_add_f32 v18, v18, v41
  v_add_f32 v16, v16, v42
  v_add_f32 v18, v18, v43
  v_add_f32 v16, v16, v44
  v_add_f32 v18, v18, v45
  v_add_f32 v16, v16, v46
  v_add_f32 v18, v18, v47
  v_add_f32 v16, v16, v48
  v_add_f32 v18, v18, v49
  v_add_f32 v16, v16, v50
  v_add_f32 v18, v18, v51
  v_mov_b32 v17, v16
  s_nop 1
  v_permlane32_swap_b32 v16, v17
  s_nop 1
  v_add_f32 v16, v16, v17
  v_mul_f32 v16, 0xba800000, v16
  s_mov_b32 s27, 0x3c800000
  v_mov_b32 v19, 0
  v_fma_f32 v17, v36, s27, v16
  v_fmac_f32 v19, v17, v17
  v_fma_f32 v17, v38, s27, v16
  v_fmac_f32 v19, v17, v17
  v_fma_f32 v17, v40, s27, v16
  v_fmac_f32 v19, v17, v17
  v_fma_f32 v17, v42, s27, v16
  v_fmac_f32 v19, v17, v17
  v_fma_f32 v17, v44, s27, v16
  v_fmac_f32 v19, v17, v17
  v_fma_f32 v17, v46, s27, v16
  v_fmac_f32 v19, v17, v17
  v_fma_f32 v17, v48, s27, v16
  v_fmac_f32 v19, v17, v17
  v_fma_f32 v17, v50, s27, v16
  v_fmac_f32 v19, v17, v17
  v_fmac_f32 v18, 0x42800000, v19
  v_mov_b32 v17, v18
  s_nop 1
  v_permlane32_swap_b32 v18, v17
  s_nop 1
  v_add_f32 v18, v18, v17
  v_mov_b32 v20, 0x3727c5ac
  v_fmac_f32 v20, 0x3a800000, v18
  v_sqrt_f32 v21, v20
  v_add_f32 v52, v52, v53
  v_add_f32 v54, v54, v55
  v_add_f32 v52, v52, v54
  v_add_f32 v56, v56, v57
  v_add_f32 v58, v58, v59
  v_add_f32 v56, v56, v58
  v_cvt_pk_bf16_f32 v22, v16, v16
  v_and_b32 v22, 0xffff0000, v22
  v_sub_f32 v23, v16, v22
  v_cvt_pk_bf16_f32 v24, v21, v21
  v_and_b32 v24, 0xffff0000, v24
  v_sub_f32 v25, v21, v24
  v_cvt_pk_bf16_f32 v26, v52, v52
  v_and_b32 v26, 0xffff0000, v26
  v_sub_f32 v27, v52, v26
  v_cvt_pk_bf16_f32 v28, v56, v56
  v_and_b32 v28, 0xffff0000, v28
  v_sub_f32 v29, v56, v28
  v_cmp_gt_u32 vcc, 32, v0
  v_cvt_pk_bf16_f32 v60, v22, v22
  v_cvt_pk_bf16_f32 v61, v23, v24
  v_cvt_pk_bf16_f32 v62, v24, v25
  v_mov_b32 v63, 0
  v_cndmask_b32 v60, 0, v60, vcc
  v_cndmask_b32 v61, 0, v61, vcc
  v_cndmask_b32 v62, 0, v62, vcc
  v_cvt_pk_bf16_f32 v64, v26, v27
  v_cvt_pk_bf16_f32 v65, v26, v28
  v_cvt_pk_bf16_f32 v66, v29, v28
  v_mov_b32 v67, 0
  s_lshl_b32 s26, s25, 10
  s_add_u32 s26, s26, 147456
  v_add_u32 v14, s26, v1
  ds_write_b128 v14, v[60:63]
  ds_write_b128 v14, v[64:67] offset:4096
  s_waitcnt lgkmcnt(0)
  s_waitcnt vmcnt(12)
  s_barrier
  s_waitcnt vmcnt(0)
  s_barrier
  s_barrier
.Lattn_kernel_skip_53:
  s_and_b32 s20, s2, 7
  s_lshr_b32 s21, s2, 3
  s_and_b32 s22, s20, 3
  s_lshr_b32 s23, s20, 2
  s_and_b32 s20, s21, 3
  s_lshr_b32 s21, s21, 2
  s_mul_i32 s22, s22, 4
  s_add_u32 s22, s22, s20
  s_mul_i32 s23, s23, 8
  s_add_u32 s23, s23, s21
  s_sub_u32 s25, s24, 4
  s_lshl_b32 s26, s25, 12
  v_add_u32 v2, s26, v1
  s_mul_i32 s28, s22, 917504
  s_mov_b32 s29, 0
  v_lshrrev_b32 v4, 3, v0
  v_and_b32 v3, 7, v0
  v_bfe_u32 v5, v0, 4, 2
  v_lshlrev_b32 v5, 1, v5
  v_xor_b32 v3, v3, v5
  s_lshl_b32 s26, s25, 4
  v_add_u32 v4, s26, v4
  v_mul_u32_u24 v4, 2048, v4
  v_lshl_add_u32 v4, v3, 4, v4
  s_mul_i32 s26, s23, 128
  v_add_u32 v4, s26, v4
  v_add_u32 v104, 0, v4
  v_add_u32 v105, 15360, v4
  s_mov_b32 s54, 524288
  s_mov_b32 s53, 7208960
  s_and_b32 s26, s23, 7
  s_cmp_lg_u32 s26, 3
  s_cbranch_scc1 .Lattn_kernel_untiled_61
  s_mov_b32 s54, 32768
  s_mov_b32 s53, 450560
  s_mul_i32 s29, s23, 458752
  s_lshl_b32 s26, s25, 11
  v_add_u32 v4, s26, v1
  v_add_u32 v104, 0, v4
  v_add_u32 v105, 0, v4
.Lattn_kernel_untiled_61:
  s_lshl_b32 s31, s25, 12
  s_lshl_b32 s32, s25, 11
  s_add_u32 s32, s32, 16384
  s_mov_b32 s30, 0
  s_mov_b32 s34, 0
  s_mov_b32 s35, 0
  v_lshlrev_b32 v12, 2, v0
  s_add_u32 s8, s6, 0x1d00000
  s_addc_u32 s9, s7, 0
  s_mov_b32 s10, 0xe00000
  s_mov_b32 s11, 0x20000
  s_mov_b32 s12, s62
  s_mov_b32 s13, s63
  s_mov_b32 s14, 0x700000
  s_mov_b32 s15, 0x20000
  s_add_u32 s26, s6, 0x3000000
  s_addc_u32 s27, s7, 0
  s_cmp_eq_u32 s54, 32768
  s_cselect_b32 s12, s26, s12
  s_cselect_b32 s13, s27, s13
  s_add_u32 s16, s6, 0x0
  s_addc_u32 s17, s7, 0
  s_mov_b32 s18, 0x100000
  s_mov_b32 s19, 0x20000
  s_mul_i32 s26, s54, 0
  s_add_u32 s26, s26, s29
  s_add_u32 s33, 0, s32
  s_add_u32 m0, s33, 0
  s_nop 0
  buffer_load_dwordx4 v104, s[12:15], s26 offen offset:0 lds
  buffer_load_dwordx4 v105, s[12:15], s26 offen offset:1024 lds
  s_mul_i32 s26, s54, 1
  s_add_u32 s26, s26, s29
  s_add_u32 s33, 24576, s32
  s_add_u32 m0, s33, 0
  s_nop 0
  buffer_load_dwordx4 v104, s[12:15], s26 offen offset:0 lds
  buffer_load_dwordx4 v105, s[12:15], s26 offen offset:1024 lds
  s_mul_i32 s26, s54, 2
  s_add_u32 s26, s26, s29
  s_add_u32 s33, 49152, s32
  s_add_u32 m0, s33, 0
  s_nop 0
  buffer_load_dwordx4 v104, s[12:15], s26 offen offset:0 lds
  buffer_load_dwordx4 v105, s[12:15], s26 offen offset:1024 lds
  s_cmp_lg_u32 s25, 0
  s_cbranch_scc1 .Lattn_kernel_nopoll_62
  s_lshl_b32 s38, s22, 8
  s_add_u32 s38, s38, 659456
  s_mov_b32 s39, 0
.Lattn_kernel_spin_63:
  v_mov_b32 v30, 0
  v_mov_b32 v31, 0
  s_mov_b64 exec, 1
  buffer_atomic_add v30, v31, s[16:19], s38 offen sc0 sc1
  s_mov_b64 exec, -1
  s_waitcnt vmcnt(0)
.Lattn_kernel_chk_64:
  v_cmp_gt_u32 vcc, 14, v30
  s_add_u32 s39, s39, 1
  s_and_b32 s61, vcc_lo, 1
  s_cbranch_scc0 .Lattn_kernel_go_65
  s_sleep 1
  s_cmp_lt_u32 s39, 131072
  s_cbranch_scc1 .Lattn_kernel_spin_63
.Lattn_kernel_go_65:
.Lattn_kernel_nopoll_62:
  s_barrier
  s_add_u32 m0, s30, s31
  s_nop 0
  buffer_load_dwordx4 v2, s[8:11], s28 offen offset:0 sc1 lds
  buffer_load_dwordx4 v2, s[8:11], s28 offen offset:1024 sc1 lds
  buffer_load_dwordx4 v2, s[8:11], s28 offen offset:2048 sc1 lds
  buffer_load_dwordx4 v2, s[8:11], s28 offen offset:3072 sc1 lds
  s_add_u32 s28, s28, 65536
  s_add_u32 s29, s29, s54
  s_add_u32 s35, s35, 1
  s_cmp_eq_u32 s35, 14
  s_cselect_b32 s26, s53, 0
  s_cselect_b32 s27, 901120, 0
  s_cselect_b32 s35, 0, s35
  s_sub_u32 s29, s29, s26
  s_sub_u32 s28, s28, s27
  s_add_u32 s30, s30, 24576
  s_cmp_eq_u32 s30, 122880
  s_cselect_b32 s30, 0, s30
  s_add_u32 s34, s34, 1
  s_add_u32 m0, s30, s31
  s_nop 0
  buffer_load_dwordx4 v2, s[8:11], s28 offen offset:0 sc1 lds
  buffer_load_dwordx4 v2, s[8:11], s28 offen offset:1024 sc1 lds
  buffer_load_dwordx4 v2, s[8:11], s28 offen offset:2048 sc1 lds
  buffer_load_dwordx4 v2, s[8:11], s28 offen offset:3072 sc1 lds
  s_add_u32 s28, s28, 65536
  s_add_u32 s29, s29, s54
  s_add_u32 s35, s35, 1
  s_cmp_eq_u32 s35, 14
  s_cselect_b32 s26, s53, 0
  s_cselect_b32 s27, 901120, 0
  s_cselect_b32 s35, 0, s35
  s_sub_u32 s29, s29, s26
  s_sub_u32 s28, s28, s27
  s_add_u32 s30, s30, 24576
  s_cmp_eq_u32 s30, 122880
  s_cselect_b32 s30, 0, s30
  s_add_u32 s34, s34, 1
  s_add_u32 m0, s30, s31
  s_nop 0
  buffer_load_dwordx4 v2, s[8:11], s28 offen offset:0 sc1 lds
  buffer_load_dwordx4 v2, s[8:11], s28 offen offset:1024 sc1 lds
  buffer_load_dwordx4 v2, s[8:11], s28 offen offset:2048 sc1 lds
  buffer_load_dwordx4 v2, s[8:11], s28 offen offset:3072 sc1 lds
  s_add_u32 s28, s28, 65536
  s_add_u32 s29, s29, s54
  s_add_u32 s35, s35, 1
  s_cmp_eq_u32 s35, 14
  s_cselect_b32 s26, s53, 0
  s_cselect_b32 s27, 901120, 0
  s_cselect_b32 s35, 0, s35
  s_sub_u32 s29, s29, s26
  s_sub_u32 s28, s28, s27
  s_add_u32 s30, s30, 24576
  s_cmp_eq_u32 s30, 122880
  s_cselect_b32 s30, 0, s30
  s_add_u32 s34, s34, 1
  s_waitcnt vmcnt(8)
  s_barrier
  s_add_u32 m0, s30, s31
  s_nop 0
  buffer_load_dwordx4 v2, s[8:11], s28 offen offset:0 sc1 lds
  buffer_load_dwordx4 v2, s[8:11], s28 offen offset:1024 sc1 lds
  buffer_load_dwordx4 v2, s[8:11], s28 offen offset:2048 sc1 lds
  buffer_load_dwordx4 v2, s[8:11], s28 offen offset:3072 sc1 lds
  s_add_u32 s33, s30, s32
  s_add_u32 m0, s33, 0
  s_nop 0
  buffer_load_dwordx4 v104, s[12:15], s29 offen offset:0 lds
  buffer_load_dwordx4 v105, s[12:15], s29 offen offset:1024 lds
  s_add_u32 s28, s28, 65536
  s_add_u32 s29, s29, s54
  s_add_u32 s35, s35, 1
  s_cmp_eq_u32 s35, 14
  s_cselect_b32 s26, s53, 0
  s_cselect_b32 s27, 901120, 0
  s_cselect_b32 s35, 0, s35
  s_sub_u32 s29, s29, s26
  s_sub_u32 s28, s28, s27
  s_add_u32 s30, s30, 24576
  s_cmp_eq_u32 s30, 122880
  s_cselect_b32 s30, 0, s30
  s_add_u32 s34, s34, 1
  s_waitcnt vmcnt(10)
  s_barrier
  s_add_u32 m0, s30, s31
  s_nop 0
  buffer_load_dwordx4 v2, s[8:11], s28 offen offset:0 sc1 lds
  buffer_load_dwordx4 v2, s[8:11], s28 offen offset:1024 sc1 lds
  buffer_load_dwordx4 v2, s[8:11], s28 offen offset:2048 sc1 lds
  buffer_load_dwordx4 v2, s[8:11], s28 offen offset:3072 sc1 lds
  s_add_u32 s33, s30, s32
  s_add_u32 m0, s33, 0
  s_nop 0
  buffer_load_dwordx4 v104, s[12:15], s29 offen offset:0 lds
  buffer_load_dwordx4 v105, s[12:15], s29 offen offset:1024 lds
  s_add_u32 s28, s28, 65536
  s_add_u32 s29, s29, s54
  s_add_u32 s35, s35, 1
  s_cmp_eq_u32 s35, 14
  s_cselect_b32 s26, s53, 0
  s_cselect_b32 s27, 901120, 0
  s_cselect_b32 s35, 0, s35
  s_sub_u32 s29, s29, s26
  s_sub_u32 s28, s28, s27
  s_add_u32 s30, s30, 24576
  s_cmp_eq_u32 s30, 122880
  s_cselect_b32 s30, 0, s30
  s_add_u32 s34, s34, 1
.Lattn_kernel_lmain_66:
  s_waitcnt vmcnt(12)
  s_barrier
  s_add_u32 m0, s30, s31
  s_nop 0
  buffer_load_dwordx4 v2, s[8:11], s28 offen offset:0 sc1 lds
  buffer_load_dwordx4 v2, s[8:11], s28 offen offset:1024 sc1 lds
  buffer_load_dwordx4 v2, s[8:11], s28 offen offset:2048 sc1 lds
  buffer_load_dwordx4 v2, s[8:11], s28 offen offset:3072 sc1 lds
  s_add_u32 s33, s30, s32
  s_add_u32 m0, s33, 0
  s_nop 0
  buffer_load_dwordx4 v104, s[12:15], s29 offen offset:0 lds
  buffer_load_dwordx4 v105, s[12:15], s29 offen offset:1024 lds
  s_add_u32 s28, s28, 65536
  s_add_u32 s29, s29, s54
  s_add_u32 s35, s35, 1
  s_cmp_eq_u32 s35, 14
  s_cselect_b32 s26, s53, 0
  s_cselect_b32 s27, 901120, 0
  s_cselect_b32 s35, 0, s35
  s_sub_u32 s29, s29, s26
  s_sub_u32 s28, s28, s27
  s_add_u32 s30, s30, 24576
  s_cmp_eq_u32 s30, 122880
  s_cselect_b32 s30, 0, s30
  s_add_u32 s34, s34, 1
  s_cmp_lt_u32 s34, 11
  s_cbranch_scc1 .Lattn_kernel_lmain_66
  s_cmp_lg_u32 s25, 0
  s_cbranch_scc1 .Lattn_kernel_nopoll_67
  s_lshl_b32 s38, s22, 8
  s_add_u32 s38, s38, 663552
  v_mov_b32 v30, 0
  v_mov_b32 v31, 0
  s_mov_b64 exec, 1
  buffer_atomic_add v30, v31, s[16:19], s38 offen sc0 sc1
  s_mov_b64 exec, -1
.Lattn_kernel_nopoll_67:
.Lattn_kernel_lmain_69:
  s_waitcnt vmcnt(12)
  s_barrier
  s_add_u32 m0, s30, s31
  s_nop 0
  buffer_load_dwordx4 v2, s[8:11], s28 offen offset:0 sc1 lds
  buffer_load_dwordx4 v2, s[8:11], s28 offen offset:1024 sc1 lds
  buffer_load_dwordx4 v2, s[8:11], s28 offen offset:2048 sc1 lds
  buffer_load_dwordx4 v2, s[8:11], s28 offen offset:3072 sc1 lds
  s_add_u32 s33, s30, s32
  s_add_u32 m0, s33, 0
  s_nop 0
  buffer_load_dwordx4 v104, s[12:15], s29 offen offset:0 lds
  buffer_load_dwordx4 v105, s[12:15], s29 offen offset:1024 lds
  s_add_u32 s28, s28, 65536
  s_add_u32 s29, s29, s54
  s_add_u32 s35, s35, 1
  s_cmp_eq_u32 s35, 14
  s_cselect_b32 s26, s53, 0
  s_cselect_b32 s27, 901120, 0
  s_cselect_b32 s35, 0, s35
  s_sub_u32 s29, s29, s26
  s_sub_u32 s28, s28, s27
  s_add_u32 s30, s30, 24576
  s_cmp_eq_u32 s30, 122880
  s_cselect_b32 s30, 0, s30
  s_add_u32 s34, s34, 1
  s_cmp_lt_u32 s34, 14
  s_cbranch_scc1 .Lattn_kernel_lmain_69
  s_cmp_lg_u32 s25, 0
  s_cbranch_scc1 .Lattn_kernel_nopoll_68
  s_mov_b32 s39, 0
  s_branch .Lattn_kernel_chk_71
.Lattn_kernel_spin_70:
  v_mov_b32 v30, 0
  v_mov_b32 v31, 0
  s_mov_b64 exec, 1
  buffer_atomic_add v30, v31, s[16:19], s38 offen sc0 sc1
  s_mov_b64 exec, -1
  s_waitcnt vmcnt(0)
.Lattn_kernel_chk_71:
  v_cmp_gt_u32 vcc, 14, v30
  s_add_u32 s39, s39, 1
  s_and_b32 s61, vcc_lo, 1
  s_cbranch_scc0 .Lattn_kernel_go_72
  s_sleep 6
  s_cmp_lt_u32 s39, 131072
  s_cbranch_scc1 .Lattn_kernel_spin_70
.Lattn_kernel_go_72:
.Lattn_kernel_nopoll_68:
.Lattn_kernel_lmain_73:
  s_waitcnt vmcnt(12)
  s_barrier
  s_add_u32 m0, s30, s31
  s_nop 0
  buffer_load_dwordx4 v2, s[8:11], s28 offen offset:0 sc1 lds
  buffer_load_dwordx4 v2, s[8:11], s28 offen offset:1024 sc1 lds
  buffer_load_dwordx4 v2, s[8:11], s28 offen offset:2048 sc1 lds
  buffer_load_dwordx4 v2, s[8:11], s28 offen offset:3072 sc1 lds
  s_add_u32 s33, s30, s32
  s_add_u32 m0, s33, 0
  s_nop 0
  buffer_load_dwordx4 v104, s[12:15], s29 offen offset:0 lds
  buffer_load_dwordx4 v105, s[12:15], s29 offen offset:1024 lds
  s_add_u32 s28, s28, 65536
  s_add_u32 s29, s29, s54
  s_add_u32 s35, s35, 1
  s_cmp_eq_u32 s35, 14
  s_cselect_b32 s26, s53, 0
  s_cselect_b32 s27, 901120, 0
  s_cselect_b32 s35, 0, s35
  s_sub_u32 s29, s29, s26
  s_sub_u32 s28, s28, s27
  s_add_u32 s30, s30, 24576
  s_cmp_eq_u32 s30, 122880
  s_cselect_b32 s30, 0, s30
  s_add_u32 s34, s34, 1
  s_cmp_lt_u32 s34, 51
  s_cbranch_scc1 .Lattn_kernel_lmain_73
  s_lshl_b32 s26, s23, 8
  s_add_u32 s27, s26, 20480
  buffer_load_dword v32, v12, s[16:19], s27 offen sc1
  s_add_u32 s27, s26, 45056
  buffer_load_dword v33, v12, s[16:19], s27 offen sc1
  s_add_u32 s27, s26, 69632
  buffer_load_dword v34, v12, s[16:19], s27 offen sc1
  s_add_u32 s27, s26, 94208
  buffer_load_dword v35, v12, s[16:19], s27 offen sc1
  s_lshl_b32 s26, s22, 7
  s_lshl_b32 s27, s25, 5
  s_add_u32 s26, s26, s27
  v_add_u32 v13, s26, v9
  v_lshlrev_b32 v14, 3, v13
  v_lshl_add_u32 v14, v7, 17, v14
  s_mov_b32 s27, 262144
  buffer_load_dwordx2 v[36:37], v14, s[16:19], s27 offen sc1
  s_mov_b32 s27, 278528
  buffer_load_dwordx2 v[38:39], v14, s[16:19], s27 offen sc1
  s_mov_b32 s27, 294912
  buffer_load_dwordx2 v[40:41], v14, s[16:19], s27 offen sc1
  s_mov_b32 s27, 311296
  buffer_load_dwordx2 v[42:43], v14, s[16:19], s27 offen sc1
  s_mov_b32 s27, 327680
  buffer_load_dwordx2 v[44:45], v14, s[16:19], s27 offen sc1
  s_mov_b32 s27, 344064
  buffer_load_dwordx2 v[46:47], v14, s[16:19], s27 offen sc1
  s_mov_b32 s27, 360448
  buffer_load_dwordx2 v[48:49], v14, s[16:19], s27 offen sc1
  s_mov_b32 s27, 376832
  buffer_load_dwordx2 v[50:51], v14, s[16:19], s27 offen sc1
.Lattn_kernel_lmain_74:
  s_waitcnt vmcnt(12)
  s_barrier
  s_add_u32 m0, s30, s31
  s_nop 0
  buffer_load_dwordx4 v2, s[8:11], s28 offen offset:0 sc1 lds
  buffer_load_dwordx4 v2, s[8:11], s28 offen offset:1024 sc1 lds
  buffer_load_dwordx4 v2, s[8:11], s28 offen offset:2048 sc1 lds
  buffer_load_dwordx4 v2, s[8:11], s28 offen offset:3072 sc1 lds
  s_add_u32 s33, s30, s32
  s_add_u32 m0, s33, 0
  s_nop 0
  buffer_load_dwordx4 v104, s[12:15], s29 offen offset:0 lds
  buffer_load_dwordx4 v105, s[12:15], s29 offen offset:1024 lds
  s_add_u32 s28, s28, 65536
  s_add_u32 s29, s29, s54
  s_add_u32 s35, s35, 1
  s_cmp_eq_u32 s35, 14
  s_cselect_b32 s26, s53, 0
  s_cselect_b32 s27, 901120, 0
  s_cselect_b32 s35, 0, s35
  s_sub_u32 s29, s29, s26
  s_sub_u32 s28, s28, s27
  s_add_u32 s30, s30, 24576
  s_cmp_eq_u32 s30, 122880
  s_cselect_b32 s30, 0, s30
  s_add_u32 s34, s34, 1
  s_cmp_lt_u32 s34, 56
  s_cbranch_scc1 .Lattn_kernel_lmain_74
  v_add_u32 v15, 122880, v12
  v_add_f32 v32, v32, v33
  v_add_f32 v34, v34, v35
  v_add_f32 v32, v32, v34
  v_cvt_pk_bf16_f32 v32, v32, v32
  v_and_b32 v32, 0xffff0000, v32
  ds_write_b32 v15, v32
  v_add_f32 v16, v36, v38
  v_add_f32 v18, v37, v39
  v_add_f32 v16, v16, v40
  v_add_f32 v18, v18, v41
  v_add_f32 v16, v16, v42
  v_add_f32 v18, v18, v43
  v_add_f32 v16, v16, v44
  v_add_f32 v18, v18, v45
  v_add_f32 v16, v16, v46
  v_add_f32 v18, v18, v47
  v_add_f32 v16, v16, v48
  v_add_f32 v18, v18, v49
  v_add_f32 v16, v16, v50
  v_add_f32 v18, v18, v51
  v_mov_b32 v17, v16
  s_nop 1
  v_permlane32_swap_b32 v16, v17
  s_nop 1
  v_add_f32 v16, v16, v17
  v_mul_f32 v16, 0xba800000, v16
  s_mov_b32 s27, 0x3c800000
  v_mov_b32 v19, 0
  v_fma_f32 v17, v36, s27, v16
  v_fmac_f32 v19, v17, v17
  v_fma_f32 v17, v38, s27, v16
  v_fmac_f32 v19, v17, v17
  v_fma_f32 v17, v40, s27, v16
  v_fmac_f32 v19, v17, v17
  v_fma_f32 v17, v42, s27, v16
  v_fmac_f32 v19, v17, v17
  v_fma_f32 v17, v44, s27, v16
  v_fmac_f32 v19, v17, v17
  v_fma_f32 v17, v46, s27, v16
  v_fmac_f32 v19, v17, v17
  v_fma_f32 v17, v48, s27, v16
  v_fmac_f32 v19, v17, v17
  v_fma_f32 v17, v50, s27, v16
  v_fmac_f32 v19, v17, v17
  v_fmac_f32 v18, 0x42800000, v19
  v_mov_b32 v17, v18
  s_nop 1
  v_permlane32_swap_b32 v18, v17
  s_nop 1
  v_add_f32 v18, v18, v17
  v_mov_b32 v20, 0x3727c5ac
  v_fmac_f32 v20, 0x3a800000, v18
  v_sqrt_f32 v21, v20
  s_lshl_b32 s27, s25, 7
  s_add_u32 s27, s27, 123392
  v_rcp_f32 v20, v21
  v_lshl_add_u32 v15, v9, 2, s27
  ds_write_b32 v15, v20
  s_waitcnt lgkmcnt(0)
  s_waitcnt vmcnt(12)
  s_barrier
  s_waitcnt vmcnt(6)
  s_barrier
  s_waitcnt vmcnt(0)
  s_barrier
  s_endpgm
.Lattn_kernel_tc_2:
  s_and_b32 s20, s2, 7
  s_lshr_b32 s21, s2, 3
  s_and_b32 s22, s20, 3
  s_lshr_b32 s23, s20, 2
  s_and_b32 s20, s21, 3
  s_lshr_b32 s21, s21, 2
  s_mul_i32 s22, s22, 4
  s_add_u32 s22, s22, s20
  s_mul_i32 s23, s23, 8
  s_add_u32 s23, s23, s21
  s_mov_b32 s25, s24
  s_lshl_b32 s27, s25, 10
  v_add_u32 v2, s27, v1
  v_bfe_u32 v6, v0, 2, 2
  v_lshlrev_b32 v4, 7, v6
  v_lshl_add_u32 v4, v7, 9, v4
  v_bfe_u32 v8, v0, 4, 1
  v_lshl_add_u32 v4, v8, 5, v4
  v_and_b32 v8, 3, v0
  v_lshl_add_u32 v4, v8, 3, v4
  v_add_u32 v4, 16384, v4
  v_lshrrev_b32 v8, 1, v6
  v_xor_b32 v6, 1, v8
  v_lshl_add_u32 v10, v6, 6, v4
  v_lshl_add_u32 v4, v8, 6, v4
  s_lshl_b32 s28, s22, 7
  s_lshl_b32 s29, s25, 5
  s_add_u32 s28, s28, s29
  v_mov_b32 v32, 0
  v_mov_b32 v33, 0
  v_mov_b32 v34, 0
  v_mov_b32 v35, 0
  v_mov_b32 v36, 0
  v_mov_b32 v37, 0
  v_mov_b32 v38, 0
  v_mov_b32 v39, 0
  v_mov_b32 v40, 0
  v_mov_b32 v41, 0
  v_mov_b32 v42, 0
  v_mov_b32 v43, 0
  v_mov_b32 v44, 0
  v_mov_b32 v45, 0
  v_mov_b32 v46, 0
  v_mov_b32 v47, 0
  v_mov_b32 v48, 0
  v_mov_b32 v49, 0
  v_mov_b32 v50, 0
  v_mov_b32 v51, 0
  v_mov_b32 v52, 0
  v_mov_b32 v53, 0
  v_mov_b32 v54, 0
  v_mov_b32 v55, 0
  v_mov_b32 v56, 0
  v_mov_b32 v57, 0
  v_mov_b32 v58, 0
  v_mov_b32 v59, 0
  v_mov_b32 v60, 0
  v_mov_b32 v61, 0
  v_mov_b32 v62, 0
  v_mov_b32 v63, 0
  s_waitcnt lgkmcnt(0)
  s_add_u32 s16, s6, 0x0
  s_addc_u32 s17, s7, 0
  s_mov_b32 s18, 0x100000
  s_mov_b32 s19, 0x20000
  v_add_u32 v14, s28, v9
  v_mov_b32 v13, 122880
  v_lshl_add_u32 v13, v7, 4, v13
  s_lshl_b32 s30, s25, 12
  s_add_u32 s30, s30, 123904
  v_lshl_add_u32 v12, v9, 7, s30
  v_lshl_add_u32 v12, v7, 3, v12
  v_and_b32 v8, 7, v0
  v_xor_b32 v16, 0, v8
  v_lshl_add_u32 v16, v16, 4, v12
  v_xor_b32 v17, 1, v8
  v_lshl_add_u32 v17, v17, 4, v12
  v_xor_b32 v18, 2, v8
  v_lshl_add_u32 v18, v18, 4, v12
  v_xor_b32 v19, 3, v8
  v_lshl_add_u32 v19, v19, 4, v12
  v_xor_b32 v20, 4, v8
  v_lshl_add_u32 v20, v20, 4, v12
  v_xor_b32 v21, 5, v8
  v_lshl_add_u32 v21, v21, 4, v12
  v_xor_b32 v22, 6, v8
  v_lshl_add_u32 v22, v22, 4, v12
  v_xor_b32 v23, 7, v8
  v_lshl_add_u32 v23, v23, 4, v12
  s_mov_b32 s34, 0
  s_mov_b32 s35, 0
  v_mov_b32 v3, v2
  v_mov_b32 v5, v4
  v_mov_b32 v11, v10
  s_setprio 1
  v_mov_b32 v24, 163776
  v_mov_b32 v26, 0
  v_mov_b32 v27, 0
  ds_write_b64 v24, v[26:27]
  ds_write_b64 v24, v[26:27] offset:8
  ds_write_b64 v24, v[26:27] offset:16
  s_waitcnt lgkmcnt(0)
  s_waitcnt vmcnt(0)
  s_barrier
  s_cmp_lg_u32 s24, 0
  s_cbranch_scc1 .Lattn_kernel_nopoll_75
  v_mov_b32 v28, 0
  v_mov_b32 v29, 1
  s_mov_b64 exec, 1
  buffer_atomic_add v29, v28, s[16:19], s60 offen sc0 sc1
  s_mov_b64 exec, -1
  s_lshl_b32 s38, s22, 8
  s_add_u32 s38, s38, 679936
  v_mov_b32 v30, 0
  v_mov_b32 v31, 0
  s_mov_b64 exec, 1
  buffer_atomic_add v30, v31, s[16:19], s38 offen sc0 sc1
  s_mov_b64 exec, -1
  v_lshlrev_b32 v28, 8, v0
  s_waitcnt vmcnt(0)
  v_readfirstlane_b32 s30, v29
  v_mov_b32 v29, 1
  s_mov_b32 s29, 684032
  s_nop 1
  s_cmp_lg_u32 s30, 15
  s_cbranch_scc1 .Lattn_kernel_notlast_76
  s_mov_b64 exec, 0xffff
  buffer_atomic_add v29, v28, s[16:19], s29 offen sc1
  s_mov_b64 exec, -1
.Lattn_kernel_notlast_76:
  s_mov_b32 s39, 0
  s_branch .Lattn_kernel_chk_78
.Lattn_kernel_spin_77:
  v_mov_b32 v30, 0
  v_mov_b32 v31, 0
  s_mov_b64 exec, 1
  buffer_atomic_add v30, v31, s[16:19], s38 offen sc0 sc1
  s_mov_b64 exec, -1
  s_waitcnt vmcnt(0)
.Lattn_kernel_chk_78:
  v_cmp_gt_u32 vcc, 16, v30
  s_add_u32 s39, s39, 1
  s_and_b32 s61, vcc_lo, 1
  s_cbranch_scc0 .Lattn_kernel_go_79
  s_sleep 1
  s_cmp_lt_u32 s39, 131072
  s_cbranch_scc1 .Lattn_kernel_spin_77
.Lattn_kernel_go_79:
.Lattn_kernel_nopoll_75:
  s_barrier
  s_barrier
  ds_read_b128 v[64:67], v3 offset:0
  ds_read_b64_tr_b16 v[68:69], v5 offset:0
  ds_read_b64_tr_b16 v[70:71], v5 offset:1024
  ds_read_b64_tr_b16 v[72:73], v11 offset:0
  ds_read_b64_tr_b16 v[74:75], v11 offset:1024
  ds_read_b128 v[76:79], v3 offset:4096
  ds_read_b64_tr_b16 v[80:81], v5 offset:2048
  ds_read_b64_tr_b16 v[82:83], v5 offset:3072
  ds_read_b64_tr_b16 v[84:85], v11 offset:2048
  ds_read_b64_tr_b16 v[86:87], v11 offset:3072
.Lattn_kernel_loop_80:
  s_cmp_ge_u32 s35, 14
  s_cbranch_scc1 .Lattn_kernel_mid_82
.Lattn_kernel_midret_83:
  s_waitcnt lgkmcnt(5)
  v_mfma_f32_32x32x16_bf16 v[32:47], v[68:71], v[64:67], v[32:47]
  ds_read_b128 v[88:91], v3 offset:8192
  ds_read_b64_tr_b16 v[92:93], v5 offset:4096
  ds_read_b64_tr_b16 v[94:95], v5 offset:5120
  v_mfma_f32_32x32x16_bf16 v[48:63], v[72:75], v[64:67], v[48:63]
  ds_read_b64_tr_b16 v[96:97], v11 offset:4096
  ds_read_b64_tr_b16 v[98:99], v11 offset:5120
  s_add_u32 s34, s34, 24576
  s_cmp_eq_u32 s34, 122880
  s_cselect_b32 s34, 0, s34
  s_waitcnt lgkmcnt(5)
  v_mfma_f32_32x32x16_bf16 v[32:47], v[80:83], v[76:79], v[32:47]
  ds_read_b128 v[100:103], v3 offset:12288
  ds_read_b64_tr_b16 v[104:105], v5 offset:6144
  ds_read_b64_tr_b16 v[106:107], v5 offset:7168
  v_mfma_f32_32x32x16_bf16 v[48:63], v[84:87], v[76:79], v[48:63]
  ds_read_b64_tr_b16 v[108:109], v11 offset:6144
  ds_read_b64_tr_b16 v[110:111], v11 offset:7168
  s_add_u32 s35, s35, 1
  v_add_u32 v3, s34, v2
  v_add_u32 v5, s34, v4
  v_add_u32 v11, s34, v10
  s_cmp_eq_u32 s35, 16
  s_cbranch_scc1 .Lattn_kernel_last_81
  s_waitcnt lgkmcnt(5)
  v_mfma_f32_32x32x16_bf16 v[32:47], v[92:95], v[88:91], v[32:47]
  s_barrier
  ds_read_b128 v[64:67], v3 offset:0
  ds_read_b64_tr_b16 v[68:69], v5 offset:0
  ds_read_b64_tr_b16 v[70:71], v5 offset:1024
  v_mfma_f32_32x32x16_bf16 v[48:63], v[96:99], v[88:91], v[48:63]
  ds_read_b64_tr_b16 v[72:73], v11 offset:0
  ds_read_b64_tr_b16 v[74:75], v11 offset:1024
  s_waitcnt lgkmcnt(5)
  v_mfma_f32_32x32x16_bf16 v[32:47], v[104:107], v[100:103], v[32:47]
  ds_read_b128 v[76:79], v3 offset:4096
  ds_read_b64_tr_b16 v[80:81], v5 offset:2048
  ds_read_b64_tr_b16 v[82:83], v5 offset:3072
  v_mfma_f32_32x32x16_bf16 v[48:63], v[108:111], v[100:103], v[48:63]
  ds_read_b64_tr_b16 v[84:85], v11 offset:2048
  ds_read_b64_tr_b16 v[86:87], v11 offset:3072
  s_branch .Lattn_kernel_loop_80
.Lattn_kernel_mid_82:
  s_cmp_eq_u32 s35, 15
  s_cbranch_scc1 .Lattn_kernel_mp_85
.Lattn_kernel_mp_84:
  s_waitcnt lgkmcnt(0)
  ds_read_b64 v[240:241], v16
  ds_read_b64 v[242:243], v17
  ds_read_b64 v[244:245], v18
  ds_read_b64 v[246:247], v19
  ds_read_b64 v[248:249], v20
  ds_read_b64 v[250:251], v21
  ds_read_b64 v[252:253], v22
  ds_read_b64 v[254:255], v23
  s_branch .Lattn_kernel_midret_83
.Lattn_kernel_mp_85:
  s_waitcnt lgkmcnt(0)
  ds_read_b128 v[112:115], v13 offset:0
  ds_read_b128 v[116:119], v13 offset:32
  ds_read_b128 v[120:123], v13 offset:64
  ds_read_b128 v[124:127], v13 offset:96
  ds_read_b128 v[128:131], v13 offset:128
  ds_read_b128 v[132:135], v13 offset:160
  ds_read_b128 v[136:139], v13 offset:192
  ds_read_b128 v[140:143], v13 offset:224
  v_lshlrev_b32 v144, 16, v240
  v_and_b32 v145, 0xffff0000, v240
  v_lshlrev_b32 v146, 16, v241
  v_and_b32 v147, 0xffff0000, v241
  v_lshlrev_b32 v148, 16, v242
  v_and_b32 v149, 0xffff0000, v242
  v_lshlrev_b32 v150, 16, v243
  v_and_b32 v151, 0xffff0000, v243
  v_lshlrev_b32 v152, 16, v244
  v_and_b32 v153, 0xffff0000, v244
  v_lshlrev_b32 v154, 16, v245
  v_and_b32 v155, 0xffff0000, v245
  v_lshlrev_b32 v156, 16, v246
  v_and_b32 v157, 0xffff0000, v246
  v_lshlrev_b32 v158, 16, v247
  v_and_b32 v159, 0xffff0000, v247
  v_lshlrev_b32 v160, 16, v248
  v_and_b32 v161, 0xffff0000, v248
  v_lshlrev_b32 v162, 16, v249
  v_and_b32 v163, 0xffff0000, v249
  v_lshlrev_b32 v164, 16, v250
  v_and_b32 v165, 0xffff0000, v250
  v_lshlrev_b32 v166, 16, v251
  v_and_b32 v167, 0xffff0000, v251
  v_lshlrev_b32 v168, 16, v252
  v_and_b32 v169, 0xffff0000, v252
  v_lshlrev_b32 v170, 16, v253
  v_and_b32 v171, 0xffff0000, v253
  v_lshlrev_b32 v172, 16, v254
  v_and_b32 v173, 0xffff0000, v254
  v_lshlrev_b32 v174, 16, v255
  v_and_b32 v175, 0xffff0000, v255
  s_branch .Lattn_kernel_midret_83
.Lattn_kernel_last_81:
  s_waitcnt lgkmcnt(5)
  v_mfma_f32_32x32x16_bf16 v[32:47], v[92:95], v[88:91], v[32:47]
  v_mfma_f32_32x32x16_bf16 v[48:63], v[96:99], v[88:91], v[48:63]
  s_waitcnt lgkmcnt(0)
  v_mfma_f32_32x32x16_bf16 v[32:47], v[104:107], v[100:103], v[32:47]
  s_barrier
  v_mfma_f32_32x32x16_bf16 v[48:63], v[108:111], v[100:103], v[48:63]
  s_add_u32 s40, s6, 0x1900000
  s_addc_u32 s41, s7, 0
  s_mov_b32 s42, 0x400000
  s_mov_b32 s43, 0x20000
  s_lshl_b32 s44, s22, 18
  s_lshl_b32 s30, s23, 14
  s_add_u32 s44, s44, s30
  s_lshl_b32 s30, s25, 10
  s_add_u32 s44, s44, s30
  s_add_u32 s45, s44, 4096
  s_add_u32 s46, s44, 8192
  s_add_u32 s47, s44, 12288
  v_pk_fma_f32 v[144:145], v[32:33], v[112:113], v[144:145]
  v_pk_fma_f32 v[146:147], v[34:35], v[114:115], v[146:147]
  v_pk_fma_f32 v[148:149], v[36:37], v[116:117], v[148:149]
  v_pk_fma_f32 v[150:151], v[38:39], v[118:119], v[150:151]
  ds_read_b128 v[112:115], v13 offset:256
  ds_read_b128 v[116:119], v13 offset:288
  v_cvt_pk_bf16_f32 v240, v144, v145
  v_cvt_pk_bf16_f32 v241, v146, v147
  v_cvt_pk_bf16_f32 v242, v148, v149
  v_cvt_pk_bf16_f32 v243, v150, v151
  v_lshlrev_b32 v144, 16, v240
  v_and_b32 v145, 0xffff0000, v240
  v_lshlrev_b32 v146, 16, v241
  v_and_b32 v147, 0xffff0000, v241
  v_lshlrev_b32 v148, 16, v242
  v_and_b32 v149, 0xffff0000, v242
  v_lshlrev_b32 v150, 16, v243
  v_and_b32 v151, 0xffff0000, v243
  v_pk_fma_f32 v[152:153], v[40:41], v[120:121], v[152:153]
  v_pk_fma_f32 v[154:155], v[42:43], v[122:123], v[154:155]
  v_pk_fma_f32 v[156:157], v[44:45], v[124:125], v[156:157]
  v_pk_fma_f32 v[158:159], v[46:47], v[126:127], v[158:159]
  ds_read_b128 v[120:123], v13 offset:320
  ds_read_b128 v[124:127], v13 offset:352
  v_cvt_pk_bf16_f32 v244, v152, v153
  v_cvt_pk_bf16_f32 v245, v154, v155
  v_cvt_pk_bf16_f32 v246, v156, v157
  v_cvt_pk_bf16_f32 v247, v158, v159
  v_lshlrev_b32 v152, 16, v244
  v_and_b32 v153, 0xffff0000, v244
  v_lshlrev_b32 v154, 16, v245
  v_and_b32 v155, 0xffff0000, v245
  v_lshlrev_b32 v156, 16, v246
  v_and_b32 v157, 0xffff0000, v246
  v_lshlrev_b32 v158, 16, v247
  v_and_b32 v159, 0xffff0000, v247
  s_waitcnt lgkmcnt(2)
  v_pk_mul_f32 v[112:113], v[112:113], v[144:145]
  v_pk_mul_f32 v[114:115], v[114:115], v[146:147]
  v_pk_mul_f32 v[116:117], v[116:117], v[148:149]
  v_pk_mul_f32 v[118:119], v[118:119], v[150:151]
  v_cvt_pk_bf16_f32 v64, v112, v113
  v_cvt_pk_bf16_f32 v65, v114, v115
  v_cvt_pk_bf16_f32 v66, v116, v117
  v_cvt_pk_bf16_f32 v67, v118, v119
  buffer_store_dwordx4 v[64:67], v1, s[40:43], s44 offen sc0 sc1
  v_pk_fma_f32 v[160:161], v[48:49], v[128:129], v[160:161]
  v_pk_fma_f32 v[162:163], v[50:51], v[130:131], v[162:163]
  v_pk_fma_f32 v[164:165], v[52:53], v[132:133], v[164:165]
  v_pk_fma_f32 v[166:167], v[54:55], v[134:135], v[166:167]
  ds_read_b128 v[128:131], v13 offset:384
  ds_read_b128 v[132:135], v13 offset:416
  v_cvt_pk_bf16_f32 v248, v160, v161
  v_cvt_pk_bf16_f32 v249, v162, v163
  v_cvt_pk_bf16_f32 v250, v164, v165
  v_cvt_pk_bf16_f32 v251, v166, v167
  v_lshlrev_b32 v160, 16, v248
  v_and_b32 v161, 0xffff0000, v248
  v_lshlrev_b32 v162, 16, v249
  v_and_b32 v163, 0xffff0000, v249
  v_lshlrev_b32 v164, 16, v250
  v_and_b32 v165, 0xffff0000, v250
  v_lshlrev_b32 v166, 16, v251
  v_and_b32 v167, 0xffff0000, v251
  s_waitcnt lgkmcnt(2)
  v_pk_mul_f32 v[120:121], v[120:121], v[152:153]
  v_pk_mul_f32 v[122:123], v[122:123], v[154:155]
  v_pk_mul_f32 v[124:125], v[124:125], v[156:157]
  v_pk_mul_f32 v[126:127], v[126:127], v[158:159]
  v_cvt_pk_bf16_f32 v68, v120, v121
  v_cvt_pk_bf16_f32 v69, v122, v123
  v_cvt_pk_bf16_f32 v70, v124, v125
  v_cvt_pk_bf16_f32 v71, v126, v127
  buffer_store_dwordx4 v[68:71], v1, s[40:43], s45 offen sc0 sc1
  v_pk_fma_f32 v[168:169], v[56:57], v[136:137], v[168:169]
  v_pk_fma_f32 v[170:171], v[58:59], v[138:139], v[170:171]
  v_pk_fma_f32 v[172:173], v[60:61], v[140:141], v[172:173]
  v_pk_fma_f32 v[174:175], v[62:63], v[142:143], v[174:175]
  ds_read_b128 v[136:139], v13 offset:448
  ds_read_b128 v[140:143], v13 offset:480
  v_cvt_pk_bf16_f32 v252, v168, v169
  v_cvt_pk_bf16_f32 v253, v170, v171
  v_cvt_pk_bf16_f32 v254, v172, v173
  v_cvt_pk_bf16_f32 v255, v174, v175
  v_lshlrev_b32 v168, 16, v252
  v_and_b32 v169, 0xffff0000, v252
  v_lshlrev_b32 v170, 16, v253
  v_and_b32 v171, 0xffff0000, v253
  v_lshlrev_b32 v172, 16, v254
  v_and_b32 v173, 0xffff0000, v254
  v_lshlrev_b32 v174, 16, v255
  v_and_b32 v175, 0xffff0000, v255
  s_waitcnt lgkmcnt(2)
  v_pk_mul_f32 v[128:129], v[128:129], v[160:161]
  v_pk_mul_f32 v[130:131], v[130:131], v[162:163]
  v_pk_mul_f32 v[132:133], v[132:133], v[164:165]
  v_pk_mul_f32 v[134:135], v[134:135], v[166:167]
  v_cvt_pk_bf16_f32 v72, v128, v129
  v_cvt_pk_bf16_f32 v73, v130, v131
  v_cvt_pk_bf16_f32 v74, v132, v133
  v_cvt_pk_bf16_f32 v75, v134, v135
  buffer_store_dwordx4 v[72:75], v1, s[40:43], s46 offen sc0 sc1
  s_waitcnt lgkmcnt(0)
  v_pk_mul_f32 v[136:137], v[136:137], v[168:169]
  v_pk_mul_f32 v[138:139], v[138:139], v[170:171]
  v_pk_mul_f32 v[140:141], v[140:141], v[172:173]
  v_pk_mul_f32 v[142:143], v[142:143], v[174:175]
  v_cvt_pk_bf16_f32 v76, v136, v137
  v_cvt_pk_bf16_f32 v77, v138, v139
  v_cvt_pk_bf16_f32 v78, v140, v141
  v_cvt_pk_bf16_f32 v79, v142, v143
  buffer_store_dwordx4 v[76:79], v1, s[40:43], s47 offen sc0 sc1
  ds_write_b128 v2, v[64:67] offset:0
  ds_write_b128 v2, v[68:71] offset:4096
  ds_write_b128 v2, v[72:75] offset:8192
  ds_write_b128 v2, v[76:79] offset:12288
  v_pk_add_f32 v[16:17], v[144:145], v[146:147]
  v_pk_add_f32 v[18:19], v[148:149], v[150:151]
  v_pk_add_f32 v[16:17], v[16:17], v[152:153]
  v_pk_add_f32 v[18:19], v[18:19], v[154:155]
  v_pk_add_f32 v[16:17], v[16:17], v[156:157]
  v_pk_add_f32 v[18:19], v[18:19], v[158:159]
  v_pk_add_f32 v[16:17], v[16:17], v[160:161]
  v_pk_add_f32 v[18:19], v[18:19], v[162:163]
  v_pk_add_f32 v[16:17], v[16:17], v[164:165]
  v_pk_add_f32 v[18:19], v[18:19], v[166:167]
  v_pk_add_f32 v[16:17], v[16:17], v[168:169]
  v_pk_add_f32 v[18:19], v[18:19], v[170:171]
  v_pk_add_f32 v[16:17], v[16:17], v[172:173]
  v_pk_add_f32 v[18:19], v[18:19], v[174:175]
  v_pk_add_f32 v[16:17], v[16:17], v[18:19]
  v_add_f32 v20, v16, v17
  v_mov_b32 v16, v20
  s_nop 1
  v_permlane32_swap_b32 v20, v16
  s_nop 1
  v_add_f32 v20, v20, v16
  v_mul_f32 v22, 0xbc800000, v20
  v_mov_b32 v16, 0
  v_mov_b32 v17, 0
  v_mov_b32 v18, 0
  v_mov_b32 v19, 0
  v_pk_add_f32 v[144:145], v[144:145], v[22:23] op_sel_hi:[1,0]
  v_pk_add_f32 v[146:147], v[146:147], v[22:23] op_sel_hi:[1,0]
  v_pk_add_f32 v[148:149], v[148:149], v[22:23] op_sel_hi:[1,0]
  v_pk_add_f32 v[150:151], v[150:151], v[22:23] op_sel_hi:[1,0]
  v_pk_add_f32 v[152:153], v[152:153], v[22:23] op_sel_hi:[1,0]
  v_pk_add_f32 v[154:155], v[154:155], v[22:23] op_sel_hi:[1,0]
  v_pk_add_f32 v[156:157], v[156:157], v[22:23] op_sel_hi:[1,0]
  v_pk_add_f32 v[158:159], v[158:159], v[22:23] op_sel_hi:[1,0]
  v_pk_add_f32 v[160:161], v[160:161], v[22:23] op_sel_hi:[1,0]
  v_pk_add_f32 v[162:163], v[162:163], v[22:23] op_sel_hi:[1,0]
  v_pk_add_f32 v[164:165], v[164:165], v[22:23] op_sel_hi:[1,0]
  v_pk_add_f32 v[166:167], v[166:167], v[22:23] op_sel_hi:[1,0]
  v_pk_add_f32 v[168:169], v[168:169], v[22:23] op_sel_hi:[1,0]
  v_pk_add_f32 v[170:171], v[170:171], v[22:23] op_sel_hi:[1,0]
  v_pk_add_f32 v[172:173], v[172:173], v[22:23] op_sel_hi:[1,0]
  v_pk_add_f32 v[174:175], v[174:175], v[22:23] op_sel_hi:[1,0]
  v_pk_fma_f32 v[16:17], v[144:145], v[144:145], v[16:17]
  v_pk_fma_f32 v[18:19], v[146:147], v[146:147], v[18:19]
  v_pk_fma_f32 v[16:17], v[148:149], v[148:149], v[16:17]
  v_pk_fma_f32 v[18:19], v[150:151], v[150:151], v[18:19]
  v_pk_fma_f32 v[16:17], v[152:153], v[152:153], v[16:17]
  v_pk_fma_f32 v[18:19], v[154:155], v[154:155], v[18:19]
  v_pk_fma_f32 v[16:17], v[156:157], v[156:157], v[16:17]
  v_pk_fma_f32 v[18:19], v[158:159], v[158:159], v[18:19]
  v_pk_fma_f32 v[16:17], v[160:161], v[160:161], v[16:17]
  v_pk_fma_f32 v[18:19], v[162:163], v[162:163], v[18:19]
  v_pk_fma_f32 v[16:17], v[164:165], v[164:165], v[16:17]
  v_pk_fma_f32 v[18:19], v[166:167], v[166:167], v[18:19]
  v_pk_fma_f32 v[16:17], v[168:169], v[168:169], v[16:17]
  v_pk_fma_f32 v[18:19], v[170:171], v[170:171], v[18:19]
  v_pk_fma_f32 v[16:17], v[172:173], v[172:173], v[16:17]
  v_pk_fma_f32 v[18:19], v[174:175], v[174:175], v[18:19]
  v_pk_add_f32 v[16:17], v[16:17], v[18:19]
  v_add_f32 v21, v16, v17
  v_mov_b32 v16, v21
  s_nop 1
  v_permlane32_swap_b32 v21, v16
  s_nop 1
  v_add_f32 v21, v21, v16
  v_lshlrev_b32 v12, 3, v14
  s_lshl_b32 s35, s23, 14
  s_add_u32 s35, s35, 262144
  buffer_store_dwordx2 v[20:21], v12, s[16:19], s35 offen sc0 sc1
  s_cmp_ge_u32 s2, 224
  s_cbranch_scc1 .Lattn_kernel_nostb_86
  s_barrier
.Lattn_kernel_nostb_86:
  s_waitcnt vmcnt(0)
  v_mov_b32 v18, 163776
  v_mov_b32 v19, 1
  s_mov_b64 exec, 1
  ds_add_rtn_u32 v20, v18, v19
  s_mov_b64 exec, -1
  s_lshl_b32 s29, s22, 8
  s_add_u32 s29, s29, 655360
  s_waitcnt lgkmcnt(0)
  v_readfirstlane_b32 s30, v20
  s_nop 3
  s_cmp_lg_u32 s30, 3
  s_cbranch_scc1 .Lattn_kernel_nolast_87
  v_mov_b32 v18, 0
  v_mov_b32 v19, 1
  s_mov_b64 exec, 1
  buffer_atomic_add v19, v18, s[16:19], s29 offen sc1
  s_mov_b64 exec, -1
.Lattn_kernel_nolast_87:
  s_cmp_ge_u32 s2, 224
  s_cbranch_scc1 .Lattn_kernel_skip_88
  s_and_b32 s20, s2, 7
  s_lshr_b32 s21, s2, 3
  s_and_b32 s22, s20, 3
  s_lshr_b32 s23, s20, 2
  s_and_b32 s20, s21, 3
  s_lshr_b32 s21, s21, 2
  s_mul_i32 s22, s22, 4
  s_add_u32 s22, s22, s20
  s_mul_i32 s23, s23, 7
  s_add_u32 s23, s23, s21
  s_lshr_b32 s25, s24, 1
  s_and_b32 s26, s24, 1
  v_and_b32 v6, 15, v0
  v_bfe_u32 v8, v0, 4, 1
  v_lshlrev_b32 v12, 4, v6
  v_lshl_add_u32 v12, v8, 9, v12
  v_lshl_add_u32 v12, v7, 12, v12
  s_lshl_b32 s27, s25, 11
  v_add_u32 v2, s27, v12
  v_bfe_u32 v13, v0, 2, 2
  v_lshlrev_b32 v4, 7, v13
  v_lshl_add_u32 v4, v8, 9, v4
  v_lshl_add_u32 v4, v7, 11, v4
  v_and_b32 v13, 3, v0
  v_lshl_add_u32 v4, v13, 3, v4
  v_bfe_u32 v13, v0, 3, 2
  s_lshl_b32 s27, s26, 1
  v_xor_b32 v13, s27, v13
  v_lshl_add_u32 v4, v13, 5, v4
  v_add_u32 v4, 16384, v4
  v_xor_b32 v10, 32, v4
  v_mov_b32 v32, 0
  v_mov_b32 v33, 0
  v_mov_b32 v34, 0
  v_mov_b32 v35, 0
  v_mov_b32 v36, 0
  v_mov_b32 v37, 0
  v_mov_b32 v38, 0
  v_mov_b32 v39, 0
  v_mov_b32 v40, 0
  v_mov_b32 v41, 0
  v_mov_b32 v42, 0
  v_mov_b32 v43, 0
  v_mov_b32 v44, 0
  v_mov_b32 v45, 0
  v_mov_b32 v46, 0
  v_mov_b32 v47, 0
  v_mov_b32 v48, 0
  v_mov_b32 v49, 0
  v_mov_b32 v50, 0
  v_mov_b32 v51, 0
  v_mov_b32 v52, 0
  v_mov_b32 v53, 0
  v_mov_b32 v54, 0
  v_mov_b32 v55, 0
  v_mov_b32 v56, 0
  v_mov_b32 v57, 0
  v_mov_b32 v58, 0
  v_mov_b32 v59, 0
  v_mov_b32 v60, 0
  v_mov_b32 v61, 0
  v_mov_b32 v62, 0
  v_mov_b32 v63, 0
  v_mov_b32 v64, 0
  v_mov_b32 v65, 0
  v_mov_b32 v66, 0
  v_mov_b32 v67, 0
  v_mov_b32 v68, 0
  v_mov_b32 v69, 0
  v_mov_b32 v70, 0
  v_mov_b32 v71, 0
  v_mov_b32 v72, 0
  v_mov_b32 v73, 0
  v_mov_b32 v74, 0
  v_mov_b32 v75, 0
  v_mov_b32 v76, 0
  v_mov_b32 v77, 0
  v_mov_b32 v78, 0
  v_mov_b32 v79, 0
  v_mov_b32 v80, 0
  v_mov_b32 v81, 0
  v_mov_b32 v82, 0
  v_mov_b32 v83, 0
  v_mov_b32 v84, 0
  v_mov_b32 v85, 0
  v_mov_b32 v86, 0
  v_mov_b32 v87, 0
  v_mov_b32 v88, 0
  v_mov_b32 v89, 0
  v_mov_b32 v90, 0
  v_mov_b32 v91, 0
  v_mov_b32 v92, 0
  v_mov_b32 v93, 0
  v_mov_b32 v94, 0
  v_mov_b32 v95, 0
  v_mov_b32 v96, 0
  v_mov_b32 v97, 0
  v_mov_b32 v98, 0
  v_mov_b32 v99, 0
  v_mov_b32 v100, 0
  v_mov_b32 v101, 0
  v_mov_b32 v102, 0
  v_mov_b32 v103, 0
  v_mov_b32 v104, 0
  v_mov_b32 v105, 0
  v_mov_b32 v106, 0
  v_mov_b32 v107, 0
  v_mov_b32 v108, 0
  v_mov_b32 v109, 0
  v_mov_b32 v110, 0
  v_mov_b32 v111, 0
  v_mov_b32 v112, 0
  v_mov_b32 v113, 0
  v_mov_b32 v114, 0
  v_mov_b32 v115, 0
  v_mov_b32 v116, 0
  v_mov_b32 v117, 0
  v_mov_b32 v118, 0
  v_mov_b32 v119, 0
  v_mov_b32 v120, 0
  v_mov_b32 v121, 0
  v_mov_b32 v122, 0
  v_mov_b32 v123, 0
  v_mov_b32 v124, 0
  v_mov_b32 v125, 0
  v_mov_b32 v126, 0
  v_mov_b32 v127, 0
  v_mov_b32 v128, 0
  v_mov_b32 v129, 0
  v_mov_b32 v130, 0
  v_mov_b32 v131, 0
  v_mov_b32 v132, 0
  v_mov_b32 v133, 0
  v_mov_b32 v134, 0
  v_mov_b32 v135, 0
  v_mov_b32 v136, 0
  v_mov_b32 v137, 0
  v_mov_b32 v138, 0
  v_mov_b32 v139, 0
  v_mov_b32 v140, 0
  v_mov_b32 v141, 0
  v_mov_b32 v142, 0
  v_mov_b32 v143, 0
  v_mov_b32 v144, 0
  v_mov_b32 v145, 0
  v_mov_b32 v146, 0
  v_mov_b32 v147, 0
  v_mov_b32 v148, 0
  v_mov_b32 v149, 0
  v_mov_b32 v150, 0
  v_mov_b32 v151, 0
  v_mov_b32 v152, 0
  v_mov_b32 v153, 0
  v_mov_b32 v154, 0
  v_mov_b32 v155, 0
  v_mov_b32 v156, 0
  v_mov_b32 v157, 0
  v_mov_b32 v158, 0
  v_mov_b32 v159, 0
  s_mov_b32 s34, 0
  s_mov_b32 s35, 0
  v_mov_b32 v3, v2
  v_mov_b32 v5, v4
  v_mov_b32 v11, v10
  v_cmp_gt_u32 vcc, 16, v0
  s_lshl_b32 s27, s25, 11
  s_add_u32 s27, s27, 147456
  v_mov_b32 v13, 512
  v_cndmask_b32 v13, v13, 0, vcc
  v_lshl_add_u32 v13, v6, 4, v13
  v_add_u32 v22, s27, v13
  s_lshl_b32 s27, s26, 9
  s_add_u32 s27, s27, 151552
  v_lshl_add_u32 v23, v6, 4, s27
  s_add_u32 s40, s6, 0x1d00000
  s_addc_u32 s41, s7, 0
  s_mov_b32 s42, 0xe00000
  s_mov_b32 s43, 0x20000
  s_mul_i32 s44, s22, 917504
  s_lshl_b32 s30, s23, 16
  s_add_u32 s44, s44, s30
  s_lshl_b32 s30, s26, 13
  s_add_u32 s44, s44, s30
  s_lshl_b32 s30, s25, 11
  s_add_u32 s44, s44, s30
  s_add_u32 s45, s44, 16384
  s_add_u32 s46, s44, 32768
  s_add_u32 s47, s44, 49152
  s_barrier
  ds_read_b64_tr_b16 v[208:209], v5 offset:0
  ds_read_b64_tr_b16 v[210:211], v5 offset:1024
  ds_read_b128 v[160:163], v3 offset:0
  ds_read_b128 v[164:167], v3 offset:256
  ds_read_b128 v[168:171], v3 offset:1024
  ds_read_b128 v[172:175], v3 offset:1280
  ds_read_b64_tr_b16 v[212:213], v11 offset:0
  ds_read_b64_tr_b16 v[214:215], v11 offset:1024
  ds_read_b64_tr_b16 v[216:217], v5 offset:8192
  ds_read_b64_tr_b16 v[218:219], v5 offset:9216
.Lattn_kernel_loop_89:
  s_waitcnt lgkmcnt(4)
  v_mfma_f32_16x16x32_bf16 v[32:35], v[208:211], v[160:163], v[32:35]
  ds_read_b64_tr_b16 v[220:221], v11 offset:8192
  v_mfma_f32_16x16x32_bf16 v[36:39], v[208:211], v[164:167], v[36:39]
  ds_read_b64_tr_b16 v[222:223], v11 offset:9216
  v_mfma_f32_16x16x32_bf16 v[40:43], v[208:211], v[168:171], v[40:43]
  v_mfma_f32_16x16x32_bf16 v[44:47], v[208:211], v[172:175], v[44:47]
  s_add_u32 s34, s34, 49152
  s_cmp_eq_u32 s34, 147456
  s_cselect_b32 s34, 0, s34
  s_add_u32 s35, s35, 1
  s_waitcnt lgkmcnt(4)
  v_mfma_f32_16x16x32_bf16 v[48:51], v[212:215], v[160:163], v[48:51]
  ds_read_b64_tr_b16 v[224:225], v5 offset:16384
  v_mfma_f32_16x16x32_bf16 v[52:55], v[212:215], v[164:167], v[52:55]
  ds_read_b64_tr_b16 v[226:227], v5 offset:17408
  v_mfma_f32_16x16x32_bf16 v[56:59], v[212:215], v[168:171], v[56:59]
  v_mfma_f32_16x16x32_bf16 v[60:63], v[212:215], v[172:175], v[60:63]
  s_waitcnt lgkmcnt(4)
  v_mfma_f32_16x16x32_bf16 v[64:67], v[216:219], v[160:163], v[64:67]
  ds_read_b64_tr_b16 v[228:229], v11 offset:16384
  v_mfma_f32_16x16x32_bf16 v[68:71], v[216:219], v[164:167], v[68:71]
  ds_read_b64_tr_b16 v[230:231], v11 offset:17408
  v_mfma_f32_16x16x32_bf16 v[72:75], v[216:219], v[168:171], v[72:75]
  v_mfma_f32_16x16x32_bf16 v[76:79], v[216:219], v[172:175], v[76:79]
  s_waitcnt lgkmcnt(4)
  v_mfma_f32_16x16x32_bf16 v[80:83], v[220:223], v[160:163], v[80:83]
  ds_read_b64_tr_b16 v[232:233], v5 offset:24576
  v_mfma_f32_16x16x32_bf16 v[84:87], v[220:223], v[164:167], v[84:87]
  ds_read_b64_tr_b16 v[234:235], v5 offset:25600
  v_mfma_f32_16x16x32_bf16 v[88:91], v[220:223], v[168:171], v[88:91]
  v_mfma_f32_16x16x32_bf16 v[92:95], v[220:223], v[172:175], v[92:95]
  s_waitcnt lgkmcnt(4)
  v_mfma_f32_16x16x32_bf16 v[96:99], v[224:227], v[160:163], v[96:99]
  ds_read_b64_tr_b16 v[236:237], v11 offset:24576
  v_mfma_f32_16x16x32_bf16 v[100:103], v[224:227], v[164:167], v[100:103]
  ds_read_b64_tr_b16 v[238:239], v11 offset:25600
  v_mfma_f32_16x16x32_bf16 v[104:107], v[224:227], v[168:171], v[104:107]
  ds_read_b128 v[176:179], v3 offset:8192
  v_mfma_f32_16x16x32_bf16 v[108:111], v[224:227], v[172:175], v[108:111]
  ds_read_b128 v[180:183], v3 offset:8448
  s_waitcnt lgkmcnt(6)
  v_mfma_f32_16x16x32_bf16 v[112:115], v[228:231], v[160:163], v[112:115]
  ds_read_b64_tr_b16 v[208:209], v5 offset:4096
  v_mfma_f32_16x16x32_bf16 v[116:119], v[228:231], v[164:167], v[116:119]
  ds_read_b64_tr_b16 v[210:211], v5 offset:5120
  v_mfma_f32_16x16x32_bf16 v[120:123], v[228:231], v[168:171], v[120:123]
  ds_read_b128 v[184:187], v3 offset:9216
  v_mfma_f32_16x16x32_bf16 v[124:127], v[228:231], v[172:175], v[124:127]
  ds_read_b128 v[188:191], v3 offset:9472
  s_waitcnt lgkmcnt(8)
  v_mfma_f32_16x16x32_bf16 v[128:131], v[232:235], v[160:163], v[128:131]
  ds_read_b64_tr_b16 v[212:213], v11 offset:4096
  v_mfma_f32_16x16x32_bf16 v[132:135], v[232:235], v[164:167], v[132:135]
  ds_read_b64_tr_b16 v[214:215], v11 offset:5120
  v_mfma_f32_16x16x32_bf16 v[136:139], v[232:235], v[168:171], v[136:139]
  v_mfma_f32_16x16x32_bf16 v[140:143], v[232:235], v[172:175], v[140:143]
  s_waitcnt lgkmcnt(8)
  v_mfma_f32_16x16x32_bf16 v[144:147], v[236:239], v[160:163], v[144:147]
  ds_read_b64_tr_b16 v[216:217], v5 offset:12288
  v_mfma_f32_16x16x32_bf16 v[148:151], v[236:239], v[164:167], v[148:151]
  ds_read_b64_tr_b16 v[218:219], v5 offset:13312
  v_mfma_f32_16x16x32_bf16 v[152:155], v[236:239], v[168:171], v[152:155]
  v_mfma_f32_16x16x32_bf16 v[156:159], v[236:239], v[172:175], v[156:159]
  s_waitcnt lgkmcnt(4)
  v_mfma_f32_16x16x32_bf16 v[32:35], v[208:211], v[176:179], v[32:35]
  ds_read_b64_tr_b16 v[220:221], v11 offset:12288
  v_mfma_f32_16x16x32_bf16 v[36:39], v[208:211], v[180:183], v[36:39]
  ds_read_b64_tr_b16 v[222:223], v11 offset:13312
  v_mfma_f32_16x16x32_bf16 v[40:43], v[208:211], v[184:187], v[40:43]
  v_mfma_f32_16x16x32_bf16 v[44:47], v[208:211], v[188:191], v[44:47]
  s_waitcnt lgkmcnt(4)
  v_mfma_f32_16x16x32_bf16 v[48:51], v[212:215], v[176:179], v[48:51]
  ds_read_b64_tr_b16 v[224:225], v5 offset:20480
  v_mfma_f32_16x16x32_bf16 v[52:55], v[212:215], v[180:183], v[52:55]
  ds_read_b64_tr_b16 v[226:227], v5 offset:21504
  v_mfma_f32_16x16x32_bf16 v[56:59], v[212:215], v[184:187], v[56:59]
  v_mfma_f32_16x16x32_bf16 v[60:63], v[212:215], v[188:191], v[60:63]
  s_waitcnt lgkmcnt(4)
  v_mfma_f32_16x16x32_bf16 v[64:67], v[216:219], v[176:179], v[64:67]
  ds_read_b64_tr_b16 v[228:229], v11 offset:20480
  v_mfma_f32_16x16x32_bf16 v[68:71], v[216:219], v[180:183], v[68:71]
  ds_read_b64_tr_b16 v[230:231], v11 offset:21504
  v_mfma_f32_16x16x32_bf16 v[72:75], v[216:219], v[184:187], v[72:75]
  v_mfma_f32_16x16x32_bf16 v[76:79], v[216:219], v[188:191], v[76:79]
  s_waitcnt lgkmcnt(4)
  v_mfma_f32_16x16x32_bf16 v[80:83], v[220:223], v[176:179], v[80:83]
  ds_read_b64_tr_b16 v[232:233], v5 offset:28672
  v_mfma_f32_16x16x32_bf16 v[84:87], v[220:223], v[180:183], v[84:87]
  ds_read_b64_tr_b16 v[234:235], v5 offset:29696
  v_mfma_f32_16x16x32_bf16 v[88:91], v[220:223], v[184:187], v[88:91]
  ds_read_b64_tr_b16 v[236:237], v11 offset:28672
  v_mfma_f32_16x16x32_bf16 v[92:95], v[220:223], v[188:191], v[92:95]
  ds_read_b64_tr_b16 v[238:239], v11 offset:29696
  v_add_u32 v3, s34, v2
  v_add_u32 v5, s34, v4
  v_add_u32 v11, s34, v10
  s_waitcnt lgkmcnt(6)
  v_mfma_f32_16x16x32_bf16 v[96:99], v[224:227], v[176:179], v[96:99]
  v_mfma_f32_16x16x32_bf16 v[100:103], v[224:227], v[180:183], v[100:103]
  v_mfma_f32_16x16x32_bf16 v[104:107], v[224:227], v[184:187], v[104:107]
  v_mfma_f32_16x16x32_bf16 v[108:111], v[224:227], v[188:191], v[108:111]
  s_waitcnt lgkmcnt(0)
  s_barrier
  v_mfma_f32_16x16x32_bf16 v[112:115], v[228:231], v[176:179], v[112:115]
  ds_read_b64_tr_b16 v[208:209], v5 offset:0
  v_mfma_f32_16x16x32_bf16 v[116:119], v[228:231], v[180:183], v[116:119]
  ds_read_b64_tr_b16 v[210:211], v5 offset:1024
  v_mfma_f32_16x16x32_bf16 v[120:123], v[228:231], v[184:187], v[120:123]
  ds_read_b128 v[160:163], v3 offset:0
  v_mfma_f32_16x16x32_bf16 v[124:127], v[228:231], v[188:191], v[124:127]
  ds_read_b128 v[164:167], v3 offset:256
  v_mfma_f32_16x16x32_bf16 v[128:131], v[232:235], v[176:179], v[128:131]
  ds_read_b128 v[168:171], v3 offset:1024
  v_mfma_f32_16x16x32_bf16 v[132:135], v[232:235], v[180:183], v[132:135]
  ds_read_b128 v[172:175], v3 offset:1280
  v_mfma_f32_16x16x32_bf16 v[136:139], v[232:235], v[184:187], v[136:139]
  ds_read_b64_tr_b16 v[212:213], v11 offset:0
  v_mfma_f32_16x16x32_bf16 v[140:143], v[232:235], v[188:191], v[140:143]
  ds_read_b64_tr_b16 v[214:215], v11 offset:1024
  v_mfma_f32_16x16x32_bf16 v[144:147], v[236:239], v[176:179], v[144:147]
  ds_read_b64_tr_b16 v[216:217], v5 offset:8192
  v_mfma_f32_16x16x32_bf16 v[148:151], v[236:239], v[180:183], v[148:151]
  ds_read_b64_tr_b16 v[218:219], v5 offset:9216
  v_mfma_f32_16x16x32_bf16 v[152:155], v[236:239], v[184:187], v[152:155]
  v_mfma_f32_16x16x32_bf16 v[156:159], v[236:239], v[188:191], v[156:159]
  s_cmp_lt_u32 s35, 14
  s_cbranch_scc1 .Lattn_kernel_loop_89
  v_add_u32 v24, 0, v2
  v_xor_b32 v25, 64, v24
  v_add_u32 v26, 0, v4
  v_add_u32 v27, 0, v10
  s_waitcnt lgkmcnt(4)
  v_mfma_f32_16x16x32_bf16 v[32:35], v[208:211], v[160:163], v[32:35]
  ds_read_b128 v[176:179], v3 offset:8192
  ds_read_b128 v[180:183], v3 offset:8448
  v_mfma_f32_16x16x32_bf16 v[36:39], v[208:211], v[164:167], v[36:39]
  ds_read_b64_tr_b16 v[220:221], v11 offset:8192
  ds_read_b64_tr_b16 v[222:223], v11 offset:9216
  v_mfma_f32_16x16x32_bf16 v[40:43], v[208:211], v[168:171], v[40:43]
  v_mfma_f32_16x16x32_bf16 v[44:47], v[208:211], v[172:175], v[44:47]
  s_waitcnt lgkmcnt(6)
  v_mfma_f32_16x16x32_bf16 v[48:51], v[212:215], v[160:163], v[48:51]
  ds_read_b128 v[184:187], v3 offset:9216
  ds_read_b128 v[188:191], v3 offset:9472
  v_mfma_f32_16x16x32_bf16 v[52:55], v[212:215], v[164:167], v[52:55]
  ds_read_b64_tr_b16 v[224:225], v5 offset:4096
  ds_read_b64_tr_b16 v[226:227], v5 offset:5120
  v_mfma_f32_16x16x32_bf16 v[56:59], v[212:215], v[168:171], v[56:59]
  v_mfma_f32_16x16x32_bf16 v[60:63], v[212:215], v[172:175], v[60:63]
  s_waitcnt lgkmcnt(8)
  v_mfma_f32_16x16x32_bf16 v[64:67], v[216:219], v[160:163], v[64:67]
  ds_read_b64_tr_b16 v[228:229], v11 offset:4096
  ds_read_b64_tr_b16 v[230:231], v11 offset:5120
  v_mfma_f32_16x16x32_bf16 v[68:71], v[216:219], v[164:167], v[68:71]
  v_mfma_f32_16x16x32_bf16 v[72:75], v[216:219], v[168:171], v[72:75]
  v_mfma_f32_16x16x32_bf16 v[76:79], v[216:219], v[172:175], v[76:79]
  s_waitcnt lgkmcnt(6)
  v_mfma_f32_16x16x32_bf16 v[80:83], v[220:223], v[160:163], v[80:83]
  ds_read_b64_tr_b16 v[232:233], v5 offset:12288
  ds_read_b64_tr_b16 v[234:235], v5 offset:13312
  v_mfma_f32_16x16x32_bf16 v[84:87], v[220:223], v[164:167], v[84:87]
  v_mfma_f32_16x16x32_bf16 v[88:91], v[220:223], v[168:171], v[88:91]
  v_mfma_f32_16x16x32_bf16 v[92:95], v[220:223], v[172:175], v[92:95]
  s_waitcnt lgkmcnt(4)
  v_mfma_f32_16x16x32_bf16 v[32:35], v[224:227], v[176:179], v[32:35]
  ds_read_b64_tr_b16 v[236:237], v11 offset:12288
  ds_read_b64_tr_b16 v[238:239], v11 offset:13312
  v_mfma_f32_16x16x32_bf16 v[36:39], v[224:227], v[180:183], v[36:39]
  v_mfma_f32_16x16x32_bf16 v[40:43], v[224:227], v[184:187], v[40:43]
  v_mfma_f32_16x16x32_bf16 v[44:47], v[224:227], v[188:191], v[44:47]
  s_barrier
  s_waitcnt lgkmcnt(4)
  v_mfma_f32_16x16x32_bf16 v[48:51], v[228:231], v[176:179], v[48:51]
  ds_read_b128 v[192:195], v24 offset:0
  ds_read_b128 v[196:199], v24 offset:256
  v_mfma_f32_16x16x32_bf16 v[52:55], v[228:231], v[180:183], v[52:55]
  ds_read_b64_tr_b16 v[208:209], v26 offset:0
  ds_read_b64_tr_b16 v[210:211], v26 offset:1024
  v_mfma_f32_16x16x32_bf16 v[56:59], v[228:231], v[184:187], v[56:59]
  v_mfma_f32_16x16x32_bf16 v[60:63], v[228:231], v[188:191], v[60:63]
  s_waitcnt lgkmcnt(6)
  v_mfma_f32_16x16x32_bf16 v[64:67], v[232:235], v[176:179], v[64:67]
  ds_read_b128 v[200:203], v24 offset:1024
  ds_read_b128 v[204:207], v24 offset:1280
  v_mfma_f32_16x16x32_bf16 v[68:71], v[232:235], v[180:183], v[68:71]
  ds_read_b64_tr_b16 v[212:213], v27 offset:0
  ds_read_b64_tr_b16 v[214:215], v27 offset:1024
  v_mfma_f32_16x16x32_bf16 v[72:75], v[232:235], v[184:187], v[72:75]
  v_mfma_f32_16x16x32_bf16 v[76:79], v[232:235], v[188:191], v[76:79]
  s_waitcnt lgkmcnt(8)
  v_mfma_f32_16x16x32_bf16 v[80:83], v[236:239], v[176:179], v[80:83]
  ds_read_b64_tr_b16 v[216:217], v26 offset:4096
  ds_read_b64_tr_b16 v[218:219], v26 offset:5120
  v_mfma_f32_16x16x32_bf16 v[84:87], v[236:239], v[180:183], v[84:87]
  v_mfma_f32_16x16x32_bf16 v[88:91], v[236:239], v[184:187], v[88:91]
  v_mfma_f32_16x16x32_bf16 v[92:95], v[236:239], v[188:191], v[92:95]
  s_waitcnt lgkmcnt(4)
  v_mfma_f32_16x16x32_bf16 v[32:35], v[208:211], v[192:195], v[32:35]
  ds_read_b128 v[176:179], v24 offset:8192
  ds_read_b128 v[180:183], v24 offset:8448
  v_mfma_f32_16x16x32_bf16 v[36:39], v[208:211], v[196:199], v[36:39]
  ds_read_b128 v[184:187], v24 offset:9216
  ds_read_b128 v[188:191], v24 offset:9472
  v_mfma_f32_16x16x32_bf16 v[40:43], v[208:211], v[200:203], v[40:43]
  ds_read_b128 v[160:163], v22 offset:0
  ds_read_b128 v[164:167], v22 offset:256
  v_mfma_f32_16x16x32_bf16 v[44:47], v[208:211], v[204:207], v[44:47]
  ds_read_b128 v[168:171], v22 offset:1024
  ds_read_b128 v[172:175], v22 offset:1280
  ds_read_b64_tr_b16 v[220:221], v27 offset:4096
  ds_read_b64_tr_b16 v[222:223], v27 offset:5120
  s_waitcnt lgkmcnt(12)
  v_mfma_f32_16x16x32_bf16 v[48:51], v[212:215], v[192:195], v[48:51]
  ds_read_b128 v[224:227], v23 offset:0
  v_mfma_f32_16x16x32_bf16 v[52:55], v[212:215], v[196:199], v[52:55]
  v_mfma_f32_16x16x32_bf16 v[56:59], v[212:215], v[200:203], v[56:59]
  v_mfma_f32_16x16x32_bf16 v[60:63], v[212:215], v[204:207], v[60:63]
  s_waitcnt lgkmcnt(7)
  v_mfma_f32_16x16x32_bf16 v[32:35], v[216:219], v[176:179], v[32:35]
  ds_read_b128 v[228:231], v23 offset:256
  v_mfma_f32_16x16x32_bf16 v[36:39], v[216:219], v[180:183], v[36:39]
  v_mfma_f32_16x16x32_bf16 v[40:43], v[216:219], v[184:187], v[40:43]
  v_mfma_f32_16x16x32_bf16 v[44:47], v[216:219], v[188:191], v[44:47]
  s_waitcnt lgkmcnt(2)
  v_mfma_f32_16x16x32_bf16 v[48:51], v[220:223], v[176:179], v[48:51]
  ds_read_b64_tr_b16 v[232:233], v26 offset:8192
  ds_read_b64_tr_b16 v[234:235], v26 offset:9216
  v_mfma_f32_16x16x32_bf16 v[52:55], v[220:223], v[180:183], v[52:55]
  v_mfma_f32_16x16x32_bf16 v[56:59], v[220:223], v[184:187], v[56:59]
  v_mfma_f32_16x16x32_bf16 v[60:63], v[220:223], v[188:191], v[60:63]
  s_waitcnt lgkmcnt(3)
  v_mfma_f32_16x16x32_bf16 v[32:35], v[224:227], v[160:163], v[32:35]
  ds_read_b64_tr_b16 v[236:237], v27 offset:8192
  ds_read_b64_tr_b16 v[238:239], v27 offset:9216
  v_mfma_f32_16x16x32_bf16 v[36:39], v[224:227], v[164:167], v[36:39]
  v_mfma_f32_16x16x32_bf16 v[40:43], v[224:227], v[168:171], v[40:43]
  v_mfma_f32_16x16x32_bf16 v[44:47], v[224:227], v[172:175], v[44:47]
  s_waitcnt lgkmcnt(4)
  v_mfma_f32_16x16x32_bf16 v[48:51], v[228:231], v[160:163], v[48:51]
  ds_read_b64_tr_b16 v[208:209], v26 offset:12288
  ds_read_b64_tr_b16 v[210:211], v26 offset:13312
  v_mfma_f32_16x16x32_bf16 v[52:55], v[228:231], v[164:167], v[52:55]
  v_mfma_f32_16x16x32_bf16 v[56:59], v[228:231], v[168:171], v[56:59]
  v_mfma_f32_16x16x32_bf16 v[60:63], v[228:231], v[172:175], v[60:63]
  s_waitcnt lgkmcnt(4)
  v_mfma_f32_16x16x32_bf16 v[64:67], v[232:235], v[192:195], v[64:67]
  ds_read_b64_tr_b16 v[212:213], v27 offset:12288
  ds_read_b64_tr_b16 v[214:215], v27 offset:13312
  v_mfma_f32_16x16x32_bf16 v[68:71], v[232:235], v[196:199], v[68:71]
  v_mfma_f32_16x16x32_bf16 v[72:75], v[232:235], v[200:203], v[72:75]
  v_mfma_f32_16x16x32_bf16 v[76:79], v[232:235], v[204:207], v[76:79]
  s_waitcnt lgkmcnt(4)
  v_mfma_f32_16x16x32_bf16 v[80:83], v[236:239], v[192:195], v[80:83]
  ds_read_b128 v[216:219], v23 offset:1024
  v_mfma_f32_16x16x32_bf16 v[84:87], v[236:239], v[196:199], v[84:87]
  v_mfma_f32_16x16x32_bf16 v[88:91], v[236:239], v[200:203], v[88:91]
  v_mfma_f32_16x16x32_bf16 v[92:95], v[236:239], v[204:207], v[92:95]
  s_waitcnt lgkmcnt(3)
  v_mfma_f32_16x16x32_bf16 v[64:67], v[208:211], v[176:179], v[64:67]
  ds_read_b128 v[220:223], v23 offset:1280
  v_cvt_pk_bf16_f32 v32, v32, v33
  v_cvt_pk_bf16_f32 v33, v34, v35
  v_cvt_pk_bf16_f32 v34, v48, v49
  v_mfma_f32_16x16x32_bf16 v[68:71], v[208:211], v[180:183], v[68:71]
  v_cvt_pk_bf16_f32 v35, v50, v51
  v_pk_max_i16 v32, v32, 0
  v_pk_max_i16 v33, v33, 0
  v_mfma_f32_16x16x32_bf16 v[72:75], v[208:211], v[184:187], v[72:75]
  v_pk_max_i16 v34, v34, 0
  v_pk_max_i16 v35, v35, 0
  buffer_store_dwordx4 v[32:35], v12, s[40:43], s44 offen offset:0 sc0 sc1
  v_mfma_f32_16x16x32_bf16 v[76:79], v[208:211], v[188:191], v[76:79]
  v_cvt_pk_bf16_f32 v36, v36, v37
  v_cvt_pk_bf16_f32 v37, v38, v39
  v_cvt_pk_bf16_f32 v38, v52, v53
  s_waitcnt lgkmcnt(2)
  v_mfma_f32_16x16x32_bf16 v[80:83], v[212:215], v[176:179], v[80:83]
  ds_read_b128 v[224:227], v23 offset:2048
  v_cvt_pk_bf16_f32 v39, v54, v55
  v_pk_max_i16 v36, v36, 0
  v_pk_max_i16 v37, v37, 0
  v_mfma_f32_16x16x32_bf16 v[84:87], v[212:215], v[180:183], v[84:87]
  v_pk_max_i16 v38, v38, 0
  v_pk_max_i16 v39, v39, 0
  buffer_store_dwordx4 v[36:39], v12, s[40:43], s44 offen offset:256 sc0 sc1
  v_mfma_f32_16x16x32_bf16 v[88:91], v[212:215], v[184:187], v[88:91]
  v_cvt_pk_bf16_f32 v40, v40, v41
  v_cvt_pk_bf16_f32 v41, v42, v43
  v_cvt_pk_bf16_f32 v42, v56, v57
  v_mfma_f32_16x16x32_bf16 v[92:95], v[212:215], v[188:191], v[92:95]
  v_cvt_pk_bf16_f32 v43, v58, v59
  v_pk_max_i16 v40, v40, 0
  v_pk_max_i16 v41, v41, 0
  s_waitcnt lgkmcnt(2)
  v_mfma_f32_16x16x32_bf16 v[64:67], v[216:219], v[160:163], v[64:67]
  ds_read_b128 v[228:231], v23 offset:2304
  v_pk_max_i16 v42, v42, 0
  v_pk_max_i16 v43, v43, 0
  buffer_store_dwordx4 v[40:43], v12, s[40:43], s44 offen offset:1024 sc0 sc1
  v_mfma_f32_16x16x32_bf16 v[68:71], v[216:219], v[164:167], v[68:71]
  v_cvt_pk_bf16_f32 v44, v44, v45
  v_cvt_pk_bf16_f32 v45, v46, v47
  v_cvt_pk_bf16_f32 v46, v60, v61
  v_mfma_f32_16x16x32_bf16 v[72:75], v[216:219], v[168:171], v[72:75]
  v_cvt_pk_bf16_f32 v47, v62, v63
  v_pk_max_i16 v44, v44, 0
  v_pk_max_i16 v45, v45, 0
  v_mfma_f32_16x16x32_bf16 v[76:79], v[216:219], v[172:175], v[76:79]
  v_pk_max_i16 v46, v46, 0
  v_pk_max_i16 v47, v47, 0
  buffer_store_dwordx4 v[44:47], v12, s[40:43], s44 offen offset:1280 sc0 sc1
  s_waitcnt lgkmcnt(2)
  v_mfma_f32_16x16x32_bf16 v[80:83], v[220:223], v[160:163], v[80:83]
  ds_read_b64_tr_b16 v[232:233], v26 offset:20480
  ds_read_b64_tr_b16 v[234:235], v26 offset:21504
  v_mfma_f32_16x16x32_bf16 v[84:87], v[220:223], v[164:167], v[84:87]
  v_mfma_f32_16x16x32_bf16 v[88:91], v[220:223], v[168:171], v[88:91]
  v_mfma_f32_16x16x32_bf16 v[92:95], v[220:223], v[172:175], v[92:95]
  s_waitcnt lgkmcnt(3)
  v_mfma_f32_16x16x32_bf16 v[96:99], v[224:227], v[160:163], v[96:99]
  ds_read_b64_tr_b16 v[236:237], v27 offset:20480
  ds_read_b64_tr_b16 v[238:239], v27 offset:21504
  v_mfma_f32_16x16x32_bf16 v[100:103], v[224:227], v[164:167], v[100:103]
  v_mfma_f32_16x16x32_bf16 v[104:107], v[224:227], v[168:171], v[104:107]
  v_mfma_f32_16x16x32_bf16 v[108:111], v[224:227], v[172:175], v[108:111]
  s_waitcnt lgkmcnt(4)
  v_mfma_f32_16x16x32_bf16 v[112:115], v[228:231], v[160:163], v[112:115]
  ds_read_b64_tr_b16 v[208:209], v26 offset:16384
  ds_read_b64_tr_b16 v[210:211], v26 offset:17408
  v_mfma_f32_16x16x32_bf16 v[116:119], v[228:231], v[164:167], v[116:119]
  v_mfma_f32_16x16x32_bf16 v[120:123], v[228:231], v[168:171], v[120:123]
  v_mfma_f32_16x16x32_bf16 v[124:127], v[228:231], v[172:175], v[124:127]
  s_waitcnt lgkmcnt(4)
  v_mfma_f32_16x16x32_bf16 v[96:99], v[232:235], v[176:179], v[96:99]
  ds_read_b128 v[160:163], v3 offset:0
  ds_read_b128 v[164:167], v3 offset:256
  v_cvt_pk_bf16_f32 v64, v64, v65
  v_cvt_pk_bf16_f32 v65, v66, v67
  v_cvt_pk_bf16_f32 v66, v80, v81
  v_mfma_f32_16x16x32_bf16 v[100:103], v[232:235], v[180:183], v[100:103]
  ds_read_b128 v[168:171], v3 offset:1024
  ds_read_b128 v[172:175], v3 offset:1280
  v_cvt_pk_bf16_f32 v67, v82, v83
  v_pk_max_i16 v64, v64, 0
  v_pk_max_i16 v65, v65, 0
  v_mfma_f32_16x16x32_bf16 v[104:107], v[232:235], v[184:187], v[104:107]
  ds_read_b64_tr_b16 v[212:213], v27 offset:16384
  ds_read_b64_tr_b16 v[214:215], v27 offset:17408
  v_pk_max_i16 v66, v66, 0
  v_pk_max_i16 v67, v67, 0
  buffer_store_dwordx4 v[64:67], v12, s[40:43], s45 offen offset:0 sc0 sc1
  v_mfma_f32_16x16x32_bf16 v[108:111], v[232:235], v[188:191], v[108:111]
  v_cvt_pk_bf16_f32 v68, v68, v69
  v_cvt_pk_bf16_f32 v69, v70, v71
  v_cvt_pk_bf16_f32 v70, v84, v85
  s_waitcnt lgkmcnt(8)
  v_mfma_f32_16x16x32_bf16 v[112:115], v[236:239], v[176:179], v[112:115]
  ds_read_b64_tr_b16 v[216:217], v5 offset:16384
  ds_read_b64_tr_b16 v[218:219], v5 offset:17408
  v_cvt_pk_bf16_f32 v71, v86, v87
  v_pk_max_i16 v68, v68, 0
  v_pk_max_i16 v69, v69, 0
  v_mfma_f32_16x16x32_bf16 v[116:119], v[236:239], v[180:183], v[116:119]
  v_pk_max_i16 v70, v70, 0
  v_pk_max_i16 v71, v71, 0
  buffer_store_dwordx4 v[68:71], v12, s[40:43], s45 offen offset:256 sc0 sc1
  v_mfma_f32_16x16x32_bf16 v[120:123], v[236:239], v[184:187], v[120:123]
  v_cvt_pk_bf16_f32 v72, v72, v73
  v_cvt_pk_bf16_f32 v73, v74, v75
  v_cvt_pk_bf16_f32 v74, v88, v89
  v_mfma_f32_16x16x32_bf16 v[124:127], v[236:239], v[188:191], v[124:127]
  v_cvt_pk_bf16_f32 v75, v90, v91
  v_pk_max_i16 v72, v72, 0
  v_pk_max_i16 v73, v73, 0
  s_waitcnt lgkmcnt(8)
  v_mfma_f32_16x16x32_bf16 v[96:99], v[208:211], v[192:195], v[96:99]
  ds_read_b128 v[176:179], v3 offset:8192
  ds_read_b128 v[180:183], v3 offset:8448
  v_pk_max_i16 v74, v74, 0
  v_pk_max_i16 v75, v75, 0
  buffer_store_dwordx4 v[72:75], v12, s[40:43], s45 offen offset:1024 sc0 sc1
  v_mfma_f32_16x16x32_bf16 v[100:103], v[208:211], v[196:199], v[100:103]
  ds_read_b128 v[184:187], v3 offset:9216
  ds_read_b128 v[188:191], v3 offset:9472
  v_cvt_pk_bf16_f32 v76, v76, v77
  v_cvt_pk_bf16_f32 v77, v78, v79
  v_cvt_pk_bf16_f32 v78, v92, v93
  v_mfma_f32_16x16x32_bf16 v[104:107], v[208:211], v[200:203], v[104:107]
  ds_read_b64_tr_b16 v[220:221], v11 offset:16384
  ds_read_b64_tr_b16 v[222:223], v11 offset:17408
  v_cvt_pk_bf16_f32 v79, v94, v95
  v_pk_max_i16 v76, v76, 0
  v_pk_max_i16 v77, v77, 0
  v_mfma_f32_16x16x32_bf16 v[108:111], v[208:211], v[204:207], v[108:111]
  v_pk_max_i16 v78, v78, 0
  v_pk_max_i16 v79, v79, 0
  buffer_store_dwordx4 v[76:79], v12, s[40:43], s45 offen offset:1280 sc0 sc1
  s_waitcnt lgkmcnt(8)
  v_mfma_f32_16x16x32_bf16 v[112:115], v[212:215], v[192:195], v[112:115]
  ds_read_b64_tr_b16 v[224:225], v5 offset:20480
  ds_read_b64_tr_b16 v[226:227], v5 offset:21504
  v_mfma_f32_16x16x32_bf16 v[116:119], v[212:215], v[196:199], v[116:119]
  v_mfma_f32_16x16x32_bf16 v[120:123], v[212:215], v[200:203], v[120:123]
  v_mfma_f32_16x16x32_bf16 v[124:127], v[212:215], v[204:207], v[124:127]
  s_waitcnt lgkmcnt(8)
  v_mfma_f32_16x16x32_bf16 v[96:99], v[216:219], v[160:163], v[96:99]
  ds_read_b64_tr_b16 v[228:229], v11 offset:20480
  ds_read_b64_tr_b16 v[230:231], v11 offset:21504
  v_mfma_f32_16x16x32_bf16 v[100:103], v[216:219], v[164:167], v[100:103]
  v_mfma_f32_16x16x32_bf16 v[104:107], v[216:219], v[168:171], v[104:107]
  v_mfma_f32_16x16x32_bf16 v[108:111], v[216:219], v[172:175], v[108:111]
  s_waitcnt lgkmcnt(4)
  v_mfma_f32_16x16x32_bf16 v[112:115], v[220:223], v[160:163], v[112:115]
  ds_read_b64_tr_b16 v[232:233], v5 offset:28672
  ds_read_b64_tr_b16 v[234:235], v5 offset:29696
  v_mfma_f32_16x16x32_bf16 v[116:119], v[220:223], v[164:167], v[116:119]
  v_mfma_f32_16x16x32_bf16 v[120:123], v[220:223], v[168:171], v[120:123]
  v_mfma_f32_16x16x32_bf16 v[124:127], v[220:223], v[172:175], v[124:127]
  s_waitcnt lgkmcnt(4)
  v_mfma_f32_16x16x32_bf16 v[96:99], v[224:227], v[176:179], v[96:99]
  ds_read_b64_tr_b16 v[236:237], v11 offset:28672
  ds_read_b64_tr_b16 v[238:239], v11 offset:29696
  v_mfma_f32_16x16x32_bf16 v[100:103], v[224:227], v[180:183], v[100:103]
  v_mfma_f32_16x16x32_bf16 v[104:107], v[224:227], v[184:187], v[104:107]
  v_mfma_f32_16x16x32_bf16 v[108:111], v[224:227], v[188:191], v[108:111]
  s_waitcnt lgkmcnt(4)
  v_mfma_f32_16x16x32_bf16 v[112:115], v[228:231], v[176:179], v[112:115]
  ds_read_b64_tr_b16 v[208:209], v5 offset:24576
  ds_read_b64_tr_b16 v[210:211], v5 offset:25600
  v_mfma_f32_16x16x32_bf16 v[116:119], v[228:231], v[180:183], v[116:119]
  v_mfma_f32_16x16x32_bf16 v[120:123], v[228:231], v[184:187], v[120:123]
  v_mfma_f32_16x16x32_bf16 v[124:127], v[228:231], v[188:191], v[124:127]
  s_waitcnt lgkmcnt(4)
  v_mfma_f32_16x16x32_bf16 v[128:131], v[232:235], v[176:179], v[128:131]
  ds_read_b64_tr_b16 v[212:213], v11 offset:24576
  ds_read_b64_tr_b16 v[214:215], v11 offset:25600
  v_mfma_f32_16x16x32_bf16 v[132:135], v[232:235], v[180:183], v[132:135]
  v_mfma_f32_16x16x32_bf16 v[136:139], v[232:235], v[184:187], v[136:139]
  v_mfma_f32_16x16x32_bf16 v[140:143], v[232:235], v[188:191], v[140:143]
  s_waitcnt lgkmcnt(4)
  v_mfma_f32_16x16x32_bf16 v[144:147], v[236:239], v[176:179], v[144:147]
  ds_read_b64_tr_b16 v[216:217], v26 offset:24576
  ds_read_b64_tr_b16 v[218:219], v26 offset:25600
  v_mfma_f32_16x16x32_bf16 v[148:151], v[236:239], v[180:183], v[148:151]
  v_mfma_f32_16x16x32_bf16 v[152:155], v[236:239], v[184:187], v[152:155]
  v_mfma_f32_16x16x32_bf16 v[156:159], v[236:239], v[188:191], v[156:159]
  s_waitcnt lgkmcnt(4)
  v_mfma_f32_16x16x32_bf16 v[128:131], v[208:211], v[160:163], v[128:131]
  ds_read_b128 v[176:179], v24 offset:8192
  ds_read_b128 v[180:183], v24 offset:8448
  v_cvt_pk_bf16_f32 v96, v96, v97
  v_cvt_pk_bf16_f32 v97, v98, v99
  v_cvt_pk_bf16_f32 v98, v112, v113
  v_mfma_f32_16x16x32_bf16 v[132:135], v[208:211], v[164:167], v[132:135]
  ds_read_b128 v[184:187], v24 offset:9216
  ds_read_b128 v[188:191], v24 offset:9472
  v_cvt_pk_bf16_f32 v99, v114, v115
  v_pk_max_i16 v96, v96, 0
  v_pk_max_i16 v97, v97, 0
  v_mfma_f32_16x16x32_bf16 v[136:139], v[208:211], v[168:171], v[136:139]
  ds_read_b64_tr_b16 v[220:221], v27 offset:24576
  ds_read_b64_tr_b16 v[222:223], v27 offset:25600
  v_pk_max_i16 v98, v98, 0
  v_pk_max_i16 v99, v99, 0
  buffer_store_dwordx4 v[96:99], v12, s[40:43], s46 offen offset:0 sc0 sc1
  v_mfma_f32_16x16x32_bf16 v[140:143], v[208:211], v[172:175], v[140:143]
  v_cvt_pk_bf16_f32 v100, v100, v101
  v_cvt_pk_bf16_f32 v101, v102, v103
  v_cvt_pk_bf16_f32 v102, v116, v117
  s_waitcnt lgkmcnt(8)
  v_mfma_f32_16x16x32_bf16 v[144:147], v[212:215], v[160:163], v[144:147]
  ds_read_b64_tr_b16 v[224:225], v26 offset:28672
  ds_read_b64_tr_b16 v[226:227], v26 offset:29696
  v_cvt_pk_bf16_f32 v103, v118, v119
  v_pk_max_i16 v100, v100, 0
  v_pk_max_i16 v101, v101, 0
  v_mfma_f32_16x16x32_bf16 v[148:151], v[212:215], v[164:167], v[148:151]
  v_pk_max_i16 v102, v102, 0
  v_pk_max_i16 v103, v103, 0
  buffer_store_dwordx4 v[100:103], v12, s[40:43], s46 offen offset:256 sc0 sc1
  v_mfma_f32_16x16x32_bf16 v[152:155], v[212:215], v[168:171], v[152:155]
  v_cvt_pk_bf16_f32 v104, v104, v105
  v_cvt_pk_bf16_f32 v105, v106, v107
  v_cvt_pk_bf16_f32 v106, v120, v121
  v_mfma_f32_16x16x32_bf16 v[156:159], v[212:215], v[172:175], v[156:159]
  v_cvt_pk_bf16_f32 v107, v122, v123
  v_pk_max_i16 v104, v104, 0
  v_pk_max_i16 v105, v105, 0
  s_waitcnt lgkmcnt(8)
  v_mfma_f32_16x16x32_bf16 v[128:131], v[216:219], v[192:195], v[128:131]
  ds_read_b128 v[160:163], v22 offset:0
  ds_read_b128 v[164:167], v22 offset:256
  v_pk_max_i16 v106, v106, 0
  v_pk_max_i16 v107, v107, 0
  buffer_store_dwordx4 v[104:107], v12, s[40:43], s46 offen offset:1024 sc0 sc1
  v_mfma_f32_16x16x32_bf16 v[132:135], v[216:219], v[196:199], v[132:135]
  ds_read_b128 v[168:171], v22 offset:1024
  ds_read_b128 v[172:175], v22 offset:1280
  v_cvt_pk_bf16_f32 v108, v108, v109
  v_cvt_pk_bf16_f32 v109, v110, v111
  v_cvt_pk_bf16_f32 v110, v124, v125
  v_mfma_f32_16x16x32_bf16 v[136:139], v[216:219], v[200:203], v[136:139]
  ds_read_b64_tr_b16 v[228:229], v27 offset:28672
  ds_read_b64_tr_b16 v[230:231], v27 offset:29696
  v_cvt_pk_bf16_f32 v111, v126, v127
  v_pk_max_i16 v108, v108, 0
  v_pk_max_i16 v109, v109, 0
  v_mfma_f32_16x16x32_bf16 v[140:143], v[216:219], v[204:207], v[140:143]
  v_pk_max_i16 v110, v110, 0
  v_pk_max_i16 v111, v111, 0
  buffer_store_dwordx4 v[108:111], v12, s[40:43], s46 offen offset:1280 sc0 sc1
  s_waitcnt lgkmcnt(8)
  v_mfma_f32_16x16x32_bf16 v[144:147], v[220:223], v[192:195], v[144:147]
  ds_read_b128 v[232:235], v23 offset:3072
  v_mfma_f32_16x16x32_bf16 v[148:151], v[220:223], v[196:199], v[148:151]
  v_mfma_f32_16x16x32_bf16 v[152:155], v[220:223], v[200:203], v[152:155]
  v_mfma_f32_16x16x32_bf16 v[156:159], v[220:223], v[204:207], v[156:159]
  s_waitcnt lgkmcnt(7)
  v_mfma_f32_16x16x32_bf16 v[128:131], v[224:227], v[176:179], v[128:131]
  ds_read_b128 v[236:239], v23 offset:3328
  v_mfma_f32_16x16x32_bf16 v[132:135], v[224:227], v[180:183], v[132:135]
  v_mfma_f32_16x16x32_bf16 v[136:139], v[224:227], v[184:187], v[136:139]
  v_mfma_f32_16x16x32_bf16 v[140:143], v[224:227], v[188:191], v[140:143]
  s_waitcnt lgkmcnt(2)
  v_mfma_f32_16x16x32_bf16 v[144:147], v[228:231], v[176:179], v[144:147]
  v_mfma_f32_16x16x32_bf16 v[148:151], v[228:231], v[180:183], v[148:151]
  v_mfma_f32_16x16x32_bf16 v[152:155], v[228:231], v[184:187], v[152:155]
  v_mfma_f32_16x16x32_bf16 v[156:159], v[228:231], v[188:191], v[156:159]
  s_waitcnt lgkmcnt(0)
  s_barrier
  v_mfma_f32_16x16x32_bf16 v[128:131], v[232:235], v[160:163], v[128:131]
  v_mfma_f32_16x16x32_bf16 v[132:135], v[232:235], v[164:167], v[132:135]
  v_mfma_f32_16x16x32_bf16 v[136:139], v[232:235], v[168:171], v[136:139]
  v_mfma_f32_16x16x32_bf16 v[140:143], v[232:235], v[172:175], v[140:143]
  v_mfma_f32_16x16x32_bf16 v[144:147], v[236:239], v[160:163], v[144:147]
  v_mfma_f32_16x16x32_bf16 v[148:151], v[236:239], v[164:167], v[148:151]
  v_mfma_f32_16x16x32_bf16 v[152:155], v[236:239], v[168:171], v[152:155]
  v_mfma_f32_16x16x32_bf16 v[156:159], v[236:239], v[172:175], v[156:159]
  s_nop 7
  s_waitcnt vmcnt(8)
  v_mov_b32 v18, 163780
  v_mov_b32 v19, 1
  s_mov_b64 exec, 1
  ds_add_rtn_u32 v20, v18, v19
  s_mov_b64 exec, -1
  s_lshl_b32 s29, s22, 8
  s_add_u32 s29, s29, 659456
  s_waitcnt lgkmcnt(0)
  v_readfirstlane_b32 s30, v20
  s_nop 3
  s_cmp_lg_u32 s30, 3
  s_cbranch_scc1 .Lattn_kernel_nolast_90
  v_mov_b32 v18, 0
  v_mov_b32 v19, 1
  s_mov_b64 exec, 1
  buffer_atomic_add v19, v18, s[16:19], s29 offen sc1
  s_mov_b64 exec, -1
.Lattn_kernel_nolast_90:
  v_cvt_pk_bf16_f32 v128, v128, v129
  v_cvt_pk_bf16_f32 v129, v130, v131
  v_cvt_pk_bf16_f32 v130, v144, v145
  v_cvt_pk_bf16_f32 v131, v146, v147
  v_pk_max_i16 v128, v128, 0
  v_pk_max_i16 v129, v129, 0
  v_pk_max_i16 v130, v130, 0
  v_pk_max_i16 v131, v131, 0
  buffer_store_dwordx4 v[128:131], v12, s[40:43], s47 offen offset:0 sc0 sc1
  v_cvt_pk_bf16_f32 v132, v132, v133
  v_cvt_pk_bf16_f32 v133, v134, v135
  v_cvt_pk_bf16_f32 v134, v148, v149
  v_cvt_pk_bf16_f32 v135, v150, v151
  v_pk_max_i16 v132, v132, 0
  v_pk_max_i16 v133, v133, 0
  v_pk_max_i16 v134, v134, 0
  v_pk_max_i16 v135, v135, 0
  buffer_store_dwordx4 v[132:135], v12, s[40:43], s47 offen offset:256 sc0 sc1
  v_cvt_pk_bf16_f32 v136, v136, v137
  v_cvt_pk_bf16_f32 v137, v138, v139
  v_cvt_pk_bf16_f32 v138, v152, v153
  v_cvt_pk_bf16_f32 v139, v154, v155
  v_pk_max_i16 v136, v136, 0
  v_pk_max_i16 v137, v137, 0
  v_pk_max_i16 v138, v138, 0
  v_pk_max_i16 v139, v139, 0
  buffer_store_dwordx4 v[136:139], v12, s[40:43], s47 offen offset:1024 sc0 sc1
  v_cvt_pk_bf16_f32 v140, v140, v141
  v_cvt_pk_bf16_f32 v141, v142, v143
  v_cvt_pk_bf16_f32 v142, v156, v157
  v_cvt_pk_bf16_f32 v143, v158, v159
  v_pk_max_i16 v140, v140, 0
  v_pk_max_i16 v141, v141, 0
  v_pk_max_i16 v142, v142, 0
  v_pk_max_i16 v143, v143, 0
  buffer_store_dwordx4 v[140:143], v12, s[40:43], s47 offen offset:1280 sc0 sc1
.Lattn_kernel_skip_88:
  s_and_b32 s20, s2, 7
  s_lshr_b32 s21, s2, 3
  s_and_b32 s22, s20, 3
  s_lshr_b32 s23, s20, 2
  s_and_b32 s20, s21, 3
  s_lshr_b32 s21, s21, 2
  s_mul_i32 s22, s22, 4
  s_add_u32 s22, s22, s20
  s_mul_i32 s23, s23, 8
  s_add_u32 s23, s23, s21
  v_and_b32 v6, 15, v0
  v_lshrrev_b32 v8, 4, v0
  v_bfe_u32 v13, v0, 4, 1
  v_lshlrev_b32 v2, 4, v6
  v_lshl_add_u32 v2, v13, 9, v2
  v_lshl_add_u32 v2, v7, 12, v2
  s_lshl_b32 s27, s24, 10
  v_add_u32 v2, s27, v2
  v_bfe_u32 v13, v0, 2, 2
  v_lshlrev_b32 v4, 7, v13
  v_lshl_add_u32 v4, v8, 9, v4
  v_and_b32 v13, 3, v0
  v_lshl_add_u32 v4, v13, 3, v4
  v_bfe_u32 v13, v0, 3, 2
  v_lshl_add_u32 v4, v13, 5, v4
  v_add_u32 v4, 16384, v4
  v_mov_b32 v32, 0
  v_mov_b32 v33, 0
  v_mov_b32 v34, 0
  v_mov_b32 v35, 0
  v_mov_b32 v36, 0
  v_mov_b32 v37, 0
  v_mov_b32 v38, 0
  v_mov_b32 v39, 0
  v_mov_b32 v40, 0
  v_mov_b32 v41, 0
  v_mov_b32 v42, 0
  v_mov_b32 v43, 0
  v_mov_b32 v44, 0
  v_mov_b32 v45, 0
  v_mov_b32 v46, 0
  v_mov_b32 v47, 0
  v_mov_b32 v48, 0
  v_mov_b32 v49, 0
  v_mov_b32 v50, 0
  v_mov_b32 v51, 0
  v_mov_b32 v52, 0
  v_mov_b32 v53, 0
  v_mov_b32 v54, 0
  v_mov_b32 v55, 0
  v_mov_b32 v56, 0
  v_mov_b32 v57, 0
  v_mov_b32 v58, 0
  v_mov_b32 v59, 0
  v_mov_b32 v60, 0
  v_mov_b32 v61, 0
  v_mov_b32 v62, 0
  v_mov_b32 v63, 0
  s_lshl_b32 s30, s24, 12
  s_add_u32 s30, s30, 123904
  v_and_b32 v17, 7, v0
  v_xor_b32 v22, v17, v7
  v_lshlrev_b32 v22, 4, v22
  v_lshl_add_u32 v23, v6, 7, v22
  v_lshl_add_u32 v22, v9, 7, v22
  v_add_u32 v22, s30, v22
  v_bfe_u32 v13, v0, 4, 1
  v_lshl_add_u32 v23, v13, 3, v23
  v_add_u32 v23, s30, v23
  v_lshrrev_b32 v13, 3, v0
  v_xor_b32 v24, v17, v13
  v_lshlrev_b32 v24, 4, v24
  v_lshl_add_u32 v24, v13, 7, v24
  v_add_u32 v24, s30, v24
  s_lshl_b32 s28, s22, 7
  s_lshl_b32 s29, s24, 5
  s_add_u32 s28, s28, s29
  v_add_u32 v25, s28, v13
  v_lshlrev_b32 v25, 11, v25
  v_lshl_add_u32 v25, v17, 4, v25
  v_mov_b32 v26, 122880
  v_lshl_add_u32 v26, v8, 4, v26
  s_lshl_b32 s30, s24, 7
  s_add_u32 s30, s30, 123392
  v_lshl_add_u32 v27, v6, 2, s30
  s_mov_b32 s34, 0
  s_mov_b32 s35, 0
  v_add_u32 v3, s34, v2
  v_add_u32 v5, s34, v4
  v_xor_b32 v10, 32, v5
  v_xor_b32 v11, 64, v5
  v_xor_b32 v12, 96, v5
  s_cmp_lt_u32 s2, 224
  s_cselect_b32 s53, 2, 99
  s_barrier
  s_barrier
  ds_read_b128 v[64:67], v3 offset:0
  ds_read_b64_tr_b16 v[72:73], v5 offset:0
  ds_read_b64_tr_b16 v[74:75], v5 offset:2048
  ds_read_b128 v[68:71], v3 offset:256
  ds_read_b64_tr_b16 v[76:77], v10 offset:0
  ds_read_b64_tr_b16 v[78:79], v10 offset:2048
  ds_read_b64_tr_b16 v[80:81], v11 offset:0
  ds_read_b64_tr_b16 v[82:83], v11 offset:2048
  ds_read_b64_tr_b16 v[84:85], v12 offset:0
  ds_read_b64_tr_b16 v[86:87], v12 offset:2048
.Lattn_kernel_loop_91:
  s_cmp_eq_u32 s35, s53
  s_cbranch_scc1 .Lattn_kernel_pub_93
.Lattn_kernel_pubr_94:
  s_cmp_ge_u32 s35, 53
  s_cbranch_scc1 .Lattn_kernel_mid_95
.Lattn_kernel_midr_96:
  s_add_u32 s34, s34, 24576
  s_cmp_eq_u32 s34, 122880
  s_cselect_b32 s34, 0, s34
  s_add_u32 s35, s35, 1
  s_waitcnt lgkmcnt(0)
  v_mfma_f32_16x16x32_bf16 v[32:35], v[72:75], v[64:67], v[32:35]
  ds_read_b128 v[88:91], v3 offset:8192
  ds_read_b64_tr_b16 v[96:97], v5 offset:4096
  v_mfma_f32_16x16x32_bf16 v[36:39], v[72:75], v[68:71], v[36:39]
  ds_read_b64_tr_b16 v[98:99], v5 offset:6144
  ds_read_b128 v[92:95], v3 offset:8448
  v_mfma_f32_16x16x32_bf16 v[40:43], v[76:79], v[64:67], v[40:43]
  ds_read_b64_tr_b16 v[100:101], v10 offset:4096
  ds_read_b64_tr_b16 v[102:103], v10 offset:6144
  v_mfma_f32_16x16x32_bf16 v[44:47], v[76:79], v[68:71], v[44:47]
  ds_read_b64_tr_b16 v[104:105], v11 offset:4096
  ds_read_b64_tr_b16 v[106:107], v11 offset:6144
  v_mfma_f32_16x16x32_bf16 v[48:51], v[80:83], v[64:67], v[48:51]
  ds_read_b64_tr_b16 v[108:109], v12 offset:4096
  ds_read_b64_tr_b16 v[110:111], v12 offset:6144
  v_mfma_f32_16x16x32_bf16 v[52:55], v[80:83], v[68:71], v[52:55]
  v_mfma_f32_16x16x32_bf16 v[56:59], v[84:87], v[64:67], v[56:59]
  v_mfma_f32_16x16x32_bf16 v[60:63], v[84:87], v[68:71], v[60:63]
  v_add_u32 v3, s34, v2
  v_add_u32 v5, s34, v4
  v_xor_b32 v10, 32, v5
  v_xor_b32 v11, 64, v5
  v_xor_b32 v12, 96, v5
  s_cmp_eq_u32 s35, 56
  s_cbranch_scc1 .Lattn_kernel_last_92
  s_waitcnt lgkmcnt(0)
  v_mfma_f32_16x16x32_bf16 v[32:35], v[96:99], v[88:91], v[32:35]
  s_barrier
  ds_read_b128 v[64:67], v3 offset:0
  ds_read_b64_tr_b16 v[72:73], v5 offset:0
  v_mfma_f32_16x16x32_bf16 v[36:39], v[96:99], v[92:95], v[36:39]
  ds_read_b64_tr_b16 v[74:75], v5 offset:2048
  ds_read_b128 v[68:71], v3 offset:256
  v_mfma_f32_16x16x32_bf16 v[40:43], v[100:103], v[88:91], v[40:43]
  ds_read_b64_tr_b16 v[76:77], v10 offset:0
  ds_read_b64_tr_b16 v[78:79], v10 offset:2048
  v_mfma_f32_16x16x32_bf16 v[44:47], v[100:103], v[92:95], v[44:47]
  ds_read_b64_tr_b16 v[80:81], v11 offset:0
  ds_read_b64_tr_b16 v[82:83], v11 offset:2048
  v_mfma_f32_16x16x32_bf16 v[48:51], v[104:107], v[88:91], v[48:51]
  ds_read_b64_tr_b16 v[84:85], v12 offset:0
  ds_read_b64_tr_b16 v[86:87], v12 offset:2048
  v_mfma_f32_16x16x32_bf16 v[52:55], v[104:107], v[92:95], v[52:55]
  v_mfma_f32_16x16x32_bf16 v[56:59], v[108:111], v[88:91], v[56:59]
  v_mfma_f32_16x16x32_bf16 v[60:63], v[108:111], v[92:95], v[60:63]
  s_branch .Lattn_kernel_loop_91
.Lattn_kernel_pub_93:
  s_waitcnt vmcnt(0)
  v_mov_b32 v18, 163784
  v_mov_b32 v19, 1
  s_mov_b64 exec, 1
  ds_add_rtn_u32 v20, v18, v19
  s_mov_b64 exec, -1
  s_lshl_b32 s29, s22, 8
  s_add_u32 s29, s29, 663552
  s_waitcnt lgkmcnt(0)
  v_readfirstlane_b32 s30, v20
  s_nop 3
  s_cmp_lg_u32 s30, 3
  s_cbranch_scc1 .Lattn_kernel_nolast_97
  v_mov_b32 v18, 0
  v_mov_b32 v19, 1
  s_mov_b64 exec, 1
  buffer_atomic_add v19, v18, s[16:19], s29 offen sc1
  s_mov_b64 exec, -1
.Lattn_kernel_nolast_97:
  s_branch .Lattn_kernel_pubr_94
.Lattn_kernel_mid_95:
  s_waitcnt lgkmcnt(0)
  s_cmp_eq_u32 s35, 54
  s_cbranch_scc1 .Lattn_kernel_mp_99
  s_cmp_eq_u32 s35, 55
  s_cbranch_scc1 .Lattn_kernel_mp_100
  v_permlane32_swap_b32 v240, v242
  v_permlane32_swap_b32 v241, v243
  v_xor_b32 v13, 0, v22
  ds_write_b128 v13, v[240:243]
  v_permlane32_swap_b32 v244, v246
  v_permlane32_swap_b32 v245, v247
  v_xor_b32 v13, 32, v22
  ds_write_b128 v13, v[244:247]
  v_permlane32_swap_b32 v248, v250
  v_permlane32_swap_b32 v249, v251
  v_xor_b32 v13, 64, v22
  ds_write_b128 v13, v[248:251]
  v_permlane32_swap_b32 v252, v254
  v_permlane32_swap_b32 v253, v255
  v_xor_b32 v13, 96, v22
  ds_write_b128 v13, v[252:255]
  s_branch .Lattn_kernel_midr_96
.Lattn_kernel_mp_99:
  v_xor_b32 v13, 0, v23
  ds_read_b64 v[240:241], v13 offset:0
  ds_read_b64 v[242:243], v13 offset:2048
  v_xor_b32 v13, 32, v23
  ds_read_b64 v[244:245], v13 offset:0
  ds_read_b64 v[246:247], v13 offset:2048
  v_xor_b32 v13, 64, v23
  ds_read_b64 v[248:249], v13 offset:0
  ds_read_b64 v[250:251], v13 offset:2048
  v_xor_b32 v13, 96, v23
  ds_read_b64 v[252:253], v13 offset:0
  ds_read_b64 v[254:255], v13 offset:2048
  ds_read_b128 v[112:115], v26 offset:0
  ds_read_b128 v[120:123], v26 offset:64
  ds_read_b128 v[128:131], v26 offset:128
  ds_read_b128 v[136:139], v26 offset:192
  ds_read_b32 v14, v27 offset:0
  ds_read_b32 v15, v27 offset:64
  s_branch .Lattn_kernel_midr_96
.Lattn_kernel_mp_100:
  v_lshlrev_b32 v144, 16, v240
  v_and_b32 v145, 0xffff0000, v240
  v_lshlrev_b32 v146, 16, v241
  v_and_b32 v147, 0xffff0000, v241
  v_lshlrev_b32 v148, 16, v242
  v_and_b32 v149, 0xffff0000, v242
  v_lshlrev_b32 v150, 16, v243
  v_and_b32 v151, 0xffff0000, v243
  v_lshlrev_b32 v152, 16, v244
  v_and_b32 v153, 0xffff0000, v244
  v_lshlrev_b32 v154, 16, v245
  v_and_b32 v155, 0xffff0000, v245
  v_lshlrev_b32 v156, 16, v246
  v_and_b32 v157, 0xffff0000, v246
  v_lshlrev_b32 v158, 16, v247
  v_and_b32 v159, 0xffff0000, v247
  v_lshlrev_b32 v160, 16, v248
  v_and_b32 v161, 0xffff0000, v248
  v_lshlrev_b32 v162, 16, v249
  v_and_b32 v163, 0xffff0000, v249
  v_lshlrev_b32 v164, 16, v250
  v_and_b32 v165, 0xffff0000, v250
  v_lshlrev_b32 v166, 16, v251
  v_and_b32 v167, 0xffff0000, v251
  v_lshlrev_b32 v168, 16, v252
  v_and_b32 v169, 0xffff0000, v252
  v_lshlrev_b32 v170, 16, v253
  v_and_b32 v171, 0xffff0000, v253
  v_lshlrev_b32 v172, 16, v254
  v_and_b32 v173, 0xffff0000, v254
  v_lshlrev_b32 v174, 16, v255
  v_and_b32 v175, 0xffff0000, v255
  v_mul_f32 v116, v112, v15
  v_mul_f32 v112, v112, v14
  v_mul_f32 v117, v113, v15
  v_mul_f32 v113, v113, v14
  v_mul_f32 v118, v114, v15
  v_mul_f32 v114, v114, v14
  v_mul_f32 v119, v115, v15
  v_mul_f32 v115, v115, v14
  v_mul_f32 v124, v120, v15
  v_mul_f32 v120, v120, v14
  v_mul_f32 v125, v121, v15
  v_mul_f32 v121, v121, v14
  v_mul_f32 v126, v122, v15
  v_mul_f32 v122, v122, v14
  v_mul_f32 v127, v123, v15
  v_mul_f32 v123, v123, v14
  v_mul_f32 v132, v128, v15
  v_mul_f32 v128, v128, v14
  v_mul_f32 v133, v129, v15
  v_mul_f32 v129, v129, v14
  v_mul_f32 v134, v130, v15
  v_mul_f32 v130, v130, v14
  v_mul_f32 v135, v131, v15
  v_mul_f32 v131, v131, v14
  v_mul_f32 v140, v136, v15
  v_mul_f32 v136, v136, v14
  v_mul_f32 v141, v137, v15
  v_mul_f32 v137, v137, v14
  v_mul_f32 v142, v138, v15
  v_mul_f32 v138, v138, v14
  v_mul_f32 v143, v139, v15
  v_mul_f32 v139, v139, v14
  s_branch .Lattn_kernel_midr_96
.Lattn_kernel_last_92:
  s_waitcnt lgkmcnt(0)
  v_mfma_f32_16x16x32_bf16 v[32:35], v[96:99], v[88:91], v[32:35]
  v_mfma_f32_16x16x32_bf16 v[36:39], v[96:99], v[92:95], v[36:39]
  v_mfma_f32_16x16x32_bf16 v[40:43], v[100:103], v[88:91], v[40:43]
  v_mfma_f32_16x16x32_bf16 v[44:47], v[100:103], v[92:95], v[44:47]
  v_mfma_f32_16x16x32_bf16 v[48:51], v[104:107], v[88:91], v[48:51]
  v_mfma_f32_16x16x32_bf16 v[52:55], v[104:107], v[92:95], v[52:55]
  v_mfma_f32_16x16x32_bf16 v[56:59], v[108:111], v[88:91], v[56:59]
  v_mfma_f32_16x16x32_bf16 v[60:63], v[108:111], v[92:95], v[60:63]
  s_mov_b32 s40, s58
  s_mov_b32 s41, s59
  s_mov_b32 s42, 0x400000
  s_mov_b32 s43, 0x20000
  s_lshl_b32 s31, s23, 7
  s_nop 2
  v_pk_fma_f32 v[144:145], v[32:33], v[112:113], v[144:145]
  v_pk_fma_f32 v[146:147], v[34:35], v[114:115], v[146:147]
  v_pk_fma_f32 v[148:149], v[36:37], v[116:117], v[148:149]
  v_pk_fma_f32 v[150:151], v[38:39], v[118:119], v[150:151]
  v_cvt_pk_bf16_f32 v240, v144, v145
  v_cvt_pk_bf16_f32 v241, v146, v147
  v_cvt_pk_bf16_f32 v242, v148, v149
  v_cvt_pk_bf16_f32 v243, v150, v151
  v_xor_b32 v13, 0, v23
  ds_write_b64 v13, v[240:241] offset:0
  ds_write_b64 v13, v[242:243] offset:2048
  v_pk_fma_f32 v[152:153], v[40:41], v[120:121], v[152:153]
  v_pk_fma_f32 v[154:155], v[42:43], v[122:123], v[154:155]
  v_pk_fma_f32 v[156:157], v[44:45], v[124:125], v[156:157]
  v_pk_fma_f32 v[158:159], v[46:47], v[126:127], v[158:159]
  v_cvt_pk_bf16_f32 v244, v152, v153
  v_cvt_pk_bf16_f32 v245, v154, v155
  v_cvt_pk_bf16_f32 v246, v156, v157
  v_cvt_pk_bf16_f32 v247, v158, v159
  v_xor_b32 v13, 32, v23
  ds_write_b64 v13, v[244:245] offset:0
  ds_write_b64 v13, v[246:247] offset:2048
  v_pk_fma_f32 v[160:161], v[48:49], v[128:129], v[160:161]
  v_pk_fma_f32 v[162:163], v[50:51], v[130:131], v[162:163]
  v_pk_fma_f32 v[164:165], v[52:53], v[132:133], v[164:165]
  v_pk_fma_f32 v[166:167], v[54:55], v[134:135], v[166:167]
  v_cvt_pk_bf16_f32 v248, v160, v161
  v_cvt_pk_bf16_f32 v249, v162, v163
  v_cvt_pk_bf16_f32 v250, v164, v165
  v_cvt_pk_bf16_f32 v251, v166, v167
  v_xor_b32 v13, 64, v23
  ds_write_b64 v13, v[248:249] offset:0
  ds_write_b64 v13, v[250:251] offset:2048
  v_pk_fma_f32 v[168:169], v[56:57], v[136:137], v[168:169]
  v_pk_fma_f32 v[170:171], v[58:59], v[138:139], v[170:171]
  v_pk_fma_f32 v[172:173], v[60:61], v[140:141], v[172:173]
  v_pk_fma_f32 v[174:175], v[62:63], v[142:143], v[174:175]
  v_cvt_pk_bf16_f32 v252, v168, v169
  v_cvt_pk_bf16_f32 v253, v170, v171
  v_cvt_pk_bf16_f32 v254, v172, v173
  v_cvt_pk_bf16_f32 v255, v174, v175
  v_xor_b32 v13, 96, v23
  ds_write_b64 v13, v[252:253] offset:0
  ds_write_b64 v13, v[254:255] offset:2048
  s_waitcnt lgkmcnt(0)
  ds_read_b128 v[64:67], v24 offset:0
  ds_read_b128 v[68:71], v24 offset:1024
  ds_read_b128 v[72:75], v24 offset:2048
  ds_read_b128 v[76:79], v24 offset:3072
  s_waitcnt lgkmcnt(3)
  buffer_store_dwordx4 v[64:67], v25, s[40:43], s31 offen sc0 sc1
  s_add_u32 s31, s31, 16384
  s_waitcnt lgkmcnt(2)
  buffer_store_dwordx4 v[68:71], v25, s[40:43], s31 offen sc0 sc1
  s_add_u32 s31, s31, 16384
  s_waitcnt lgkmcnt(1)
  buffer_store_dwordx4 v[72:75], v25, s[40:43], s31 offen sc0 sc1
  s_add_u32 s31, s31, 16384
  s_waitcnt lgkmcnt(0)
  buffer_store_dwordx4 v[76:79], v25, s[40:43], s31 offen sc0 sc1
  s_add_u32 s31, s31, 16384
  s_endpgm
.Lattn_kernel_end_3:
  s_endpgm
.p2align 8
.Ltext_end:
.section .rodata,"a"
.p2align 6
.amdhsa_kernel mod_kernel
  .amdhsa_next_free_vgpr 80
  .amdhsa_next_free_sgpr 48
  .amdhsa_accum_offset 80
  .amdhsa_group_segment_fixed_size 0
  .amdhsa_kernarg_size 88
  .amdhsa_user_sgpr_count 2
  .amdhsa_user_sgpr_kernarg_segment_ptr 1
  .amdhsa_system_sgpr_workgroup_id_x 1
.end_amdhsa_kernel
.p2align 6
.amdhsa_kernel attn_kernel
  .amdhsa_next_free_vgpr 256
  .amdhsa_next_free_sgpr 64
  .amdhsa_accum_offset 256
  .amdhsa_group_segment_fixed_size 0
  .amdhsa_kernarg_size 88
  .amdhsa_user_sgpr_count 2
  .amdhsa_user_sgpr_kernarg_segment_ptr 1
  .amdhsa_system_sgpr_workgroup_id_x 1
.end_amdhsa_kernel
```
